```python
import torch

def _softmax(x, axis=-1):
    return torch.softmax(x, dim=axis)
def _gelu(x):
    return torch.nn.functional.gelu(x, approximate="tanh")
def _silu(x):
    return torch.nn.functional.silu(x)
def _sigmoid(x):
    return torch.sigmoid(x)
def _layernorm(x, axis=-1, eps=1e-5):
    m = x.mean(dim=axis, keepdim=True)
    v = x.var(dim=axis, keepdim=True, unbiased=False)
    return (x - m) / torch.sqrt(v + eps)
def _scatter_add(tgt, idx, src, axis=0):
    return tgt.clone().index_add_(axis, idx, src)
def _segment_sum(src, seg, n):
    out = torch.zeros((n,) + src.shape[1:], dtype=src.dtype)
    return out.index_add_(0, seg, src)
def _pad(x, pw):
    flat = tuple(v for pair in reversed(pw) for v in pair)
    return torch.nn.functional.pad(x, flat)

kernel_name = 'gated_mix__mha_block__dense_activation_relu__prompt'

def setup_inputs():

    _w = (lambda a: (lambda t: t.to(torch.bfloat16) if t.is_floating_point() else t)(torch.as_tensor(a)))
    def _A_setup():
        B, S, D, H = 1, 2048, 640, 32
        return {
            "x": _w((lambda *s: torch.randn(*s, dtype=torch.bfloat16) * 0.05)(B, S, D)),
            "wqkv": _w((lambda *s: torch.randn(*s, dtype=torch.bfloat16) * 0.8)(D, 3 * D)),
            "wo": _w((lambda *s: torch.randn(*s, dtype=torch.bfloat16) * 0.2)(D, D)),
        }
    _A_in = _A_setup()

    def _B_setup():
        B, S, D, Dff = 1, 2048, 640, 1728
        return {
            "x": _w((lambda *s: torch.randn(*s, dtype=torch.bfloat16) * 0.05)(B, S, D)),
            "w1": _w((lambda *s: torch.randn(*s, dtype=torch.bfloat16) * 0.05)(D, Dff)),
            "w2": _w((lambda *s: torch.randn(*s, dtype=torch.bfloat16) * 0.05)(Dff, D)),
        }
    _B_in = _B_setup()

    return {
        "A_x": _A_in["x"],
        "A_wqkv": _A_in["wqkv"],
        "A_wo": _A_in["wo"],
        "B_x": _B_in["x"],
        "B_w1": _B_in["w1"],
        "B_w2": _B_in["w2"],
        "gate_w": _w((lambda *s: torch.randn(*s, dtype=torch.bfloat16) * 0.05)(640) * 16.0),
    }

def reference(A_x, A_wqkv, A_wo, B_x, B_w1, B_w2, gate_w):
    def _A_ref(x, wqkv, wo):
        B, S, D = x.shape
        H = 32
        Dh = D // H
        qkv = (lambda x, *d: x.permute(*d))((x @ wqkv).reshape(B, S, 3, H, Dh), 2, 0, 3, 1, 4)
        q, k, v = qkv[0], qkv[1], qkv[2]
        scores = torch.einsum("bhqd,bhkd->bhqk", q, k) * (Dh ** -0.5)
        p = _softmax(scores, axis=-1)
        o = torch.einsum("bhqk,bhkd->bhqd", p, v)
        return (lambda x, *d: x.permute(*d))(o, 0, 2, 1, 3).reshape(B, S, D) @ wo

    def _B_ref(x, w1, w2):
        h = torch.einsum("bsd,df->bsf", x, w1)
        zero = torch.zeros_like(h)
        h = torch.maximum(h, zero)
        return torch.einsum("bsf,fd->bsd", h, w2)

    x = A_x
    g = _sigmoid((x * gate_w).sum(-1, keepdims=True))
    a = _A_ref(x, A_wqkv, A_wo)
    b = _B_ref(x, B_w1, B_w2)
    return g * a + (1 - g) * b
```

```asm
; @launch grid=(256,1,1) block=(512,1,1) lds=163840
.amdgcn_target "amdgcn-amd-amdhsa--gfx950"
.text
.globl gated_mix__mha_block__dense_activation_relu__prompt_kernel
.p2align 12
.p2align 8
.type gated_mix__mha_block__dense_activation_relu__prompt_kernel,@function
gated_mix__mha_block__dense_activation_relu__prompt_kernel:
    s_cmp_ge_u32 s2, 256
    s_cbranch_scc1 K_END
    s_load_dwordx2 s[4:5], s[0:1], 0
    s_load_dwordx2 s[6:7], s[0:1], 8
    s_load_dwordx2 s[8:9], s[0:1], 72
    s_load_dwordx2 s[10:11], s[0:1], 32
    s_load_dwordx2 s[80:81], s[0:1], 64
    s_load_dwordx2 s[40:41], s[0:1], 40
    s_load_dwordx2 s[42:43], s[0:1], 16
    v_and_b32 v1, 63, v0
    v_lshrrev_b32 v2, 6, v0
    s_bfe_u32 s24, s2, 0x10002
    s_lshl_b32 s24, s24, 3
    s_lshr_b32 s3, s2, 5
    s_add_u32 s24, s24, s3
    s_bfe_u32 s3, s2, 0x20003
    s_and_b32 s27, s2, 3
    s_lshl_b32 s25, s27, 2
    s_add_u32 s25, s25, s3
    s_mul_i32 s34, s27, 3
    s_add_u32 s34, s34, s3
    s_lshl_b32 s34, s34, 1
    s_add_u32 s35, s34, 1
    s_add_u32 s27, s27, 24
    s_cmp_lt_u32 s3, 3
    s_cselect_b32 s34, s34, s27
    s_cselect_b32 s33, 1, 0
    v_readfirstlane_b32 s38, v2
    s_cmp_lt_u32 s38, 4
    s_cbranch_scc0 PAD_END
    s_cmp_ge_u32 s38, 2
    s_cbranch_scc0 CW_END
    s_getpc_b64 s[48:49]
    s_and_b32 s48, s48, 0xfffff000
    s_bfe_u32 s3, s2, 131075
    s_lshl_b32 s3, s3, 1
    s_add_u32 s3, s3, s38
    s_sub_u32 s3, s3, 2
    s_lshl_b32 s3, s3, 13
    v_lshlrev_b32 v250, 7, v1
    v_add_u32 v250, s3, v250
    v_min_u32 v250, 57856, v250
    v_mov_b32 v251, s49
    v_add_co_u32 v250, vcc, s48, v250
    v_addc_co_u32 v251, vcc, 0, v251, vcc
    global_load_dword v252, v[250:251], off
CW_END:
    s_cmp_eq_u32 s38, 0
    s_cbranch_scc1 PAD_1
    s_cmp_eq_u32 s38, 1
    s_cbranch_scc1 PAD_2
    s_cmp_eq_u32 s38, 2
    s_cbranch_scc1 PAD_3
    s_cmp_eq_u32 s38, 3
    s_cbranch_scc1 PAD_4
PAD_END:
    s_cmp_eq_u32 s25, 15
    s_cbranch_scc1 K_SPARE
    s_cmp_lt_u32 s38, 4
    s_cbranch_scc1 PA_COMP
    s_sub_u32 s38, s38, 4
    s_lshl_b32 s47, s38, 10
    v_lshrrev_b32 v2, 3, v1
    v_and_b32 v3, 7, v1
    s_lshl_b32 s3, s38, 3
    v_add_u32 v2, s3, v2
    v_bfe_u32 v16, v2, 1, 3
    v_xor_b32 v16, v16, v3
    s_mul_i32 s3, s24, 163840
    v_mul_u32_u24 v17, 1280, v2
    v_lshl_add_u32 v16, v16, 4, s3
    v_add_u32 v4, v16, v17
    v_add_u32 v5, 40960, v4
    v_add_u32 v6, 40960, v5
    v_add_u32 v7, 40960, v6
    v_bfe_u32 v16, v1, 4, 1
    v_lshlrev_b32 v16, 2, v16
    v_xor_b32 v3, v3, v16
    v_lshlrev_b32 v3, 4, v3
    s_lshl_b32 s3, s25, 8
    v_mul_u32_u24 v16, 3840, v2
    v_add3_u32 v8, v16, v3, s3
    v_add_u32 v9, 128, v8
    v_add_u32 v10, 122880, v8
    v_add_u32 v11, 122880, v9
    s_add_u32 s3, s24, s25
    s_mul_i32 s27, s3, 205
    s_lshr_b32 s27, s27, 11
    s_mul_i32 s27, s27, 10
    s_sub_u32 s3, s3, s27
    s_lshl_b32 s70, s3, 7
    s_mul_i32 s60, s3, 245760
    s_add_u32 s3, s3, 1
    s_cmp_eq_u32 s3, 10
    s_cselect_b32 s3, 0, s3
    s_lshl_b32 s71, s3, 7
    s_mul_i32 s61, s3, 245760
    s_add_u32 s3, s3, 1
    s_cmp_eq_u32 s3, 10
    s_cselect_b32 s3, 0, s3
    s_waitcnt lgkmcnt(0)
    s_mov_b32 s12, s4
    s_and_b32 s13, s5, 0xffff
    s_mov_b32 s14, 2621440
    s_mov_b32 s15, 0x00020000
    s_mov_b32 s16, s6
    s_and_b32 s17, s7, 0xffff
    s_mov_b32 s18, 2457600
    s_mov_b32 s19, 0x00020000
    s_add_u32 m0, s47, 65536
    s_nop 0
    buffer_load_dwordx4 v4, s[12:15], s70 offen lds
    s_add_u32 m0, s47, 81920
    s_nop 0
    buffer_load_dwordx4 v8, s[16:19], s60 offen lds
    s_add_u32 m0, s47, 69632
    s_nop 0
    buffer_load_dwordx4 v5, s[12:15], s70 offen lds
    s_add_u32 m0, s47, 86016
    s_nop 0
    buffer_load_dwordx4 v9, s[16:19], s60 offen lds
    s_add_u32 m0, s47, 73728
    s_nop 0
    buffer_load_dwordx4 v6, s[12:15], s70 offen lds
    s_add_u32 m0, s47, 90112
    s_nop 0
    buffer_load_dwordx4 v10, s[16:19], s60 offen lds
    s_add_u32 m0, s47, 77824
    s_nop 0
    buffer_load_dwordx4 v7, s[12:15], s70 offen lds
    s_add_u32 m0, s47, 94208
    s_nop 0
    buffer_load_dwordx4 v11, s[16:19], s60 offen lds
    s_add_u32 m0, s47, 98304
    s_nop 0
    buffer_load_dwordx4 v4, s[12:15], s71 offen lds
    s_add_u32 m0, s47, 114688
    s_nop 0
    buffer_load_dwordx4 v8, s[16:19], s61 offen lds
    s_add_u32 m0, s47, 102400
    s_nop 0
    buffer_load_dwordx4 v5, s[12:15], s71 offen lds
    s_add_u32 m0, s47, 118784
    s_nop 0
    buffer_load_dwordx4 v9, s[16:19], s61 offen lds
    s_add_u32 m0, s47, 106496
    s_nop 0
    buffer_load_dwordx4 v6, s[12:15], s71 offen lds
    s_lshl_b32 s72, s3, 7
    s_mul_i32 s62, s3, 245760
    s_add_u32 s3, s3, 1
    s_cmp_eq_u32 s3, 10
    s_cselect_b32 s3, 0, s3
    s_lshl_b32 s73, s3, 7
    s_mul_i32 s63, s3, 245760
    s_add_u32 s3, s3, 1
    s_cmp_eq_u32 s3, 10
    s_cselect_b32 s3, 0, s3
    s_lshl_b32 s74, s3, 7
    s_mul_i32 s64, s3, 245760
    s_add_u32 s3, s3, 1
    s_cmp_eq_u32 s3, 10
    s_cselect_b32 s3, 0, s3
    s_lshl_b32 s75, s3, 7
    s_mul_i32 s65, s3, 245760
    s_add_u32 s3, s3, 1
    s_cmp_eq_u32 s3, 10
    s_cselect_b32 s3, 0, s3
    s_lshl_b32 s76, s3, 7
    s_mul_i32 s66, s3, 245760
    s_add_u32 s3, s3, 1
    s_cmp_eq_u32 s3, 10
    s_cselect_b32 s3, 0, s3
    s_lshl_b32 s77, s3, 7
    s_mul_i32 s67, s3, 245760
    s_add_u32 s3, s3, 1
    s_cmp_eq_u32 s3, 10
    s_cselect_b32 s3, 0, s3
    s_lshl_b32 s78, s3, 7
    s_mul_i32 s68, s3, 245760
    s_add_u32 s3, s3, 1
    s_cmp_eq_u32 s3, 10
    s_cselect_b32 s3, 0, s3
    s_lshl_b32 s79, s3, 7
    s_mul_i32 s69, s3, 245760
    s_mul_i32 s48, s70, 1728
    s_mul_i32 s49, s71, 1728
    s_mul_i32 s50, s72, 1728
    s_mul_i32 s51, s73, 1728
    s_mul_i32 s52, s74, 1728
    s_mul_i32 s53, s75, 1728
    s_mul_i32 s54, s76, 1728
    s_mul_i32 s55, s77, 1728
    s_mul_i32 s56, s78, 1728
    s_mul_i32 s57, s79, 1728
    s_mov_b32 s28, s10
    s_and_b32 s29, s11, 0xffff
    s_mov_b32 s30, 2211840
    s_mov_b32 s31, 0x00020000
    s_mov_b32 s80, s80
    s_and_b32 s81, s81, 0xffff
    s_mov_b32 s82, 256
    s_mov_b32 s83, 0x00020000
    v_mul_u32_u24 v16, 3456, v2
    v_add_u32 v16, v16, v3
    s_lshl_b32 s3, s34, 7
    s_cmp_eq_u32 s33, 0
    v_add_u32 v12, s3, v16
    v_add_u32 v13, 110592, v12
    s_lshl_b32 s3, s35, 7
    s_cmp_eq_u32 s33, 0
    s_cselect_b32 s3, 0x40000000, s3
    v_add_u32 v14, s3, v16
    v_add_u32 v15, 110592, v14
    s_lshl_b32 s85, s24, 9
    s_add_u32 s85, s85, 65536
    s_mov_b32 s39, -1
    s_lshl_b32 s3, s38, 12
    v_mov_b32 v26, s3
    s_lshr_b32 s7, s2, 6
    s_lshl_b32 s7, s7, 2
    s_bfe_u32 s20, s2, 0x20001
    s_add_u32 s7, s7, s20
    s_bfe_u32 s20, s2, 0x10005
    s_lshl_b32 s20, s20, 4
    s_add_u32 s4, s7, s20
    s_and_b32 s7, s2, 1
    s_lshl_b32 s7, s7, 2
    s_bfe_u32 s20, s2, 0x20003
    s_add_u32 s5, s7, s20
    v_lshrrev_b32 v22, 4, v1
    v_and_b32 v23, 15, v1
    s_lshl_b32 s6, s4, 2
    s_add_u32 s6, s6, s38
    s_lshl_b32 s3, s6, 6
    v_lshl_add_u32 v255, v23, 2, s3
    s_mul_i32 s6, s6, 20480
    s_mul_i32 s3, s5, 160
    s_add_u32 s3, s3, s6
    v_mul_u32_u24 v2, 1280, v23
    v_add_u32 v2, s3, v2
    v_lshl_add_u32 v253, v22, 3, v2
    v_and_b32 v3, 1, v22
    v_lshl_add_u32 v2, v3, 5, v2
    v_lshrrev_b32 v3, 1, v22
    v_lshl_add_u32 v252, v3, 4, v2
    s_mov_b32 s3, 54272
    v_lshlrev_b32 v2, 3, v22
    v_lshrrev_b32 v3, 2, v23
    v_add_u32 v2, v2, v3
    v_mul_u32_u24 v2, 160, v2
    v_and_b32 v3, 3, v23
    v_lshlrev_b32 v3, 3, v3
    v_add3_u32 v2, v2, v3, s3
    v_and_b32 v3, 1, v22
    v_mul_u32_u24 v3, 640, v3
    v_add_u32 v245, v2, v3
    v_sub_u32 v2, v2, v3
    v_add_u32 v246, 640, v2
    v_add_u32 v247, 61440, v245
    v_add_u32 v248, 61440, v246
    s_mul_i32 s3, s38, 2560
    s_add_u32 s3, s3, 146432
    v_lshl_add_u32 v249, v1, 3, s3
    s_mul_i32 s3, s38, 10240
    s_add_u32 s3, s3, 5120
    v_lshl_add_u32 v254, v1, 4, s3
    s_waitcnt vmcnt(12)
    s_add_u32 m0, s47, 122880
    s_nop 0
    buffer_load_dwordx4 v10, s[16:19], s61 offen lds
    s_waitcnt vmcnt(12)
    s_add_u32 m0, s47, 110592
    s_nop 0
    buffer_load_dwordx4 v7, s[12:15], s71 offen lds
    s_waitcnt vmcnt(12)
    s_add_u32 m0, s47, 126976
    s_nop 0
    buffer_load_dwordx4 v11, s[16:19], s61 offen lds
    s_waitcnt vmcnt(12)
    s_add_u32 m0, s47, 0
    s_nop 0
    buffer_load_dwordx4 v4, s[12:15], s72 offen lds
    s_waitcnt vmcnt(12)
    s_add_u32 m0, s47, 16384
    s_nop 0
    buffer_load_dwordx4 v8, s[16:19], s62 offen lds
    s_waitcnt vmcnt(12)
    s_add_u32 m0, s47, 4096
    s_nop 0
    buffer_load_dwordx4 v5, s[12:15], s72 offen lds
    s_waitcnt vmcnt(12)
    s_add_u32 m0, s47, 20480
    s_nop 0
    buffer_load_dwordx4 v9, s[16:19], s62 offen lds
    s_waitcnt vmcnt(12)
    s_barrier
    s_add_u32 m0, s47, 8192
    s_nop 0
    buffer_load_dwordx4 v6, s[12:15], s72 offen lds
    s_waitcnt vmcnt(12)
    s_add_u32 m0, s47, 24576
    s_nop 0
    buffer_load_dwordx4 v10, s[16:19], s62 offen lds
    s_waitcnt vmcnt(12)
    s_add_u32 m0, s47, 12288
    s_nop 0
    buffer_load_dwordx4 v7, s[12:15], s72 offen lds
    s_waitcnt vmcnt(12)
    s_add_u32 m0, s47, 28672
    s_nop 0
    buffer_load_dwordx4 v11, s[16:19], s62 offen lds
    s_waitcnt vmcnt(12)
    s_add_u32 m0, s47, 32768
    s_nop 0
    buffer_load_dwordx4 v4, s[12:15], s73 offen lds
    s_waitcnt vmcnt(12)
    s_add_u32 m0, s47, 49152
    s_nop 0
    buffer_load_dwordx4 v8, s[16:19], s63 offen lds
    s_waitcnt vmcnt(12)
    s_add_u32 m0, s47, 36864
    s_nop 0
    buffer_load_dwordx4 v5, s[12:15], s73 offen lds
    s_waitcnt vmcnt(12)
    s_add_u32 m0, s47, 53248
    s_nop 0
    buffer_load_dwordx4 v9, s[16:19], s63 offen lds
    s_waitcnt vmcnt(12)
    s_barrier
    s_add_u32 m0, s47, 40960
    s_nop 0
    buffer_load_dwordx4 v6, s[12:15], s73 offen lds
    s_waitcnt vmcnt(12)
    s_add_u32 m0, s47, 57344
    s_nop 0
    buffer_load_dwordx4 v10, s[16:19], s63 offen lds
    s_waitcnt vmcnt(12)
    s_add_u32 m0, s47, 45056
    s_nop 0
    buffer_load_dwordx4 v7, s[12:15], s73 offen lds
    s_waitcnt vmcnt(12)
    s_add_u32 m0, s47, 61440
    s_nop 0
    buffer_load_dwordx4 v11, s[16:19], s63 offen lds
    s_waitcnt vmcnt(12)
    s_add_u32 m0, s47, 65536
    s_nop 0
    buffer_load_dwordx4 v4, s[12:15], s74 offen lds
    s_waitcnt vmcnt(12)
    s_add_u32 m0, s47, 81920
    s_nop 0
    buffer_load_dwordx4 v8, s[16:19], s64 offen lds
    s_waitcnt vmcnt(12)
    s_add_u32 m0, s47, 69632
    s_nop 0
    buffer_load_dwordx4 v5, s[12:15], s74 offen lds
    s_waitcnt vmcnt(12)
    s_add_u32 m0, s47, 86016
    s_nop 0
    buffer_load_dwordx4 v9, s[16:19], s64 offen lds
    s_waitcnt vmcnt(12)
    s_barrier
    s_add_u32 m0, s47, 73728
    s_nop 0
    buffer_load_dwordx4 v6, s[12:15], s74 offen lds
    s_waitcnt vmcnt(12)
    s_add_u32 m0, s47, 90112
    s_nop 0
    buffer_load_dwordx4 v10, s[16:19], s64 offen lds
    s_waitcnt vmcnt(12)
    s_add_u32 m0, s47, 77824
    s_nop 0
    buffer_load_dwordx4 v7, s[12:15], s74 offen lds
    s_waitcnt vmcnt(12)
    s_add_u32 m0, s47, 94208
    s_nop 0
    buffer_load_dwordx4 v11, s[16:19], s64 offen lds
    s_waitcnt vmcnt(12)
    s_add_u32 m0, s47, 98304
    s_nop 0
    buffer_load_dwordx4 v4, s[12:15], s75 offen lds
    s_waitcnt vmcnt(12)
    s_add_u32 m0, s47, 114688
    s_nop 0
    buffer_load_dwordx4 v8, s[16:19], s65 offen lds
    s_waitcnt vmcnt(12)
    s_add_u32 m0, s47, 102400
    s_nop 0
    buffer_load_dwordx4 v5, s[12:15], s75 offen lds
    s_waitcnt vmcnt(12)
    s_add_u32 m0, s47, 118784
    s_nop 0
    buffer_load_dwordx4 v9, s[16:19], s65 offen lds
    s_waitcnt vmcnt(12)
    s_barrier
    s_add_u32 m0, s47, 106496
    s_nop 0
    buffer_load_dwordx4 v6, s[12:15], s75 offen lds
    s_waitcnt vmcnt(12)
    s_add_u32 m0, s47, 122880
    s_nop 0
    buffer_load_dwordx4 v10, s[16:19], s65 offen lds
    s_waitcnt vmcnt(12)
    s_add_u32 m0, s47, 110592
    s_nop 0
    buffer_load_dwordx4 v7, s[12:15], s75 offen lds
    s_waitcnt vmcnt(12)
    s_add_u32 m0, s47, 126976
    s_nop 0
    buffer_load_dwordx4 v11, s[16:19], s65 offen lds
    s_waitcnt vmcnt(12)
    s_add_u32 m0, s47, 0
    s_nop 0
    buffer_load_dwordx4 v4, s[12:15], s76 offen lds
    s_waitcnt vmcnt(12)
    s_add_u32 m0, s47, 16384
    s_nop 0
    buffer_load_dwordx4 v8, s[16:19], s66 offen lds
    s_waitcnt vmcnt(12)
    s_add_u32 m0, s47, 4096
    s_nop 0
    buffer_load_dwordx4 v5, s[12:15], s76 offen lds
    s_waitcnt vmcnt(12)
    s_add_u32 m0, s47, 20480
    s_nop 0
    buffer_load_dwordx4 v9, s[16:19], s66 offen lds
    s_waitcnt vmcnt(12)
    s_barrier
    s_add_u32 m0, s47, 8192
    s_nop 0
    buffer_load_dwordx4 v6, s[12:15], s76 offen lds
    s_waitcnt vmcnt(12)
    s_add_u32 m0, s47, 24576
    s_nop 0
    buffer_load_dwordx4 v10, s[16:19], s66 offen lds
    s_waitcnt vmcnt(12)
    s_add_u32 m0, s47, 12288
    s_nop 0
    buffer_load_dwordx4 v7, s[12:15], s76 offen lds
    s_waitcnt vmcnt(12)
    s_add_u32 m0, s47, 28672
    s_nop 0
    buffer_load_dwordx4 v11, s[16:19], s66 offen lds
    s_waitcnt vmcnt(12)
    s_add_u32 m0, s47, 32768
    s_nop 0
    buffer_load_dwordx4 v4, s[12:15], s77 offen lds
    s_waitcnt vmcnt(12)
    s_add_u32 m0, s47, 49152
    s_nop 0
    buffer_load_dwordx4 v8, s[16:19], s67 offen lds
    s_waitcnt vmcnt(12)
    s_add_u32 m0, s47, 36864
    s_nop 0
    buffer_load_dwordx4 v5, s[12:15], s77 offen lds
    s_waitcnt vmcnt(12)
    s_add_u32 m0, s47, 53248
    s_nop 0
    buffer_load_dwordx4 v9, s[16:19], s67 offen lds
    s_waitcnt vmcnt(12)
    s_barrier
    s_add_u32 m0, s47, 40960
    s_nop 0
    buffer_load_dwordx4 v6, s[12:15], s77 offen lds
    s_waitcnt vmcnt(12)
    s_add_u32 m0, s47, 57344
    s_nop 0
    buffer_load_dwordx4 v10, s[16:19], s67 offen lds
    s_waitcnt vmcnt(12)
    s_add_u32 m0, s47, 45056
    s_nop 0
    buffer_load_dwordx4 v7, s[12:15], s77 offen lds
    s_waitcnt vmcnt(12)
    s_add_u32 m0, s47, 61440
    s_nop 0
    buffer_load_dwordx4 v11, s[16:19], s67 offen lds
    s_waitcnt vmcnt(12)
    s_add_u32 m0, s47, 65536
    s_nop 0
    buffer_load_dwordx4 v4, s[12:15], s78 offen lds
    s_waitcnt vmcnt(12)
    s_add_u32 m0, s47, 81920
    s_nop 0
    buffer_load_dwordx4 v8, s[16:19], s68 offen lds
    s_waitcnt vmcnt(12)
    s_add_u32 m0, s47, 69632
    s_nop 0
    buffer_load_dwordx4 v5, s[12:15], s78 offen lds
    s_waitcnt vmcnt(12)
    s_add_u32 m0, s47, 86016
    s_nop 0
    buffer_load_dwordx4 v9, s[16:19], s68 offen lds
    s_waitcnt vmcnt(12)
    s_barrier
    s_add_u32 m0, s47, 73728
    s_nop 0
    buffer_load_dwordx4 v6, s[12:15], s78 offen lds
    s_waitcnt vmcnt(12)
    s_add_u32 m0, s47, 90112
    s_nop 0
    buffer_load_dwordx4 v10, s[16:19], s68 offen lds
    s_waitcnt vmcnt(12)
    s_add_u32 m0, s47, 77824
    s_nop 0
    buffer_load_dwordx4 v7, s[12:15], s78 offen lds
    s_waitcnt vmcnt(12)
    s_add_u32 m0, s47, 94208
    s_nop 0
    buffer_load_dwordx4 v11, s[16:19], s68 offen lds
    s_waitcnt vmcnt(12)
    s_add_u32 m0, s47, 147456
    s_nop 0
    buffer_load_dwordx4 v12, s[28:31], s48 offen lds
    buffer_load_dword v19, v26, s[80:83], 0 offen sc1
    s_waitcnt vmcnt(13)
    s_add_u32 m0, s47, 151552
    s_nop 0
    buffer_load_dwordx4 v13, s[28:31], s48 offen lds
    s_waitcnt vmcnt(13)
    s_add_u32 m0, s47, 155648
    s_nop 0
    buffer_load_dwordx4 v12, s[28:31], s49 offen lds
    s_waitcnt vmcnt(13)
    s_add_u32 m0, s47, 159744
    s_nop 0
    buffer_load_dwordx4 v13, s[28:31], s49 offen lds
    s_waitcnt vmcnt(13)
    s_barrier
    s_add_u32 m0, s47, 131072
    s_nop 0
    buffer_load_dwordx4 v14, s[28:31], s48 offen lds
    s_waitcnt vmcnt(13)
    s_add_u32 m0, s47, 135168
    s_nop 0
    buffer_load_dwordx4 v15, s[28:31], s48 offen lds
    s_waitcnt vmcnt(13)
    s_add_u32 m0, s47, 139264
    s_nop 0
    buffer_load_dwordx4 v14, s[28:31], s49 offen lds
    s_waitcnt vmcnt(13)
    s_add_u32 m0, s47, 143360
    s_nop 0
    buffer_load_dwordx4 v15, s[28:31], s49 offen lds
    s_waitcnt vmcnt(13)
    s_add_u32 m0, s47, 98304
    s_nop 0
    buffer_load_dwordx4 v4, s[12:15], s79 offen lds
    s_waitcnt vmcnt(13)
    s_add_u32 m0, s47, 114688
    s_nop 0
    buffer_load_dwordx4 v8, s[16:19], s69 offen lds
    s_waitcnt vmcnt(13)
    s_add_u32 m0, s47, 102400
    s_nop 0
    buffer_load_dwordx4 v5, s[12:15], s79 offen lds
    s_waitcnt vmcnt(13)
    s_add_u32 m0, s47, 118784
    s_nop 0
    buffer_load_dwordx4 v9, s[16:19], s69 offen lds
    s_waitcnt vmcnt(13)
    s_barrier
    s_add_u32 m0, s47, 106496
    s_nop 0
    buffer_load_dwordx4 v6, s[12:15], s79 offen lds
    s_waitcnt vmcnt(13)
    s_add_u32 m0, s47, 122880
    s_nop 0
    buffer_load_dwordx4 v10, s[16:19], s69 offen lds
    s_waitcnt vmcnt(12)
    s_add_u32 m0, s47, 110592
    s_nop 0
    buffer_load_dwordx4 v7, s[12:15], s79 offen lds
    s_waitcnt vmcnt(12)
    s_add_u32 m0, s47, 126976
    s_nop 0
    buffer_load_dwordx4 v11, s[16:19], s69 offen lds
    s_waitcnt vmcnt(12)
    s_add_u32 m0, s47, 0
    s_nop 0
    buffer_load_dwordx4 v12, s[28:31], s50 offen lds
    s_waitcnt vmcnt(12)
    s_add_u32 m0, s47, 4096
    s_nop 0
    buffer_load_dwordx4 v13, s[28:31], s50 offen lds
    s_waitcnt vmcnt(12)
    s_add_u32 m0, s47, 8192
    s_nop 0
    buffer_load_dwordx4 v12, s[28:31], s51 offen lds
    s_waitcnt vmcnt(12)
    s_add_u32 m0, s47, 12288
    s_nop 0
    buffer_load_dwordx4 v13, s[28:31], s51 offen lds
    s_waitcnt vmcnt(12)
    s_add_u32 m0, s47, 16384
    s_nop 0
    buffer_load_dwordx4 v12, s[28:31], s52 offen lds
    s_waitcnt vmcnt(12)
    s_add_u32 m0, s47, 20480
    s_nop 0
    buffer_load_dwordx4 v13, s[28:31], s52 offen lds
    s_waitcnt vmcnt(12)
    s_add_u32 m0, s47, 24576
    s_nop 0
    buffer_load_dwordx4 v12, s[28:31], s53 offen lds
    s_waitcnt vmcnt(12)
    s_add_u32 m0, s47, 28672
    s_nop 0
    buffer_load_dwordx4 v13, s[28:31], s53 offen lds
    s_waitcnt vmcnt(12)
    s_add_u32 m0, s47, 32768
    s_nop 0
    buffer_load_dwordx4 v12, s[28:31], s54 offen lds
    s_waitcnt vmcnt(12)
    s_add_u32 m0, s47, 36864
    s_nop 0
    buffer_load_dwordx4 v13, s[28:31], s54 offen lds
    s_waitcnt vmcnt(12)
    s_add_u32 m0, s47, 40960
    s_nop 0
    buffer_load_dwordx4 v12, s[28:31], s55 offen lds
    s_waitcnt vmcnt(12)
    s_add_u32 m0, s47, 45056
    s_nop 0
    buffer_load_dwordx4 v13, s[28:31], s55 offen lds
    s_waitcnt vmcnt(12)
    s_barrier
    s_add_u32 m0, s47, 49152
    s_nop 0
    buffer_load_dwordx4 v12, s[28:31], s56 offen lds
    s_waitcnt vmcnt(12)
    s_add_u32 m0, s47, 53248
    s_nop 0
    buffer_load_dwordx4 v13, s[28:31], s56 offen lds
    s_waitcnt vmcnt(12)
    s_add_u32 m0, s47, 57344
    s_nop 0
    buffer_load_dwordx4 v12, s[28:31], s57 offen lds
    s_waitcnt vmcnt(12)
    s_add_u32 m0, s47, 61440
    s_nop 0
    buffer_load_dwordx4 v13, s[28:31], s57 offen lds
    s_waitcnt vmcnt(12)
    s_add_u32 m0, s47, 65536
    s_nop 0
    buffer_load_dwordx4 v14, s[28:31], s50 offen lds
    s_waitcnt vmcnt(12)
    s_add_u32 m0, s47, 69632
    s_nop 0
    buffer_load_dwordx4 v15, s[28:31], s50 offen lds
    s_waitcnt vmcnt(12)
    s_add_u32 m0, s47, 73728
    s_nop 0
    buffer_load_dwordx4 v14, s[28:31], s51 offen lds
    s_waitcnt vmcnt(12)
    s_add_u32 m0, s47, 77824
    s_nop 0
    buffer_load_dwordx4 v15, s[28:31], s51 offen lds
    s_waitcnt vmcnt(12)
    s_add_u32 m0, s47, 81920
    s_nop 0
    buffer_load_dwordx4 v14, s[28:31], s52 offen lds
    s_waitcnt vmcnt(12)
    s_add_u32 m0, s47, 86016
    s_nop 0
    buffer_load_dwordx4 v15, s[28:31], s52 offen lds
    s_waitcnt vmcnt(12)
    s_waitcnt vmcnt(6)
    v_readfirstlane_b32 s3, v19
    s_or_b32 s3, s3, s38
    s_cbranch_scc1 PA_FOK
    s_mov_b32 s46, 0
PA_FP:
    buffer_load_dword v19, v26, s[80:83], 0 offen sc1
    s_add_u32 s46, s46, 1
    s_waitcnt vmcnt(0)
    v_readfirstlane_b32 s3, v19
    s_cmp_lg_u32 s3, 0
    s_cbranch_scc1 PA_FP_OK
    s_sleep 8
    s_cmp_lt_u32 s46, 0x20000
    s_cbranch_scc1 PA_FP
PA_FP_OK:
PA_FOK:
    s_barrier
    s_add_u32 m0, s47, 90112
    s_nop 0
    buffer_load_dwordx4 v14, s[28:31], s53 offen lds
    s_add_u32 m0, s47, 94208
    s_nop 0
    buffer_load_dwordx4 v15, s[28:31], s53 offen lds
    s_add_u32 m0, s47, 98304
    s_nop 0
    buffer_load_dwordx4 v14, s[28:31], s54 offen lds
    s_add_u32 m0, s47, 102400
    s_nop 0
    buffer_load_dwordx4 v15, s[28:31], s54 offen lds
    s_add_u32 m0, s47, 106496
    s_nop 0
    buffer_load_dwordx4 v14, s[28:31], s55 offen lds
    s_add_u32 m0, s47, 110592
    s_nop 0
    buffer_load_dwordx4 v15, s[28:31], s55 offen lds
    s_add_u32 m0, s47, 114688
    s_nop 0
    buffer_load_dwordx4 v14, s[28:31], s56 offen lds
    s_waitcnt vmcnt(12)
    s_branch PADX_1
PAD_1:
    s_branch PAD_5
PADX_1:
    s_add_u32 m0, s47, 118784
    s_nop 0
    buffer_load_dwordx4 v15, s[28:31], s56 offen lds
    s_waitcnt vmcnt(12)
    s_add_u32 m0, s47, 122880
    s_nop 0
    buffer_load_dwordx4 v14, s[28:31], s57 offen lds
    s_waitcnt vmcnt(12)
    s_add_u32 m0, s47, 126976
    s_nop 0
    buffer_load_dwordx4 v15, s[28:31], s57 offen lds
    s_branch H_POST
PA_COMP:
    s_setprio 2
    v_and_b32 v2, 31, v1
    v_lshrrev_b32 v0, 5, v1
    v_bfe_u32 v3, v2, 1, 3
    v_xor_b32 v3, v3, v0
    v_lshlrev_b32 v3, 4, v3
    v_lshl_add_u32 v3, v2, 7, v3
    s_lshl_b32 s3, s38, 12
    v_add_u32 v12, s3, v3
    v_bfe_u32 v3, v1, 2, 2
    v_lshl_add_u32 v3, v0, 3, v3
    v_bfe_u32 v13, v1, 4, 1
    v_bfe_u32 v14, v1, 1, 1
    v_lshl_add_u32 v13, v13, 1, v14
    v_bfe_u32 v14, v1, 3, 1
    v_lshl_add_u32 v13, v14, 2, v13
    v_lshlrev_b32 v13, 4, v13
    v_lshl_add_u32 v3, v3, 7, v13
    v_and_b32 v13, 1, v1
    v_lshl_add_u32 v4, v13, 3, v3
    v_xor_b32 v5, 64, v4
    v_add_u32 v6, 0x10000, v4
    v_add_u32 v8, 0x18000, v4
    v_add_u32 v7, 0x10000, v5
    v_add_u32 v9, 0x18000, v5
    s_lshl_b32 s26, s24, 2
    s_add_u32 s26, s26, s38
    s_lshr_b32 s27, s26, 3
    s_mul_i32 s27, s27, 21504
    s_add_u32 s27, s27, 4194304
    s_and_b32 s32, s26, 7
    s_lshr_b32 s3, s26, 1
    s_mul_i32 s3, s3, 27
    s_add_u32 s76, s3, s34
    s_add_u32 s77, s3, s35
    s_and_b32 s3, s26, 1
    s_lshl_b32 s3, s3, 11
    s_lshl_b32 s76, s76, 13
    s_lshl_b32 s77, s77, 13
    s_add_u32 s76, s76, s3
    s_add_u32 s77, s77, s3
    s_mov_b32 s79, s25
    s_mov_b32 s78, s26
    s_waitcnt lgkmcnt(0)
    s_mov_b32 s20, s8
    s_and_b32 s21, s9, 0xffff
    s_mov_b32 s22, 9699328
    s_mov_b32 s23, 0x00020000
    s_add_u32 s28, s8, 12582912
    s_addc_u32 s29, s9, 0
    s_and_b32 s29, s29, 0xffff
    s_mov_b32 s30, 7077888
    s_mov_b32 s31, 0x00020000
    s_mov_b32 s24, s28
    s_mov_b32 s25, s29
    s_mov_b32 s26, 7077888
    s_or_b32 s3, s2, s38
    s_cbranch_scc1 PA_NZ
    s_add_u32 s44, s8, 41943040
    s_addc_u32 s45, s9, 0
    s_and_b32 s45, s45, 0xffff
    s_mov_b32 s46, 139264
    s_mov_b32 s47, 0x00020000
    s_mov_b32 s80, s80
    s_and_b32 s81, s81, 0xffff
    s_mov_b32 s82, 256
    s_mov_b32 s83, 0x00020000
    v_lshlrev_b32 v13, 8, v1
    v_mov_b32 v14, 0
    s_mov_b32 s3, 0
    buffer_store_dword v14, v13, s[44:47], s3 offen sc1
    s_mov_b32 s3, 16384
    buffer_store_dword v14, v13, s[44:47], s3 offen sc1
    s_mov_b32 s3, 32768
    buffer_store_dword v14, v13, s[44:47], s3 offen sc1
    s_mov_b32 s3, 49152
    buffer_store_dword v14, v13, s[44:47], s3 offen sc1
    s_mov_b32 s3, 65536
    buffer_store_dword v14, v13, s[44:47], s3 offen sc1
    s_mov_b32 s3, 81920
    buffer_store_dword v14, v13, s[44:47], s3 offen sc1
    s_mov_b32 s3, 98304
    buffer_store_dword v14, v13, s[44:47], s3 offen sc1
    s_mov_b32 s3, 114688
    buffer_store_dword v14, v13, s[44:47], s3 offen sc1
    s_mov_b32 s3, 131072
    buffer_store_dword v14, v13, s[44:47], s3 offen sc1
    v_mov_b32 v13, 1
    s_waitcnt vmcnt(0)
    s_mov_b64 exec, 1
    buffer_store_dword v13, v14, s[80:83], 0 offen sc1
    s_mov_b64 exec, -1
PA_NZ:
    s_add_u32 s12, s8, 41943040
    s_addc_u32 s13, s9, 0
    s_and_b32 s13, s13, 0xffff
    s_mov_b32 s14, 139264
    s_mov_b32 s15, 0x00020000
    s_mul_i32 s3, s79, 205
    s_lshr_b32 s3, s3, 10
    s_cmp_eq_u32 s3, 0
    s_cselect_b32 s81, 0x10000, 1
    s_mul_i32 s3, s3, 5
    s_sub_u32 s3, s79, s3
    s_movk_i32 s82, 0x7f
    s_cmp_eq_u32 s3, 2
    s_cselect_b32 s82, 0xff, s82
    s_mov_b32 s83, 0
    s_mul_i32 s16, s3, 6560
    s_lshr_b32 s16, s16, 10
    s_lshl_b32 s80, s16, 11
    s_lshr_b32 s3, s78, 3
    s_lshl_b32 s3, s3, 8
    s_add_u32 s80, s80, s3
    s_add_u32 s80, s80, 73728
    s_cmp_ge_u32 s79, 10
    s_cbranch_scc1 PA_V
    s_lshl_b32 s34, s32, 10
    s_add_u32 s34, s34, s27
    s_mul_i32 s35, s32, 1664
    s_add_u32 s35, s35, s27
    s_add_u32 s35, s35, 9472
    s_mul_i32 s36, s78, 1280
    s_add_u32 s37, s36, 1024
    s_sub_u32 s3, s79, 5
    s_mov_b32 s39, 172032
    s_cmp_lt_u32 s79, 5
    s_cselect_b32 s3, s79, s3
    s_cselect_b32 s78, 1051011932, 1.0
    s_cselect_b32 s39, 81920, s39
    s_cselect_b32 s34, s36, s34
    s_cselect_b32 s35, s37, s35
    s_mov_b32 s27, 0x00020000
    s_lshl_b32 s3, s3, 5
    v_add_u32 v3, s3, v2
    v_mul_u32_u24 v13, 205, v3
    v_lshrrev_b32 v13, 10, v13
    v_mul_u32_u24 v14, 5, v13
    v_sub_u32 v3, v3, v14
    v_cmp_eq_u32 vcc, 4, v3
    v_lshl_add_u32 v3, v3, 8, s34
    v_mov_b32 v14, s35
    v_mul_lo_u32 v13, v13, s39
    v_cndmask_b32 v3, v3, v14, vcc
    v_add_u32 v3, v3, v13
    v_lshlrev_b32 v15, 3, v2
    v_lshlrev_b32 v1, 4, v1
    v_readlane_b32 s44, v3, 0
    v_readlane_b32 s60, v3, 1
    v_readlane_b32 s45, v3, 2
    v_readlane_b32 s61, v3, 3
    v_readlane_b32 s46, v3, 4
    v_readlane_b32 s62, v3, 5
    v_readlane_b32 s47, v3, 6
    v_readlane_b32 s63, v3, 7
    v_readlane_b32 s48, v3, 8
    v_readlane_b32 s64, v3, 9
    v_readlane_b32 s49, v3, 10
    v_readlane_b32 s65, v3, 11
    v_readlane_b32 s50, v3, 12
    v_readlane_b32 s66, v3, 13
    v_readlane_b32 s51, v3, 14
    v_readlane_b32 s67, v3, 15
    v_readlane_b32 s52, v3, 16
    v_readlane_b32 s68, v3, 17
    v_readlane_b32 s53, v3, 18
    v_readlane_b32 s69, v3, 19
    v_readlane_b32 s54, v3, 20
    v_readlane_b32 s70, v3, 21
    v_readlane_b32 s55, v3, 22
    v_readlane_b32 s71, v3, 23
    v_readlane_b32 s56, v3, 24
    v_readlane_b32 s72, v3, 25
    v_readlane_b32 s57, v3, 26
    v_readlane_b32 s73, v3, 27
    v_readlane_b32 s58, v3, 28
    v_readlane_b32 s74, v3, 29
    v_readlane_b32 s59, v3, 30
    v_readlane_b32 s75, v3, 31
    s_sub_u32 s60, s60, s44
    s_sub_u32 s61, s61, s45
    s_sub_u32 s62, s62, s46
    s_sub_u32 s63, s63, s47
    s_sub_u32 s64, s64, s48
    s_sub_u32 s65, s65, s49
    s_sub_u32 s66, s66, s50
    s_sub_u32 s67, s67, s51
    s_sub_u32 s68, s68, s52
    s_sub_u32 s69, s69, s53
    s_sub_u32 s70, s70, s54
    s_sub_u32 s71, s71, s55
    s_sub_u32 s72, s72, s56
    s_sub_u32 s73, s73, s57
    s_sub_u32 s74, s74, s58
    s_sub_u32 s75, s75, s59
    s_barrier
    v_xor_b32 v13, 65536, v12
    ds_read_b128 v[96:99], v13
    ds_read_b64_tr_b16 v[16:17], v6 offset:16384
    ds_read_b64_tr_b16 v[18:19], v6 offset:16896
    ds_read_b64_tr_b16 v[20:21], v7 offset:16384
    ds_read_b64_tr_b16 v[22:23], v7 offset:16896
    ds_read_b64_tr_b16 v[24:25], v6 offset:20480
    ds_read_b64_tr_b16 v[26:27], v6 offset:20992
    ds_read_b64_tr_b16 v[28:29], v7 offset:20480
    ds_read_b64_tr_b16 v[30:31], v7 offset:20992
    s_waitcnt lgkmcnt(6)
    v_mfma_f32_32x32x16_bf16 v[32:47], v[16:19], v[96:99], 0
    s_waitcnt lgkmcnt(4)
    v_xor_b32 v14, 65568, v12
    ds_read_b128 v[100:103], v14
    ds_read_b64_tr_b16 v[16:17], v6 offset:18432
    ds_read_b64_tr_b16 v[18:19], v6 offset:18944
    v_mfma_f32_32x32x16_bf16 v[48:63], v[20:23], v[96:99], 0
    s_waitcnt lgkmcnt(5)
    ds_read_b64_tr_b16 v[20:21], v7 offset:18432
    ds_read_b64_tr_b16 v[22:23], v7 offset:18944
    v_mfma_f32_32x32x16_bf16 v[64:79], v[24:27], v[96:99], 0
    s_waitcnt lgkmcnt(5)
    ds_read_b64_tr_b16 v[24:25], v6 offset:22528
    ds_read_b64_tr_b16 v[26:27], v6 offset:23040
    v_mfma_f32_32x32x16_bf16 v[80:95], v[28:31], v[96:99], 0
    s_waitcnt lgkmcnt(4)
    ds_read_b64_tr_b16 v[28:29], v7 offset:22528
    ds_read_b64_tr_b16 v[30:31], v7 offset:23040
    v_mfma_f32_32x32x16_bf16 v[32:47], v[16:19], v[100:103], v[32:47]
    s_waitcnt lgkmcnt(4)
    v_xor_b32 v13, 65600, v12
    ds_read_b128 v[104:107], v13
    ds_read_b64_tr_b16 v[16:17], v6 offset:24576
    ds_read_b64_tr_b16 v[18:19], v6 offset:25088
    v_mfma_f32_32x32x16_bf16 v[48:63], v[20:23], v[100:103], v[48:63]
    s_waitcnt lgkmcnt(5)
    ds_read_b64_tr_b16 v[20:21], v7 offset:24576
    ds_read_b64_tr_b16 v[22:23], v7 offset:25088
    v_mfma_f32_32x32x16_bf16 v[64:79], v[24:27], v[100:103], v[64:79]
    s_waitcnt lgkmcnt(5)
    ds_read_b64_tr_b16 v[24:25], v6 offset:28672
    ds_read_b64_tr_b16 v[26:27], v6 offset:29184
    v_mfma_f32_32x32x16_bf16 v[80:95], v[28:31], v[100:103], v[80:95]
    s_waitcnt lgkmcnt(4)
    ds_read_b64_tr_b16 v[28:29], v7 offset:28672
    ds_read_b64_tr_b16 v[30:31], v7 offset:29184
    v_mfma_f32_32x32x16_bf16 v[32:47], v[16:19], v[104:107], v[32:47]
    s_waitcnt lgkmcnt(4)
    v_xor_b32 v14, 65632, v12
    ds_read_b128 v[108:111], v14
    ds_read_b64_tr_b16 v[16:17], v6 offset:26624
    ds_read_b64_tr_b16 v[18:19], v6 offset:27136
    v_mfma_f32_32x32x16_bf16 v[48:63], v[20:23], v[104:107], v[48:63]
    s_waitcnt lgkmcnt(5)
    ds_read_b64_tr_b16 v[20:21], v7 offset:26624
    ds_read_b64_tr_b16 v[22:23], v7 offset:27136
    v_mfma_f32_32x32x16_bf16 v[64:79], v[24:27], v[104:107], v[64:79]
    s_waitcnt lgkmcnt(5)
    ds_read_b64_tr_b16 v[24:25], v6 offset:30720
    ds_read_b64_tr_b16 v[26:27], v6 offset:31232
    v_mfma_f32_32x32x16_bf16 v[80:95], v[28:31], v[104:107], v[80:95]
    s_waitcnt lgkmcnt(4)
    ds_read_b64_tr_b16 v[28:29], v7 offset:30720
    ds_read_b64_tr_b16 v[30:31], v7 offset:31232
    v_mfma_f32_32x32x16_bf16 v[32:47], v[16:19], v[108:111], v[32:47]
    s_barrier
    s_waitcnt vmcnt(0)
    v_xor_b32 v13, 98304, v12
    ds_read_b128 v[112:115], v13
    ds_read_b64_tr_b16 v[16:17], v8 offset:16384
    ds_read_b64_tr_b16 v[18:19], v8 offset:16896
    s_waitcnt lgkmcnt(7)
    v_mfma_f32_32x32x16_bf16 v[48:63], v[20:23], v[108:111], v[48:63]
    s_waitcnt lgkmcnt(5)
    ds_read_b64_tr_b16 v[20:21], v9 offset:16384
    ds_read_b64_tr_b16 v[22:23], v9 offset:16896
    v_mfma_f32_32x32x16_bf16 v[64:79], v[24:27], v[108:111], v[64:79]
    s_waitcnt lgkmcnt(5)
    ds_read_b64_tr_b16 v[24:25], v8 offset:20480
    ds_read_b64_tr_b16 v[26:27], v8 offset:20992
    v_mfma_f32_32x32x16_bf16 v[80:95], v[28:31], v[108:111], v[80:95]
    s_waitcnt lgkmcnt(4)
    ds_read_b64_tr_b16 v[28:29], v9 offset:20480
    ds_read_b64_tr_b16 v[30:31], v9 offset:20992
    v_mfma_f32_32x32x16_bf16 v[32:47], v[16:19], v[112:115], v[32:47]
    s_waitcnt lgkmcnt(4)
    v_xor_b32 v14, 98336, v12
    ds_read_b128 v[116:119], v14
    ds_read_b64_tr_b16 v[16:17], v8 offset:18432
    ds_read_b64_tr_b16 v[18:19], v8 offset:18944
    v_mfma_f32_32x32x16_bf16 v[48:63], v[20:23], v[112:115], v[48:63]
    s_waitcnt lgkmcnt(5)
    ds_read_b64_tr_b16 v[20:21], v9 offset:18432
    ds_read_b64_tr_b16 v[22:23], v9 offset:18944
    v_mfma_f32_32x32x16_bf16 v[64:79], v[24:27], v[112:115], v[64:79]
    s_waitcnt lgkmcnt(5)
    ds_read_b64_tr_b16 v[24:25], v8 offset:22528
    ds_read_b64_tr_b16 v[26:27], v8 offset:23040
    v_mfma_f32_32x32x16_bf16 v[80:95], v[28:31], v[112:115], v[80:95]
    s_waitcnt lgkmcnt(4)
    ds_read_b64_tr_b16 v[28:29], v9 offset:22528
    ds_read_b64_tr_b16 v[30:31], v9 offset:23040
    v_mfma_f32_32x32x16_bf16 v[32:47], v[16:19], v[116:119], v[32:47]
    s_waitcnt lgkmcnt(4)
    v_xor_b32 v13, 98368, v12
    ds_read_b128 v[120:123], v13
    ds_read_b64_tr_b16 v[16:17], v8 offset:24576
    ds_read_b64_tr_b16 v[18:19], v8 offset:25088
    v_mfma_f32_32x32x16_bf16 v[48:63], v[20:23], v[116:119], v[48:63]
    s_waitcnt lgkmcnt(5)
    ds_read_b64_tr_b16 v[20:21], v9 offset:24576
    ds_read_b64_tr_b16 v[22:23], v9 offset:25088
    v_mfma_f32_32x32x16_bf16 v[64:79], v[24:27], v[116:119], v[64:79]
    s_waitcnt lgkmcnt(5)
    ds_read_b64_tr_b16 v[24:25], v8 offset:28672
    ds_read_b64_tr_b16 v[26:27], v8 offset:29184
    v_mfma_f32_32x32x16_bf16 v[80:95], v[28:31], v[116:119], v[80:95]
    s_waitcnt lgkmcnt(4)
    ds_read_b64_tr_b16 v[28:29], v9 offset:28672
    ds_read_b64_tr_b16 v[30:31], v9 offset:29184
    v_mfma_f32_32x32x16_bf16 v[32:47], v[16:19], v[120:123], v[32:47]
    s_waitcnt lgkmcnt(4)
    v_xor_b32 v14, 98400, v12
    ds_read_b128 v[124:127], v14
    ds_read_b64_tr_b16 v[16:17], v8 offset:26624
    ds_read_b64_tr_b16 v[18:19], v8 offset:27136
    v_mfma_f32_32x32x16_bf16 v[48:63], v[20:23], v[120:123], v[48:63]
    s_waitcnt lgkmcnt(5)
    ds_read_b64_tr_b16 v[20:21], v9 offset:26624
    ds_read_b64_tr_b16 v[22:23], v9 offset:27136
    v_mfma_f32_32x32x16_bf16 v[64:79], v[24:27], v[120:123], v[64:79]
    s_waitcnt lgkmcnt(5)
    ds_read_b64_tr_b16 v[24:25], v8 offset:30720
    ds_read_b64_tr_b16 v[26:27], v8 offset:31232
    v_mfma_f32_32x32x16_bf16 v[80:95], v[28:31], v[120:123], v[80:95]
    s_waitcnt lgkmcnt(4)
    ds_read_b64_tr_b16 v[28:29], v9 offset:30720
    ds_read_b64_tr_b16 v[30:31], v9 offset:31232
    v_mfma_f32_32x32x16_bf16 v[32:47], v[16:19], v[124:127], v[32:47]
    s_barrier
    v_xor_b32 v13, 0, v12
    ds_read_b128 v[128:131], v13
    ds_read_b64_tr_b16 v[16:17], v4 offset:16384
    ds_read_b64_tr_b16 v[18:19], v4 offset:16896
    s_waitcnt lgkmcnt(7)
    v_mfma_f32_32x32x16_bf16 v[48:63], v[20:23], v[124:127], v[48:63]
    s_waitcnt lgkmcnt(5)
    ds_read_b64_tr_b16 v[20:21], v5 offset:16384
    ds_read_b64_tr_b16 v[22:23], v5 offset:16896
    v_mfma_f32_32x32x16_bf16 v[64:79], v[24:27], v[124:127], v[64:79]
    s_waitcnt lgkmcnt(5)
    ds_read_b64_tr_b16 v[24:25], v4 offset:20480
    ds_read_b64_tr_b16 v[26:27], v4 offset:20992
    v_mfma_f32_32x32x16_bf16 v[80:95], v[28:31], v[124:127], v[80:95]
    s_waitcnt lgkmcnt(4)
    ds_read_b64_tr_b16 v[28:29], v5 offset:20480
    ds_read_b64_tr_b16 v[30:31], v5 offset:20992
    v_mfma_f32_32x32x16_bf16 v[32:47], v[16:19], v[128:131], v[32:47]
    s_waitcnt lgkmcnt(4)
    v_xor_b32 v14, 32, v12
    ds_read_b128 v[132:135], v14
    ds_read_b64_tr_b16 v[16:17], v4 offset:18432
    ds_read_b64_tr_b16 v[18:19], v4 offset:18944
    v_mfma_f32_32x32x16_bf16 v[48:63], v[20:23], v[128:131], v[48:63]
    s_waitcnt lgkmcnt(5)
    ds_read_b64_tr_b16 v[20:21], v5 offset:18432
    ds_read_b64_tr_b16 v[22:23], v5 offset:18944
    v_mfma_f32_32x32x16_bf16 v[64:79], v[24:27], v[128:131], v[64:79]
    s_waitcnt lgkmcnt(5)
    ds_read_b64_tr_b16 v[24:25], v4 offset:22528
    ds_read_b64_tr_b16 v[26:27], v4 offset:23040
    v_mfma_f32_32x32x16_bf16 v[80:95], v[28:31], v[128:131], v[80:95]
    s_waitcnt lgkmcnt(4)
    ds_read_b64_tr_b16 v[28:29], v5 offset:22528
    ds_read_b64_tr_b16 v[30:31], v5 offset:23040
    v_mfma_f32_32x32x16_bf16 v[32:47], v[16:19], v[132:135], v[32:47]
    s_waitcnt lgkmcnt(4)
    v_xor_b32 v13, 64, v12
    ds_read_b128 v[136:139], v13
    ds_read_b64_tr_b16 v[16:17], v4 offset:24576
    ds_read_b64_tr_b16 v[18:19], v4 offset:25088
    v_mfma_f32_32x32x16_bf16 v[48:63], v[20:23], v[132:135], v[48:63]
    s_waitcnt lgkmcnt(5)
    ds_read_b64_tr_b16 v[20:21], v5 offset:24576
    ds_read_b64_tr_b16 v[22:23], v5 offset:25088
    v_mfma_f32_32x32x16_bf16 v[64:79], v[24:27], v[132:135], v[64:79]
    s_waitcnt lgkmcnt(5)
    ds_read_b64_tr_b16 v[24:25], v4 offset:28672
    ds_read_b64_tr_b16 v[26:27], v4 offset:29184
    v_mfma_f32_32x32x16_bf16 v[80:95], v[28:31], v[132:135], v[80:95]
    s_waitcnt lgkmcnt(4)
    ds_read_b64_tr_b16 v[28:29], v5 offset:28672
    ds_read_b64_tr_b16 v[30:31], v5 offset:29184
    v_mfma_f32_32x32x16_bf16 v[32:47], v[16:19], v[136:139], v[32:47]
    s_waitcnt lgkmcnt(4)
    v_xor_b32 v14, 96, v12
    ds_read_b128 v[140:143], v14
    ds_read_b64_tr_b16 v[16:17], v4 offset:26624
    ds_read_b64_tr_b16 v[18:19], v4 offset:27136
    v_mfma_f32_32x32x16_bf16 v[48:63], v[20:23], v[136:139], v[48:63]
    s_waitcnt lgkmcnt(5)
    ds_read_b64_tr_b16 v[20:21], v5 offset:26624
    ds_read_b64_tr_b16 v[22:23], v5 offset:27136
    v_mfma_f32_32x32x16_bf16 v[64:79], v[24:27], v[136:139], v[64:79]
    s_waitcnt lgkmcnt(5)
    ds_read_b64_tr_b16 v[24:25], v4 offset:30720
    ds_read_b64_tr_b16 v[26:27], v4 offset:31232
    v_mfma_f32_32x32x16_bf16 v[80:95], v[28:31], v[136:139], v[80:95]
    s_waitcnt lgkmcnt(4)
    ds_read_b64_tr_b16 v[28:29], v5 offset:30720
    ds_read_b64_tr_b16 v[30:31], v5 offset:31232
    v_mfma_f32_32x32x16_bf16 v[32:47], v[16:19], v[140:143], v[32:47]
    s_barrier
    v_xor_b32 v13, 32768, v12
    ds_read_b128 v[144:147], v13
    ds_read_b64_tr_b16 v[16:17], v4 offset:49152
    ds_read_b64_tr_b16 v[18:19], v4 offset:49664
    s_waitcnt lgkmcnt(7)
    v_mfma_f32_32x32x16_bf16 v[48:63], v[20:23], v[140:143], v[48:63]
    s_waitcnt lgkmcnt(5)
    ds_read_b64_tr_b16 v[20:21], v5 offset:49152
    ds_read_b64_tr_b16 v[22:23], v5 offset:49664
    v_mfma_f32_32x32x16_bf16 v[64:79], v[24:27], v[140:143], v[64:79]
    s_waitcnt lgkmcnt(5)
    ds_read_b64_tr_b16 v[24:25], v4 offset:53248
    ds_read_b64_tr_b16 v[26:27], v4 offset:53760
    v_mfma_f32_32x32x16_bf16 v[80:95], v[28:31], v[140:143], v[80:95]
    s_waitcnt lgkmcnt(4)
    ds_read_b64_tr_b16 v[28:29], v5 offset:53248
    ds_read_b64_tr_b16 v[30:31], v5 offset:53760
    v_mfma_f32_32x32x16_bf16 v[32:47], v[16:19], v[144:147], v[32:47]
    s_waitcnt lgkmcnt(4)
    v_xor_b32 v14, 32800, v12
    ds_read_b128 v[148:151], v14
    ds_read_b64_tr_b16 v[16:17], v4 offset:51200
    ds_read_b64_tr_b16 v[18:19], v4 offset:51712
    v_mfma_f32_32x32x16_bf16 v[48:63], v[20:23], v[144:147], v[48:63]
    s_waitcnt lgkmcnt(5)
    ds_read_b64_tr_b16 v[20:21], v5 offset:51200
    ds_read_b64_tr_b16 v[22:23], v5 offset:51712
    v_mfma_f32_32x32x16_bf16 v[64:79], v[24:27], v[144:147], v[64:79]
    s_waitcnt lgkmcnt(5)
    ds_read_b64_tr_b16 v[24:25], v4 offset:55296
    ds_read_b64_tr_b16 v[26:27], v4 offset:55808
    v_mfma_f32_32x32x16_bf16 v[80:95], v[28:31], v[144:147], v[80:95]
    s_waitcnt lgkmcnt(4)
    ds_read_b64_tr_b16 v[28:29], v5 offset:55296
    ds_read_b64_tr_b16 v[30:31], v5 offset:55808
    v_mfma_f32_32x32x16_bf16 v[32:47], v[16:19], v[148:151], v[32:47]
    s_waitcnt lgkmcnt(4)
    v_xor_b32 v13, 32832, v12
    ds_read_b128 v[152:155], v13
    ds_read_b64_tr_b16 v[16:17], v4 offset:57344
    ds_read_b64_tr_b16 v[18:19], v4 offset:57856
    v_mfma_f32_32x32x16_bf16 v[48:63], v[20:23], v[148:151], v[48:63]
    s_waitcnt lgkmcnt(5)
    ds_read_b64_tr_b16 v[20:21], v5 offset:57344
    ds_read_b64_tr_b16 v[22:23], v5 offset:57856
    v_mfma_f32_32x32x16_bf16 v[64:79], v[24:27], v[148:151], v[64:79]
    s_waitcnt lgkmcnt(5)
    ds_read_b64_tr_b16 v[24:25], v4 offset:61440
    ds_read_b64_tr_b16 v[26:27], v4 offset:61952
    v_mfma_f32_32x32x16_bf16 v[80:95], v[28:31], v[148:151], v[80:95]
    s_waitcnt lgkmcnt(4)
    ds_read_b64_tr_b16 v[28:29], v5 offset:61440
    ds_read_b64_tr_b16 v[30:31], v5 offset:61952
    v_mfma_f32_32x32x16_bf16 v[32:47], v[16:19], v[152:155], v[32:47]
    s_waitcnt lgkmcnt(4)
    v_xor_b32 v14, 32864, v12
    ds_read_b128 v[156:159], v14
    ds_read_b64_tr_b16 v[16:17], v4 offset:59392
    ds_read_b64_tr_b16 v[18:19], v4 offset:59904
    v_mfma_f32_32x32x16_bf16 v[48:63], v[20:23], v[152:155], v[48:63]
    s_waitcnt lgkmcnt(5)
    ds_read_b64_tr_b16 v[20:21], v5 offset:59392
    ds_read_b64_tr_b16 v[22:23], v5 offset:59904
    v_mfma_f32_32x32x16_bf16 v[64:79], v[24:27], v[152:155], v[64:79]
    s_waitcnt lgkmcnt(5)
    ds_read_b64_tr_b16 v[24:25], v4 offset:63488
    ds_read_b64_tr_b16 v[26:27], v4 offset:64000
    v_mfma_f32_32x32x16_bf16 v[80:95], v[28:31], v[152:155], v[80:95]
    s_waitcnt lgkmcnt(4)
    ds_read_b64_tr_b16 v[28:29], v5 offset:63488
    ds_read_b64_tr_b16 v[30:31], v5 offset:64000
    v_mfma_f32_32x32x16_bf16 v[32:47], v[16:19], v[156:159], v[32:47]
    s_barrier
    v_xor_b32 v13, 65536, v12
    ds_read_b128 v[160:163], v13
    ds_read_b64_tr_b16 v[16:17], v6 offset:16384
    ds_read_b64_tr_b16 v[18:19], v6 offset:16896
    s_waitcnt lgkmcnt(7)
    v_mfma_f32_32x32x16_bf16 v[48:63], v[20:23], v[156:159], v[48:63]
    s_waitcnt lgkmcnt(5)
    ds_read_b64_tr_b16 v[20:21], v7 offset:16384
    ds_read_b64_tr_b16 v[22:23], v7 offset:16896
    v_mfma_f32_32x32x16_bf16 v[64:79], v[24:27], v[156:159], v[64:79]
    s_waitcnt lgkmcnt(5)
    ds_read_b64_tr_b16 v[24:25], v6 offset:20480
    ds_read_b64_tr_b16 v[26:27], v6 offset:20992
    v_mfma_f32_32x32x16_bf16 v[80:95], v[28:31], v[156:159], v[80:95]
    s_waitcnt lgkmcnt(4)
    ds_read_b64_tr_b16 v[28:29], v7 offset:20480
    ds_read_b64_tr_b16 v[30:31], v7 offset:20992
    v_mfma_f32_32x32x16_bf16 v[32:47], v[16:19], v[160:163], v[32:47]
    s_waitcnt lgkmcnt(4)
    v_xor_b32 v14, 65568, v12
    ds_read_b128 v[164:167], v14
    ds_read_b64_tr_b16 v[16:17], v6 offset:18432
    ds_read_b64_tr_b16 v[18:19], v6 offset:18944
    v_mfma_f32_32x32x16_bf16 v[48:63], v[20:23], v[160:163], v[48:63]
    s_waitcnt lgkmcnt(5)
    ds_read_b64_tr_b16 v[20:21], v7 offset:18432
    ds_read_b64_tr_b16 v[22:23], v7 offset:18944
    v_mfma_f32_32x32x16_bf16 v[64:79], v[24:27], v[160:163], v[64:79]
    s_waitcnt lgkmcnt(5)
    ds_read_b64_tr_b16 v[24:25], v6 offset:22528
    ds_read_b64_tr_b16 v[26:27], v6 offset:23040
    v_mfma_f32_32x32x16_bf16 v[80:95], v[28:31], v[160:163], v[80:95]
    s_waitcnt lgkmcnt(4)
    ds_read_b64_tr_b16 v[28:29], v7 offset:22528
    ds_read_b64_tr_b16 v[30:31], v7 offset:23040
    v_mfma_f32_32x32x16_bf16 v[32:47], v[16:19], v[164:167], v[32:47]
    s_waitcnt lgkmcnt(4)
    v_xor_b32 v13, 65600, v12
    ds_read_b128 v[168:171], v13
    ds_read_b64_tr_b16 v[16:17], v6 offset:24576
    ds_read_b64_tr_b16 v[18:19], v6 offset:25088
    v_mfma_f32_32x32x16_bf16 v[48:63], v[20:23], v[164:167], v[48:63]
    s_waitcnt lgkmcnt(5)
    ds_read_b64_tr_b16 v[20:21], v7 offset:24576
    ds_read_b64_tr_b16 v[22:23], v7 offset:25088
    v_mfma_f32_32x32x16_bf16 v[64:79], v[24:27], v[164:167], v[64:79]
    s_waitcnt lgkmcnt(5)
    ds_read_b64_tr_b16 v[24:25], v6 offset:28672
    ds_read_b64_tr_b16 v[26:27], v6 offset:29184
    v_mfma_f32_32x32x16_bf16 v[80:95], v[28:31], v[164:167], v[80:95]
    s_waitcnt lgkmcnt(4)
    ds_read_b64_tr_b16 v[28:29], v7 offset:28672
    ds_read_b64_tr_b16 v[30:31], v7 offset:29184
    v_mfma_f32_32x32x16_bf16 v[32:47], v[16:19], v[168:171], v[32:47]
    s_waitcnt lgkmcnt(4)
    v_xor_b32 v14, 65632, v12
    ds_read_b128 v[172:175], v14
    ds_read_b64_tr_b16 v[16:17], v6 offset:26624
    ds_read_b64_tr_b16 v[18:19], v6 offset:27136
    v_mfma_f32_32x32x16_bf16 v[48:63], v[20:23], v[168:171], v[48:63]
    s_waitcnt lgkmcnt(5)
    ds_read_b64_tr_b16 v[20:21], v7 offset:26624
    ds_read_b64_tr_b16 v[22:23], v7 offset:27136
    v_mfma_f32_32x32x16_bf16 v[64:79], v[24:27], v[168:171], v[64:79]
    s_waitcnt lgkmcnt(5)
    ds_read_b64_tr_b16 v[24:25], v6 offset:30720
    ds_read_b64_tr_b16 v[26:27], v6 offset:31232
    v_mfma_f32_32x32x16_bf16 v[80:95], v[28:31], v[168:171], v[80:95]
    s_waitcnt lgkmcnt(4)
    ds_read_b64_tr_b16 v[28:29], v7 offset:30720
    ds_read_b64_tr_b16 v[30:31], v7 offset:31232
    v_mfma_f32_32x32x16_bf16 v[32:47], v[16:19], v[172:175], v[32:47]
    s_barrier
    v_xor_b32 v13, 98304, v12
    ds_read_b128 v[176:179], v13
    ds_read_b64_tr_b16 v[16:17], v8 offset:16384
    ds_read_b64_tr_b16 v[18:19], v8 offset:16896
    s_waitcnt lgkmcnt(7)
    v_mfma_f32_32x32x16_bf16 v[48:63], v[20:23], v[172:175], v[48:63]
    s_waitcnt lgkmcnt(5)
    ds_read_b64_tr_b16 v[20:21], v9 offset:16384
    ds_read_b64_tr_b16 v[22:23], v9 offset:16896
    v_mfma_f32_32x32x16_bf16 v[64:79], v[24:27], v[172:175], v[64:79]
    s_waitcnt lgkmcnt(5)
    ds_read_b64_tr_b16 v[24:25], v8 offset:20480
    ds_read_b64_tr_b16 v[26:27], v8 offset:20992
    v_mfma_f32_32x32x16_bf16 v[80:95], v[28:31], v[172:175], v[80:95]
    s_waitcnt lgkmcnt(4)
    ds_read_b64_tr_b16 v[28:29], v9 offset:20480
    ds_read_b64_tr_b16 v[30:31], v9 offset:20992
    v_mfma_f32_32x32x16_bf16 v[32:47], v[16:19], v[176:179], v[32:47]
    s_waitcnt lgkmcnt(4)
    v_xor_b32 v14, 98336, v12
    ds_read_b128 v[180:183], v14
    ds_read_b64_tr_b16 v[16:17], v8 offset:18432
    ds_read_b64_tr_b16 v[18:19], v8 offset:18944
    v_mfma_f32_32x32x16_bf16 v[48:63], v[20:23], v[176:179], v[48:63]
    s_waitcnt lgkmcnt(5)
    ds_read_b64_tr_b16 v[20:21], v9 offset:18432
    ds_read_b64_tr_b16 v[22:23], v9 offset:18944
    v_mfma_f32_32x32x16_bf16 v[64:79], v[24:27], v[176:179], v[64:79]
    s_waitcnt lgkmcnt(5)
    ds_read_b64_tr_b16 v[24:25], v8 offset:22528
    ds_read_b64_tr_b16 v[26:27], v8 offset:23040
    v_mfma_f32_32x32x16_bf16 v[80:95], v[28:31], v[176:179], v[80:95]
    s_waitcnt lgkmcnt(4)
    ds_read_b64_tr_b16 v[28:29], v9 offset:22528
    ds_read_b64_tr_b16 v[30:31], v9 offset:23040
    v_mfma_f32_32x32x16_bf16 v[32:47], v[16:19], v[180:183], v[32:47]
    s_waitcnt lgkmcnt(4)
    v_xor_b32 v13, 98368, v12
    ds_read_b128 v[184:187], v13
    ds_read_b64_tr_b16 v[16:17], v8 offset:24576
    ds_read_b64_tr_b16 v[18:19], v8 offset:25088
    s_branch PADX_2
PAD_2:
    s_branch PAD_6
PADX_2:
    v_mfma_f32_32x32x16_bf16 v[48:63], v[20:23], v[180:183], v[48:63]
    s_waitcnt lgkmcnt(5)
    ds_read_b64_tr_b16 v[20:21], v9 offset:24576
    ds_read_b64_tr_b16 v[22:23], v9 offset:25088
    v_mfma_f32_32x32x16_bf16 v[64:79], v[24:27], v[180:183], v[64:79]
    s_waitcnt lgkmcnt(5)
    ds_read_b64_tr_b16 v[24:25], v8 offset:28672
    ds_read_b64_tr_b16 v[26:27], v8 offset:29184
    v_mfma_f32_32x32x16_bf16 v[80:95], v[28:31], v[180:183], v[80:95]
    s_waitcnt lgkmcnt(4)
    ds_read_b64_tr_b16 v[28:29], v9 offset:28672
    ds_read_b64_tr_b16 v[30:31], v9 offset:29184
    v_mfma_f32_32x32x16_bf16 v[32:47], v[16:19], v[184:187], v[32:47]
    s_waitcnt lgkmcnt(4)
    v_xor_b32 v14, 98400, v12
    ds_read_b128 v[188:191], v14
    ds_read_b64_tr_b16 v[16:17], v8 offset:26624
    ds_read_b64_tr_b16 v[18:19], v8 offset:27136
    v_mfma_f32_32x32x16_bf16 v[48:63], v[20:23], v[184:187], v[48:63]
    s_waitcnt lgkmcnt(5)
    ds_read_b64_tr_b16 v[20:21], v9 offset:26624
    ds_read_b64_tr_b16 v[22:23], v9 offset:27136
    v_mfma_f32_32x32x16_bf16 v[64:79], v[24:27], v[184:187], v[64:79]
    s_waitcnt lgkmcnt(5)
    ds_read_b64_tr_b16 v[24:25], v8 offset:30720
    ds_read_b64_tr_b16 v[26:27], v8 offset:31232
    v_mfma_f32_32x32x16_bf16 v[80:95], v[28:31], v[184:187], v[80:95]
    s_waitcnt lgkmcnt(4)
    ds_read_b64_tr_b16 v[28:29], v9 offset:30720
    ds_read_b64_tr_b16 v[30:31], v9 offset:31232
    v_mfma_f32_32x32x16_bf16 v[32:47], v[16:19], v[188:191], v[32:47]
    s_barrier
    v_xor_b32 v13, 0, v12
    ds_read_b128 v[192:195], v13
    ds_read_b64_tr_b16 v[16:17], v4 offset:16384
    ds_read_b64_tr_b16 v[18:19], v4 offset:16896
    s_waitcnt lgkmcnt(7)
    v_mfma_f32_32x32x16_bf16 v[48:63], v[20:23], v[188:191], v[48:63]
    s_waitcnt lgkmcnt(5)
    ds_read_b64_tr_b16 v[20:21], v5 offset:16384
    ds_read_b64_tr_b16 v[22:23], v5 offset:16896
    v_mfma_f32_32x32x16_bf16 v[64:79], v[24:27], v[188:191], v[64:79]
    s_waitcnt lgkmcnt(5)
    ds_read_b64_tr_b16 v[24:25], v4 offset:20480
    ds_read_b64_tr_b16 v[26:27], v4 offset:20992
    v_mfma_f32_32x32x16_bf16 v[80:95], v[28:31], v[188:191], v[80:95]
    s_waitcnt lgkmcnt(4)
    ds_read_b64_tr_b16 v[28:29], v5 offset:20480
    ds_read_b64_tr_b16 v[30:31], v5 offset:20992
    v_mfma_f32_32x32x16_bf16 v[32:47], v[16:19], v[192:195], v[32:47]
    s_waitcnt lgkmcnt(4)
    v_xor_b32 v14, 32, v12
    ds_read_b128 v[196:199], v14
    ds_read_b64_tr_b16 v[16:17], v4 offset:18432
    ds_read_b64_tr_b16 v[18:19], v4 offset:18944
    v_mfma_f32_32x32x16_bf16 v[48:63], v[20:23], v[192:195], v[48:63]
    s_waitcnt lgkmcnt(5)
    ds_read_b64_tr_b16 v[20:21], v5 offset:18432
    ds_read_b64_tr_b16 v[22:23], v5 offset:18944
    v_mfma_f32_32x32x16_bf16 v[64:79], v[24:27], v[192:195], v[64:79]
    s_waitcnt lgkmcnt(5)
    ds_read_b64_tr_b16 v[24:25], v4 offset:22528
    ds_read_b64_tr_b16 v[26:27], v4 offset:23040
    v_mfma_f32_32x32x16_bf16 v[80:95], v[28:31], v[192:195], v[80:95]
    s_waitcnt lgkmcnt(4)
    ds_read_b64_tr_b16 v[28:29], v5 offset:22528
    ds_read_b64_tr_b16 v[30:31], v5 offset:23040
    v_mfma_f32_32x32x16_bf16 v[32:47], v[16:19], v[196:199], v[32:47]
    s_waitcnt lgkmcnt(4)
    v_xor_b32 v13, 64, v12
    ds_read_b128 v[200:203], v13
    ds_read_b64_tr_b16 v[16:17], v4 offset:24576
    ds_read_b64_tr_b16 v[18:19], v4 offset:25088
    v_mfma_f32_32x32x16_bf16 v[48:63], v[20:23], v[196:199], v[48:63]
    s_waitcnt lgkmcnt(5)
    ds_read_b64_tr_b16 v[20:21], v5 offset:24576
    ds_read_b64_tr_b16 v[22:23], v5 offset:25088
    v_mfma_f32_32x32x16_bf16 v[64:79], v[24:27], v[196:199], v[64:79]
    s_waitcnt lgkmcnt(5)
    ds_read_b64_tr_b16 v[24:25], v4 offset:28672
    ds_read_b64_tr_b16 v[26:27], v4 offset:29184
    v_mfma_f32_32x32x16_bf16 v[80:95], v[28:31], v[196:199], v[80:95]
    s_waitcnt lgkmcnt(4)
    ds_read_b64_tr_b16 v[28:29], v5 offset:28672
    ds_read_b64_tr_b16 v[30:31], v5 offset:29184
    v_mfma_f32_32x32x16_bf16 v[32:47], v[16:19], v[200:203], v[32:47]
    s_waitcnt lgkmcnt(4)
    v_xor_b32 v14, 96, v12
    ds_read_b128 v[204:207], v14
    ds_read_b64_tr_b16 v[16:17], v4 offset:26624
    ds_read_b64_tr_b16 v[18:19], v4 offset:27136
    v_mfma_f32_32x32x16_bf16 v[48:63], v[20:23], v[200:203], v[48:63]
    s_waitcnt lgkmcnt(5)
    ds_read_b64_tr_b16 v[20:21], v5 offset:26624
    ds_read_b64_tr_b16 v[22:23], v5 offset:27136
    v_mfma_f32_32x32x16_bf16 v[64:79], v[24:27], v[200:203], v[64:79]
    s_waitcnt lgkmcnt(5)
    ds_read_b64_tr_b16 v[24:25], v4 offset:30720
    ds_read_b64_tr_b16 v[26:27], v4 offset:31232
    v_mfma_f32_32x32x16_bf16 v[80:95], v[28:31], v[200:203], v[80:95]
    s_waitcnt lgkmcnt(4)
    ds_read_b64_tr_b16 v[28:29], v5 offset:30720
    ds_read_b64_tr_b16 v[30:31], v5 offset:31232
    v_mfma_f32_32x32x16_bf16 v[32:47], v[16:19], v[204:207], v[32:47]
    s_barrier
    v_xor_b32 v13, 32768, v12
    ds_read_b128 v[208:211], v13
    ds_read_b64_tr_b16 v[16:17], v4 offset:49152
    ds_read_b64_tr_b16 v[18:19], v4 offset:49664
    s_waitcnt lgkmcnt(7)
    v_mfma_f32_32x32x16_bf16 v[48:63], v[20:23], v[204:207], v[48:63]
    s_waitcnt lgkmcnt(5)
    ds_read_b64_tr_b16 v[20:21], v5 offset:49152
    ds_read_b64_tr_b16 v[22:23], v5 offset:49664
    v_mfma_f32_32x32x16_bf16 v[64:79], v[24:27], v[204:207], v[64:79]
    s_waitcnt lgkmcnt(5)
    ds_read_b64_tr_b16 v[24:25], v4 offset:53248
    ds_read_b64_tr_b16 v[26:27], v4 offset:53760
    v_mfma_f32_32x32x16_bf16 v[80:95], v[28:31], v[204:207], v[80:95]
    s_waitcnt lgkmcnt(4)
    ds_read_b64_tr_b16 v[28:29], v5 offset:53248
    ds_read_b64_tr_b16 v[30:31], v5 offset:53760
    v_mfma_f32_32x32x16_bf16 v[32:47], v[16:19], v[208:211], v[32:47]
    s_waitcnt lgkmcnt(4)
    v_xor_b32 v14, 32800, v12
    ds_read_b128 v[212:215], v14
    ds_read_b64_tr_b16 v[16:17], v4 offset:51200
    ds_read_b64_tr_b16 v[18:19], v4 offset:51712
    v_mfma_f32_32x32x16_bf16 v[48:63], v[20:23], v[208:211], v[48:63]
    s_waitcnt lgkmcnt(5)
    ds_read_b64_tr_b16 v[20:21], v5 offset:51200
    ds_read_b64_tr_b16 v[22:23], v5 offset:51712
    v_mfma_f32_32x32x16_bf16 v[64:79], v[24:27], v[208:211], v[64:79]
    s_waitcnt lgkmcnt(5)
    ds_read_b64_tr_b16 v[24:25], v4 offset:55296
    ds_read_b64_tr_b16 v[26:27], v4 offset:55808
    v_mfma_f32_32x32x16_bf16 v[80:95], v[28:31], v[208:211], v[80:95]
    s_waitcnt lgkmcnt(4)
    ds_read_b64_tr_b16 v[28:29], v5 offset:55296
    ds_read_b64_tr_b16 v[30:31], v5 offset:55808
    v_mfma_f32_32x32x16_bf16 v[32:47], v[16:19], v[212:215], v[32:47]
    s_waitcnt lgkmcnt(4)
    v_xor_b32 v13, 32832, v12
    ds_read_b128 v[216:219], v13
    ds_read_b64_tr_b16 v[16:17], v4 offset:57344
    ds_read_b64_tr_b16 v[18:19], v4 offset:57856
    v_mfma_f32_32x32x16_bf16 v[48:63], v[20:23], v[212:215], v[48:63]
    s_waitcnt lgkmcnt(5)
    ds_read_b64_tr_b16 v[20:21], v5 offset:57344
    ds_read_b64_tr_b16 v[22:23], v5 offset:57856
    v_mfma_f32_32x32x16_bf16 v[64:79], v[24:27], v[212:215], v[64:79]
    s_waitcnt lgkmcnt(5)
    ds_read_b64_tr_b16 v[24:25], v4 offset:61440
    ds_read_b64_tr_b16 v[26:27], v4 offset:61952
    v_mfma_f32_32x32x16_bf16 v[80:95], v[28:31], v[212:215], v[80:95]
    s_waitcnt lgkmcnt(4)
    ds_read_b64_tr_b16 v[28:29], v5 offset:61440
    ds_read_b64_tr_b16 v[30:31], v5 offset:61952
    v_mfma_f32_32x32x16_bf16 v[32:47], v[16:19], v[216:219], v[32:47]
    s_waitcnt lgkmcnt(4)
    v_xor_b32 v14, 32864, v12
    ds_read_b128 v[220:223], v14
    ds_read_b64_tr_b16 v[16:17], v4 offset:59392
    ds_read_b64_tr_b16 v[18:19], v4 offset:59904
    v_mfma_f32_32x32x16_bf16 v[48:63], v[20:23], v[216:219], v[48:63]
    s_waitcnt lgkmcnt(5)
    ds_read_b64_tr_b16 v[20:21], v5 offset:59392
    ds_read_b64_tr_b16 v[22:23], v5 offset:59904
    v_mfma_f32_32x32x16_bf16 v[64:79], v[24:27], v[216:219], v[64:79]
    s_waitcnt lgkmcnt(5)
    ds_read_b64_tr_b16 v[24:25], v4 offset:63488
    ds_read_b64_tr_b16 v[26:27], v4 offset:64000
    v_mfma_f32_32x32x16_bf16 v[80:95], v[28:31], v[216:219], v[80:95]
    s_waitcnt lgkmcnt(4)
    ds_read_b64_tr_b16 v[28:29], v5 offset:63488
    ds_read_b64_tr_b16 v[30:31], v5 offset:64000
    v_mfma_f32_32x32x16_bf16 v[32:47], v[16:19], v[220:223], v[32:47]
    s_barrier
    v_xor_b32 v13, 65536, v12
    ds_read_b128 v[224:227], v13
    ds_read_b64_tr_b16 v[16:17], v6 offset:16384
    ds_read_b64_tr_b16 v[18:19], v6 offset:16896
    s_waitcnt lgkmcnt(7)
    v_mfma_f32_32x32x16_bf16 v[48:63], v[20:23], v[220:223], v[48:63]
    s_waitcnt lgkmcnt(5)
    ds_read_b64_tr_b16 v[20:21], v7 offset:16384
    ds_read_b64_tr_b16 v[22:23], v7 offset:16896
    v_mfma_f32_32x32x16_bf16 v[64:79], v[24:27], v[220:223], v[64:79]
    s_waitcnt lgkmcnt(5)
    ds_read_b64_tr_b16 v[24:25], v6 offset:20480
    ds_read_b64_tr_b16 v[26:27], v6 offset:20992
    v_mfma_f32_32x32x16_bf16 v[80:95], v[28:31], v[220:223], v[80:95]
    s_waitcnt lgkmcnt(4)
    ds_read_b64_tr_b16 v[28:29], v7 offset:20480
    ds_read_b64_tr_b16 v[30:31], v7 offset:20992
    v_mfma_f32_32x32x16_bf16 v[32:47], v[16:19], v[224:227], v[32:47]
    s_waitcnt lgkmcnt(4)
    v_xor_b32 v14, 65568, v12
    ds_read_b128 v[228:231], v14
    ds_read_b64_tr_b16 v[16:17], v6 offset:18432
    ds_read_b64_tr_b16 v[18:19], v6 offset:18944
    v_mfma_f32_32x32x16_bf16 v[48:63], v[20:23], v[224:227], v[48:63]
    s_waitcnt lgkmcnt(5)
    ds_read_b64_tr_b16 v[20:21], v7 offset:18432
    ds_read_b64_tr_b16 v[22:23], v7 offset:18944
    v_mfma_f32_32x32x16_bf16 v[64:79], v[24:27], v[224:227], v[64:79]
    s_waitcnt lgkmcnt(5)
    ds_read_b64_tr_b16 v[24:25], v6 offset:22528
    ds_read_b64_tr_b16 v[26:27], v6 offset:23040
    v_mfma_f32_32x32x16_bf16 v[80:95], v[28:31], v[224:227], v[80:95]
    s_waitcnt lgkmcnt(4)
    ds_read_b64_tr_b16 v[28:29], v7 offset:22528
    ds_read_b64_tr_b16 v[30:31], v7 offset:23040
    v_mfma_f32_32x32x16_bf16 v[32:47], v[16:19], v[228:231], v[32:47]
    s_waitcnt lgkmcnt(4)
    v_xor_b32 v13, 65600, v12
    ds_read_b128 v[232:235], v13
    ds_read_b64_tr_b16 v[16:17], v6 offset:24576
    ds_read_b64_tr_b16 v[18:19], v6 offset:25088
    v_mfma_f32_32x32x16_bf16 v[48:63], v[20:23], v[228:231], v[48:63]
    s_waitcnt lgkmcnt(5)
    ds_read_b64_tr_b16 v[20:21], v7 offset:24576
    ds_read_b64_tr_b16 v[22:23], v7 offset:25088
    v_mfma_f32_32x32x16_bf16 v[64:79], v[24:27], v[228:231], v[64:79]
    s_waitcnt lgkmcnt(5)
    ds_read_b64_tr_b16 v[24:25], v6 offset:28672
    ds_read_b64_tr_b16 v[26:27], v6 offset:29184
    v_mfma_f32_32x32x16_bf16 v[80:95], v[28:31], v[228:231], v[80:95]
    s_waitcnt lgkmcnt(4)
    ds_read_b64_tr_b16 v[28:29], v7 offset:28672
    ds_read_b64_tr_b16 v[30:31], v7 offset:29184
    v_mfma_f32_32x32x16_bf16 v[32:47], v[16:19], v[232:235], v[32:47]
    s_waitcnt lgkmcnt(4)
    v_xor_b32 v14, 65632, v12
    ds_read_b128 v[236:239], v14
    ds_read_b64_tr_b16 v[16:17], v6 offset:26624
    ds_read_b64_tr_b16 v[18:19], v6 offset:27136
    v_mfma_f32_32x32x16_bf16 v[48:63], v[20:23], v[232:235], v[48:63]
    s_waitcnt lgkmcnt(5)
    ds_read_b64_tr_b16 v[20:21], v7 offset:26624
    ds_read_b64_tr_b16 v[22:23], v7 offset:27136
    v_mfma_f32_32x32x16_bf16 v[64:79], v[24:27], v[232:235], v[64:79]
    s_waitcnt lgkmcnt(5)
    ds_read_b64_tr_b16 v[24:25], v6 offset:30720
    ds_read_b64_tr_b16 v[26:27], v6 offset:31232
    v_mfma_f32_32x32x16_bf16 v[80:95], v[28:31], v[232:235], v[80:95]
    s_waitcnt lgkmcnt(4)
    ds_read_b64_tr_b16 v[28:29], v7 offset:30720
    ds_read_b64_tr_b16 v[30:31], v7 offset:31232
    v_mfma_f32_32x32x16_bf16 v[32:47], v[16:19], v[236:239], v[32:47]
    s_barrier
    v_xor_b32 v13, 98304, v12
    ds_read_b128 v[240:243], v13
    ds_read_b64_tr_b16 v[16:17], v8 offset:20480
    ds_read_b64_tr_b16 v[18:19], v8 offset:20992
    s_waitcnt lgkmcnt(7)
    v_mfma_f32_32x32x16_bf16 v[48:63], v[20:23], v[236:239], v[48:63]
    s_waitcnt lgkmcnt(5)
    v_xor_b32 v14, 98336, v12
    ds_read_b128 v[244:247], v14
    ds_read_b64_tr_b16 v[20:21], v8 offset:22528
    ds_read_b64_tr_b16 v[22:23], v8 offset:23040
    v_mfma_f32_32x32x16_bf16 v[64:79], v[24:27], v[236:239], v[64:79]
    s_waitcnt lgkmcnt(6)
    v_xor_b32 v13, 98368, v12
    ds_read_b128 v[248:251], v13
    ds_read_b64_tr_b16 v[24:25], v8 offset:28672
    ds_read_b64_tr_b16 v[26:27], v8 offset:29184
    v_mfma_f32_32x32x16_bf16 v[80:95], v[28:31], v[236:239], v[80:95]
    s_cmp_ge_u32 s79, 5
    s_cbranch_scc1 PA_K
    v_xor_b32 v14, 98400, v12
    ds_read_b128 v[252:255], v14
    ds_read_b64_tr_b16 v[28:29], v8 offset:30720
    ds_read_b64_tr_b16 v[30:31], v8 offset:31232
    s_waitcnt lgkmcnt(9)
    v_mfma_f32_32x32x16_bf16 v[64:79], v[16:19], v[240:243], v[64:79]
    s_waitcnt lgkmcnt(6)
    ds_read_b64_tr_b16 v[16:17], v8 offset:16384
    ds_read_b64_tr_b16 v[18:19], v8 offset:16896
    v_mfma_f32_32x32x16_bf16 v[64:79], v[20:23], v[244:247], v[64:79]
    s_waitcnt lgkmcnt(5)
    ds_read_b64_tr_b16 v[20:21], v8 offset:18432
    ds_read_b64_tr_b16 v[22:23], v8 offset:18944
    v_mfma_f32_32x32x16_bf16 v[64:79], v[24:27], v[248:251], v[64:79]
    s_waitcnt lgkmcnt(4)
    ds_read_b64_tr_b16 v[24:25], v8 offset:24576
    ds_read_b64_tr_b16 v[26:27], v8 offset:25088
    v_mfma_f32_32x32x16_bf16 v[64:79], v[28:31], v[252:255], v[64:79]
    s_waitcnt lgkmcnt(4)
    ds_read_b64_tr_b16 v[28:29], v8 offset:26624
    ds_read_b64_tr_b16 v[30:31], v8 offset:27136
    v_mfma_f32_32x32x16_bf16 v[32:47], v[16:19], v[240:243], v[32:47]
    s_waitcnt lgkmcnt(4)
    ds_read_b64_tr_b16 v[16:17], v9 offset:20480
    ds_read_b64_tr_b16 v[18:19], v9 offset:20992
    v_mfma_f32_32x32x16_bf16 v[32:47], v[20:23], v[244:247], v[32:47]
    s_waitcnt lgkmcnt(4)
    ds_read_b64_tr_b16 v[20:21], v9 offset:22528
    ds_read_b64_tr_b16 v[22:23], v9 offset:23040
    v_mul_f32 v64, s78, v64
    v_mul_f32 v65, s78, v65
    v_mul_f32 v66, s78, v66
    v_mul_f32 v67, s78, v67
    v_cvt_pk_bf16_f32 v64, v64, v65
    v_mfma_f32_32x32x16_bf16 v[32:47], v[24:27], v[248:251], v[32:47]
    s_waitcnt lgkmcnt(4)
    ds_read_b64_tr_b16 v[24:25], v9 offset:28672
    ds_read_b64_tr_b16 v[26:27], v9 offset:29184
    v_cvt_pk_bf16_f32 v65, v66, v67
    v_mul_f32 v68, s78, v68
    v_mul_f32 v69, s78, v69
    v_mul_f32 v70, s78, v70
    v_mul_f32 v71, s78, v71
    v_mad_u32_u24 v10, v0, s68, v15
    buffer_store_dwordx2 v[64:65], v10, s[20:23], s52 offen sc1
    v_mfma_f32_32x32x16_bf16 v[32:47], v[28:31], v[252:255], v[32:47]
    s_waitcnt lgkmcnt(4)
    ds_read_b64_tr_b16 v[28:29], v9 offset:30720
    ds_read_b64_tr_b16 v[30:31], v9 offset:31232
    v_cvt_pk_bf16_f32 v66, v68, v69
    v_cvt_pk_bf16_f32 v67, v70, v71
    v_mul_f32 v72, s78, v72
    v_mul_f32 v73, s78, v73
    v_mul_f32 v74, s78, v74
    v_mfma_f32_32x32x16_bf16 v[80:95], v[16:19], v[240:243], v[80:95]
    s_waitcnt lgkmcnt(4)
    ds_read_b64_tr_b16 v[16:17], v9 offset:16384
    ds_read_b64_tr_b16 v[18:19], v9 offset:16896
    v_mul_f32 v75, s78, v75
    v_cvt_pk_bf16_f32 v68, v72, v73
    v_cvt_pk_bf16_f32 v69, v74, v75
    v_mul_f32 v76, s78, v76
    v_mul_f32 v77, s78, v77
    v_mfma_f32_32x32x16_bf16 v[80:95], v[20:23], v[244:247], v[80:95]
    s_waitcnt lgkmcnt(4)
    ds_read_b64_tr_b16 v[20:21], v9 offset:18432
    ds_read_b64_tr_b16 v[22:23], v9 offset:18944
    v_mul_f32 v78, s78, v78
    v_mul_f32 v79, s78, v79
    v_cvt_pk_bf16_f32 v70, v76, v77
    v_cvt_pk_bf16_f32 v71, v78, v79
    v_mul_f32 v32, s78, v32
    v_mad_u32_u24 v11, v0, s69, v15
    buffer_store_dwordx2 v[66:67], v11, s[20:23], s53 offen sc1
    v_mfma_f32_32x32x16_bf16 v[80:95], v[24:27], v[248:251], v[80:95]
    s_waitcnt lgkmcnt(4)
    ds_read_b64_tr_b16 v[24:25], v9 offset:24576
    ds_read_b64_tr_b16 v[26:27], v9 offset:25088
    v_mul_f32 v33, s78, v33
    v_mul_f32 v34, s78, v34
    v_mul_f32 v35, s78, v35
    v_cvt_pk_bf16_f32 v72, v32, v33
    v_cvt_pk_bf16_f32 v73, v34, v35
    v_mfma_f32_32x32x16_bf16 v[80:95], v[28:31], v[252:255], v[80:95]
    s_waitcnt lgkmcnt(4)
    ds_read_b64_tr_b16 v[28:29], v9 offset:26624
    ds_read_b64_tr_b16 v[30:31], v9 offset:27136
    v_mul_f32 v36, s78, v36
    v_mul_f32 v37, s78, v37
    v_mul_f32 v38, s78, v38
    v_mul_f32 v39, s78, v39
    v_cvt_pk_bf16_f32 v74, v36, v37
    v_mfma_f32_32x32x16_bf16 v[48:63], v[16:19], v[240:243], v[48:63]
    s_waitcnt lgkmcnt(4)
    ds_read_b64_tr_b16 v[16:17], v8 offset:49152
    ds_read_b64_tr_b16 v[18:19], v8 offset:49664
    v_cvt_pk_bf16_f32 v75, v38, v39
    v_mul_f32 v40, s78, v40
    v_mul_f32 v41, s78, v41
    v_mul_f32 v42, s78, v42
    v_mul_f32 v43, s78, v43
    v_mad_u32_u24 v10, v0, s70, v15
    buffer_store_dwordx2 v[68:69], v10, s[20:23], s54 offen sc1
    v_mfma_f32_32x32x16_bf16 v[48:63], v[20:23], v[244:247], v[48:63]
    s_waitcnt lgkmcnt(4)
    ds_read_b64_tr_b16 v[20:21], v8 offset:51200
    ds_read_b64_tr_b16 v[22:23], v8 offset:51712
    v_cvt_pk_bf16_f32 v76, v40, v41
    v_cvt_pk_bf16_f32 v77, v42, v43
    v_mul_f32 v44, s78, v44
    v_mul_f32 v45, s78, v45
    v_mul_f32 v46, s78, v46
    v_mfma_f32_32x32x16_bf16 v[48:63], v[24:27], v[248:251], v[48:63]
    s_waitcnt lgkmcnt(4)
    ds_read_b64_tr_b16 v[24:25], v8 offset:53248
    ds_read_b64_tr_b16 v[26:27], v8 offset:53760
    v_mul_f32 v47, s78, v47
    v_cvt_pk_bf16_f32 v78, v44, v45
    v_cvt_pk_bf16_f32 v79, v46, v47
    v_mul_f32 v80, s78, v80
    v_mul_f32 v81, s78, v81
    v_mfma_f32_32x32x16_bf16 v[48:63], v[28:31], v[252:255], v[48:63]
    s_waitcnt lgkmcnt(4)
    ds_read_b64_tr_b16 v[28:29], v8 offset:55296
    ds_read_b64_tr_b16 v[30:31], v8 offset:55808
    v_mul_f32 v82, s78, v82
    v_mul_f32 v83, s78, v83
    v_cvt_pk_bf16_f32 v80, v80, v81
    v_cvt_pk_bf16_f32 v81, v82, v83
    v_mul_f32 v84, s78, v84
    v_mad_u32_u24 v11, v0, s71, v15
    buffer_store_dwordx2 v[70:71], v11, s[20:23], s55 offen sc1
    v_mfma_f32_32x32x16_bf16 v[32:47], v[16:19], v[96:99], 0
    s_waitcnt lgkmcnt(4)
    ds_read_b64_tr_b16 v[16:17], v8 offset:57344
    ds_read_b64_tr_b16 v[18:19], v8 offset:57856
    v_mul_f32 v85, s78, v85
    v_mul_f32 v86, s78, v86
    v_mul_f32 v87, s78, v87
    v_cvt_pk_bf16_f32 v82, v84, v85
    v_cvt_pk_bf16_f32 v83, v86, v87
    v_mfma_f32_32x32x16_bf16 v[32:47], v[20:23], v[100:103], v[32:47]
    s_waitcnt lgkmcnt(4)
    ds_read_b64_tr_b16 v[20:21], v8 offset:59392
    ds_read_b64_tr_b16 v[22:23], v8 offset:59904
    v_mul_f32 v88, s78, v88
    v_mul_f32 v89, s78, v89
    v_mul_f32 v90, s78, v90
    v_mul_f32 v91, s78, v91
    v_cvt_pk_bf16_f32 v84, v88, v89
    v_mov_b32 v13, 147456
    ds_read_b32 v14, v13
    v_mfma_f32_32x32x16_bf16 v[32:47], v[24:27], v[104:107], v[32:47]
    s_waitcnt lgkmcnt(5)
    ds_read_b64_tr_b16 v[24:25], v8 offset:61440
    ds_read_b64_tr_b16 v[26:27], v8 offset:61952
    v_cvt_pk_bf16_f32 v85, v90, v91
    v_mul_f32 v92, s78, v92
    v_mul_f32 v93, s78, v93
    v_mul_f32 v94, s78, v94
    v_mul_f32 v95, s78, v95
    v_mad_u32_u24 v10, v0, s60, v15
    buffer_store_dwordx2 v[72:73], v10, s[20:23], s44 offen sc1
    v_mfma_f32_32x32x16_bf16 v[32:47], v[28:31], v[108:111], v[32:47]
    s_waitcnt lgkmcnt(5)
    ds_read_b64_tr_b16 v[28:29], v8 offset:63488
    ds_read_b64_tr_b16 v[30:31], v8 offset:64000
    v_cvt_pk_bf16_f32 v86, v92, v93
    v_cvt_pk_bf16_f32 v87, v94, v95
    v_mul_f32 v48, s78, v48
    v_mul_f32 v49, s78, v49
    v_mul_f32 v50, s78, v50
    v_mfma_f32_32x32x16_bf16 v[32:47], v[16:19], v[112:115], v[32:47]
    s_waitcnt lgkmcnt(5)
    ds_read_b64_tr_b16 v[16:17], v9 offset:49152
    ds_read_b64_tr_b16 v[18:19], v9 offset:49664
    v_mul_f32 v51, s78, v51
    v_cvt_pk_bf16_f32 v88, v48, v49
    v_cvt_pk_bf16_f32 v89, v50, v51
    v_mul_f32 v52, s78, v52
    v_mul_f32 v53, s78, v53
    v_mfma_f32_32x32x16_bf16 v[32:47], v[20:23], v[116:119], v[32:47]
    s_waitcnt lgkmcnt(4)
    ds_read_b64_tr_b16 v[20:21], v9 offset:51200
    ds_read_b64_tr_b16 v[22:23], v9 offset:51712
    v_mul_f32 v54, s78, v54
    v_mul_f32 v55, s78, v55
    v_cvt_pk_bf16_f32 v90, v52, v53
    v_cvt_pk_bf16_f32 v91, v54, v55
    v_mul_f32 v56, s78, v56
    v_mad_u32_u24 v11, v0, s61, v15
    buffer_store_dwordx2 v[74:75], v11, s[20:23], s45 offen sc1
    v_mfma_f32_32x32x16_bf16 v[32:47], v[24:27], v[120:123], v[32:47]
    s_waitcnt lgkmcnt(4)
    ds_read_b64_tr_b16 v[24:25], v9 offset:53248
    ds_read_b64_tr_b16 v[26:27], v9 offset:53760
    v_mul_f32 v57, s78, v57
    v_mul_f32 v58, s78, v58
    v_mul_f32 v59, s78, v59
    v_cvt_pk_bf16_f32 v92, v56, v57
    v_cvt_pk_bf16_f32 v93, v58, v59
    v_mfma_f32_32x32x16_bf16 v[32:47], v[28:31], v[124:127], v[32:47]
    s_waitcnt lgkmcnt(4)
    ds_read_b64_tr_b16 v[28:29], v9 offset:55296
    ds_read_b64_tr_b16 v[30:31], v9 offset:55808
    v_mul_f32 v60, s78, v60
    v_mul_f32 v61, s78, v61
    v_mul_f32 v62, s78, v62
    v_mul_f32 v63, s78, v63
    v_cvt_pk_bf16_f32 v94, v60, v61
    v_cvt_pk_bf16_f32 v95, v62, v63
    v_readfirstlane_b32 s17, v14
    s_add_u32 s17, s17, 3
    v_mfma_f32_32x32x16_bf16 v[48:63], v[16:19], v[96:99], 0
    s_waitcnt lgkmcnt(4)
    ds_read_b64_tr_b16 v[16:17], v9 offset:57344
    ds_read_b64_tr_b16 v[18:19], v9 offset:57856
    v_mad_u32_u24 v10, v0, s62, v15
    buffer_store_dwordx2 v[76:77], v10, s[20:23], s46 offen sc1
    v_mfma_f32_32x32x16_bf16 v[48:63], v[20:23], v[100:103], v[48:63]
    s_waitcnt lgkmcnt(4)
    ds_read_b64_tr_b16 v[20:21], v9 offset:59392
    ds_read_b64_tr_b16 v[22:23], v9 offset:59904
    v_mfma_f32_32x32x16_bf16 v[48:63], v[24:27], v[104:107], v[48:63]
    s_waitcnt lgkmcnt(4)
    ds_read_b64_tr_b16 v[24:25], v9 offset:61440
    ds_read_b64_tr_b16 v[26:27], v9 offset:61952
    v_mfma_f32_32x32x16_bf16 v[48:63], v[28:31], v[108:111], v[48:63]
    s_waitcnt lgkmcnt(4)
    ds_read_b64_tr_b16 v[28:29], v9 offset:63488
    ds_read_b64_tr_b16 v[30:31], v9 offset:64000
    v_mad_u32_u24 v11, v0, s63, v15
    buffer_store_dwordx2 v[78:79], v11, s[20:23], s47 offen sc1
    v_mfma_f32_32x32x16_bf16 v[48:63], v[16:19], v[112:115], v[48:63]
    s_barrier
    ds_read_b64_tr_b16 v[16:17], v4 offset:0
    ds_read_b64_tr_b16 v[18:19], v4 offset:512
    s_waitcnt lgkmcnt(6)
    v_mfma_f32_32x32x16_bf16 v[48:63], v[20:23], v[116:119], v[48:63]
    s_waitcnt lgkmcnt(4)
    ds_read_b64_tr_b16 v[20:21], v4 offset:2048
    ds_read_b64_tr_b16 v[22:23], v4 offset:2560
    v_mfma_f32_32x32x16_bf16 v[48:63], v[24:27], v[120:123], v[48:63]
    s_waitcnt lgkmcnt(4)
    ds_read_b64_tr_b16 v[24:25], v5 offset:0
    ds_read_b64_tr_b16 v[26:27], v5 offset:512
    v_mad_u32_u24 v10, v0, s72, v15
    buffer_store_dwordx2 v[80:81], v10, s[20:23], s56 offen sc1
    v_mfma_f32_32x32x16_bf16 v[48:63], v[28:31], v[124:127], v[48:63]
    s_waitcnt lgkmcnt(4)
    ds_read_b64_tr_b16 v[28:29], v5 offset:2048
    ds_read_b64_tr_b16 v[30:31], v5 offset:2560
    v_mfma_f32_32x32x16_bf16 v[32:47], v[16:19], v[128:131], v[32:47]
    s_waitcnt lgkmcnt(4)
    ds_read_b64_tr_b16 v[16:17], v4 offset:4096
    ds_read_b64_tr_b16 v[18:19], v4 offset:4608
    v_mfma_f32_32x32x16_bf16 v[32:47], v[20:23], v[132:135], v[32:47]
    s_waitcnt lgkmcnt(4)
    ds_read_b64_tr_b16 v[20:21], v4 offset:6144
    ds_read_b64_tr_b16 v[22:23], v4 offset:6656
    v_mad_u32_u24 v11, v0, s73, v15
    buffer_store_dwordx2 v[82:83], v11, s[20:23], s57 offen sc1
    v_mfma_f32_32x32x16_bf16 v[48:63], v[24:27], v[128:131], v[48:63]
    s_waitcnt lgkmcnt(4)
    ds_read_b64_tr_b16 v[24:25], v5 offset:4096
    ds_read_b64_tr_b16 v[26:27], v5 offset:4608
    v_mfma_f32_32x32x16_bf16 v[48:63], v[28:31], v[132:135], v[48:63]
    s_waitcnt lgkmcnt(4)
    ds_read_b64_tr_b16 v[28:29], v5 offset:6144
    ds_read_b64_tr_b16 v[30:31], v5 offset:6656
    v_mfma_f32_32x32x16_bf16 v[32:47], v[16:19], v[136:139], v[32:47]
    s_waitcnt lgkmcnt(4)
    ds_read_b64_tr_b16 v[16:17], v4 offset:8192
    ds_read_b64_tr_b16 v[18:19], v4 offset:8704
    v_mad_u32_u24 v10, v0, s74, v15
    buffer_store_dwordx2 v[84:85], v10, s[20:23], s58 offen sc1
    v_mfma_f32_32x32x16_bf16 v[32:47], v[20:23], v[140:143], v[32:47]
    s_waitcnt lgkmcnt(4)
    ds_read_b64_tr_b16 v[20:21], v4 offset:10240
    ds_read_b64_tr_b16 v[22:23], v4 offset:10752
    v_mfma_f32_32x32x16_bf16 v[48:63], v[24:27], v[136:139], v[48:63]
    s_waitcnt lgkmcnt(4)
    ds_read_b64_tr_b16 v[24:25], v5 offset:8192
    ds_read_b64_tr_b16 v[26:27], v5 offset:8704
    v_mfma_f32_32x32x16_bf16 v[48:63], v[28:31], v[140:143], v[48:63]
    s_waitcnt lgkmcnt(4)
    ds_read_b64_tr_b16 v[28:29], v5 offset:10240
    ds_read_b64_tr_b16 v[30:31], v5 offset:10752
    v_mad_u32_u24 v11, v0, s75, v15
    buffer_store_dwordx2 v[86:87], v11, s[20:23], s59 offen sc1
    v_mfma_f32_32x32x16_bf16 v[32:47], v[16:19], v[144:147], v[32:47]
    s_waitcnt lgkmcnt(4)
    ds_read_b64_tr_b16 v[16:17], v4 offset:12288
    ds_read_b64_tr_b16 v[18:19], v4 offset:12800
    v_mfma_f32_32x32x16_bf16 v[32:47], v[20:23], v[148:151], v[32:47]
    s_waitcnt lgkmcnt(4)
    ds_read_b64_tr_b16 v[20:21], v4 offset:14336
    ds_read_b64_tr_b16 v[22:23], v4 offset:14848
    v_mfma_f32_32x32x16_bf16 v[48:63], v[24:27], v[144:147], v[48:63]
    s_waitcnt lgkmcnt(4)
    ds_read_b64_tr_b16 v[24:25], v5 offset:12288
    ds_read_b64_tr_b16 v[26:27], v5 offset:12800
    v_mad_u32_u24 v10, v0, s64, v15
    buffer_store_dwordx2 v[88:89], v10, s[20:23], s48 offen sc1
    v_mfma_f32_32x32x16_bf16 v[48:63], v[28:31], v[148:151], v[48:63]
    s_waitcnt lgkmcnt(4)
    ds_read_b64_tr_b16 v[28:29], v5 offset:14336
    ds_read_b64_tr_b16 v[30:31], v5 offset:14848
    v_mfma_f32_32x32x16_bf16 v[32:47], v[16:19], v[152:155], v[32:47]
    s_waitcnt lgkmcnt(4)
    ds_read_b64_tr_b16 v[16:17], v4 offset:16384
    ds_read_b64_tr_b16 v[18:19], v4 offset:16896
    v_mfma_f32_32x32x16_bf16 v[32:47], v[20:23], v[156:159], v[32:47]
    s_waitcnt lgkmcnt(4)
    ds_read_b64_tr_b16 v[20:21], v4 offset:18432
    ds_read_b64_tr_b16 v[22:23], v4 offset:18944
    v_mad_u32_u24 v11, v0, s65, v15
    buffer_store_dwordx2 v[90:91], v11, s[20:23], s49 offen sc1
    v_mfma_f32_32x32x16_bf16 v[48:63], v[24:27], v[152:155], v[48:63]
    s_waitcnt lgkmcnt(4)
    ds_read_b64_tr_b16 v[24:25], v5 offset:16384
    ds_read_b64_tr_b16 v[26:27], v5 offset:16896
    v_mfma_f32_32x32x16_bf16 v[48:63], v[28:31], v[156:159], v[48:63]
    s_waitcnt lgkmcnt(4)
    ds_read_b64_tr_b16 v[28:29], v5 offset:18432
    ds_read_b64_tr_b16 v[30:31], v5 offset:18944
    v_mfma_f32_32x32x16_bf16 v[32:47], v[16:19], v[160:163], v[32:47]
    s_waitcnt lgkmcnt(4)
    ds_read_b64_tr_b16 v[16:17], v4 offset:20480
    ds_read_b64_tr_b16 v[18:19], v4 offset:20992
    v_mad_u32_u24 v10, v0, s66, v15
    buffer_store_dwordx2 v[92:93], v10, s[20:23], s50 offen sc1
    s_branch PADX_3
PAD_3:
    s_branch PAD_7
PADX_3:
    v_mfma_f32_32x32x16_bf16 v[32:47], v[20:23], v[164:167], v[32:47]
    s_waitcnt lgkmcnt(4)
    ds_read_b64_tr_b16 v[20:21], v4 offset:22528
    ds_read_b64_tr_b16 v[22:23], v4 offset:23040
    v_mfma_f32_32x32x16_bf16 v[48:63], v[24:27], v[160:163], v[48:63]
    s_waitcnt lgkmcnt(4)
    ds_read_b64_tr_b16 v[24:25], v5 offset:20480
    ds_read_b64_tr_b16 v[26:27], v5 offset:20992
    v_mfma_f32_32x32x16_bf16 v[48:63], v[28:31], v[164:167], v[48:63]
    s_waitcnt lgkmcnt(4)
    ds_read_b64_tr_b16 v[28:29], v5 offset:22528
    ds_read_b64_tr_b16 v[30:31], v5 offset:23040
    v_mad_u32_u24 v11, v0, s67, v15
    buffer_store_dwordx2 v[94:95], v11, s[20:23], s51 offen sc1
    v_mfma_f32_32x32x16_bf16 v[32:47], v[16:19], v[168:171], v[32:47]
    s_waitcnt lgkmcnt(4)
    ds_read_b64_tr_b16 v[16:17], v4 offset:24576
    ds_read_b64_tr_b16 v[18:19], v4 offset:25088
    v_mfma_f32_32x32x16_bf16 v[32:47], v[20:23], v[172:175], v[32:47]
    s_waitcnt lgkmcnt(4)
    ds_read_b64_tr_b16 v[20:21], v4 offset:26624
    ds_read_b64_tr_b16 v[22:23], v4 offset:27136
    v_mfma_f32_32x32x16_bf16 v[48:63], v[24:27], v[168:171], v[48:63]
    s_waitcnt lgkmcnt(4)
    ds_read_b64_tr_b16 v[24:25], v5 offset:24576
    ds_read_b64_tr_b16 v[26:27], v5 offset:25088
    v_mfma_f32_32x32x16_bf16 v[48:63], v[28:31], v[172:175], v[48:63]
    s_waitcnt lgkmcnt(4)
    ds_read_b64_tr_b16 v[28:29], v5 offset:26624
    ds_read_b64_tr_b16 v[30:31], v5 offset:27136
    v_mfma_f32_32x32x16_bf16 v[32:47], v[16:19], v[176:179], v[32:47]
    s_waitcnt lgkmcnt(4)
    ds_read_b64_tr_b16 v[16:17], v4 offset:28672
    ds_read_b64_tr_b16 v[18:19], v4 offset:29184
    v_mfma_f32_32x32x16_bf16 v[32:47], v[20:23], v[180:183], v[32:47]
    s_waitcnt lgkmcnt(4)
    ds_read_b64_tr_b16 v[20:21], v4 offset:30720
    ds_read_b64_tr_b16 v[22:23], v4 offset:31232
    v_mfma_f32_32x32x16_bf16 v[48:63], v[24:27], v[176:179], v[48:63]
    s_waitcnt lgkmcnt(4)
    ds_read_b64_tr_b16 v[24:25], v5 offset:28672
    ds_read_b64_tr_b16 v[26:27], v5 offset:29184
    v_mfma_f32_32x32x16_bf16 v[48:63], v[28:31], v[180:183], v[48:63]
    s_branch PA_JOIN
PA_K:
    v_xor_b32 v14, 98400, v12
    ds_read_b128 v[252:255], v14
    ds_read_b64_tr_b16 v[28:29], v8 offset:30720
    ds_read_b64_tr_b16 v[30:31], v8 offset:31232
    s_waitcnt lgkmcnt(9)
    v_mfma_f32_32x32x16_bf16 v[64:79], v[16:19], v[240:243], v[64:79]
    s_waitcnt lgkmcnt(6)
    ds_read_b64_tr_b16 v[16:17], v8 offset:16384
    ds_read_b64_tr_b16 v[18:19], v8 offset:16896
    v_mfma_f32_32x32x16_bf16 v[64:79], v[20:23], v[244:247], v[64:79]
    s_waitcnt lgkmcnt(5)
    ds_read_b64_tr_b16 v[20:21], v8 offset:18432
    ds_read_b64_tr_b16 v[22:23], v8 offset:18944
    v_mfma_f32_32x32x16_bf16 v[64:79], v[24:27], v[248:251], v[64:79]
    s_waitcnt lgkmcnt(4)
    ds_read_b64_tr_b16 v[24:25], v8 offset:24576
    ds_read_b64_tr_b16 v[26:27], v8 offset:25088
    v_mfma_f32_32x32x16_bf16 v[64:79], v[28:31], v[252:255], v[64:79]
    s_waitcnt lgkmcnt(4)
    ds_read_b64_tr_b16 v[28:29], v8 offset:26624
    ds_read_b64_tr_b16 v[30:31], v8 offset:27136
    v_mfma_f32_32x32x16_bf16 v[32:47], v[16:19], v[240:243], v[32:47]
    s_waitcnt lgkmcnt(4)
    ds_read_b64_tr_b16 v[16:17], v9 offset:20480
    ds_read_b64_tr_b16 v[18:19], v9 offset:20992
    v_mfma_f32_32x32x16_bf16 v[32:47], v[20:23], v[244:247], v[32:47]
    s_waitcnt lgkmcnt(4)
    ds_read_b64_tr_b16 v[20:21], v9 offset:22528
    ds_read_b64_tr_b16 v[22:23], v9 offset:23040
    v_cvt_pk_bf16_f32 v64, v64, v65
    v_cvt_pk_bf16_f32 v65, v66, v67
    v_cvt_pk_bf16_f32 v66, v68, v69
    v_cvt_pk_bf16_f32 v67, v70, v71
    v_cvt_pk_bf16_f32 v68, v72, v73
    v_mad_u32_u24 v10, v0, s68, v15
    buffer_store_dwordx2 v[64:65], v10, s[20:23], s52 offen sc1
    v_mfma_f32_32x32x16_bf16 v[32:47], v[24:27], v[248:251], v[32:47]
    s_waitcnt lgkmcnt(4)
    ds_read_b64_tr_b16 v[24:25], v9 offset:28672
    ds_read_b64_tr_b16 v[26:27], v9 offset:29184
    v_cvt_pk_bf16_f32 v69, v74, v75
    v_cvt_pk_bf16_f32 v70, v76, v77
    v_cvt_pk_bf16_f32 v71, v78, v79
    v_mfma_f32_32x32x16_bf16 v[32:47], v[28:31], v[252:255], v[32:47]
    s_waitcnt lgkmcnt(4)
    ds_read_b64_tr_b16 v[28:29], v9 offset:30720
    ds_read_b64_tr_b16 v[30:31], v9 offset:31232
    v_mfma_f32_32x32x16_bf16 v[80:95], v[16:19], v[240:243], v[80:95]
    s_waitcnt lgkmcnt(4)
    ds_read_b64_tr_b16 v[16:17], v9 offset:16384
    ds_read_b64_tr_b16 v[18:19], v9 offset:16896
    v_mad_u32_u24 v11, v0, s69, v15
    buffer_store_dwordx2 v[66:67], v11, s[20:23], s53 offen sc1
    v_mfma_f32_32x32x16_bf16 v[80:95], v[20:23], v[244:247], v[80:95]
    s_waitcnt lgkmcnt(4)
    ds_read_b64_tr_b16 v[20:21], v9 offset:18432
    ds_read_b64_tr_b16 v[22:23], v9 offset:18944
    v_cvt_pk_bf16_f32 v72, v32, v33
    v_cvt_pk_bf16_f32 v73, v34, v35
    v_cvt_pk_bf16_f32 v74, v36, v37
    v_cvt_pk_bf16_f32 v75, v38, v39
    v_cvt_pk_bf16_f32 v76, v40, v41
    v_mfma_f32_32x32x16_bf16 v[80:95], v[24:27], v[248:251], v[80:95]
    s_waitcnt lgkmcnt(4)
    ds_read_b64_tr_b16 v[24:25], v9 offset:24576
    ds_read_b64_tr_b16 v[26:27], v9 offset:25088
    v_cvt_pk_bf16_f32 v77, v42, v43
    v_cvt_pk_bf16_f32 v78, v44, v45
    v_cvt_pk_bf16_f32 v79, v46, v47
    v_mfma_f32_32x32x16_bf16 v[80:95], v[28:31], v[252:255], v[80:95]
    s_waitcnt lgkmcnt(4)
    ds_read_b64_tr_b16 v[28:29], v9 offset:26624
    ds_read_b64_tr_b16 v[30:31], v9 offset:27136
    v_mad_u32_u24 v10, v0, s70, v15
    buffer_store_dwordx2 v[68:69], v10, s[20:23], s54 offen sc1
    v_mfma_f32_32x32x16_bf16 v[48:63], v[16:19], v[240:243], v[48:63]
    s_waitcnt lgkmcnt(4)
    ds_read_b64_tr_b16 v[16:17], v8 offset:49152
    ds_read_b64_tr_b16 v[18:19], v8 offset:49664
    v_mfma_f32_32x32x16_bf16 v[48:63], v[20:23], v[244:247], v[48:63]
    s_waitcnt lgkmcnt(4)
    ds_read_b64_tr_b16 v[20:21], v8 offset:51200
    ds_read_b64_tr_b16 v[22:23], v8 offset:51712
    v_cvt_pk_bf16_f32 v80, v80, v81
    v_cvt_pk_bf16_f32 v81, v82, v83
    v_cvt_pk_bf16_f32 v82, v84, v85
    v_cvt_pk_bf16_f32 v83, v86, v87
    v_cvt_pk_bf16_f32 v84, v88, v89
    v_mfma_f32_32x32x16_bf16 v[48:63], v[24:27], v[248:251], v[48:63]
    s_waitcnt lgkmcnt(4)
    ds_read_b64_tr_b16 v[24:25], v8 offset:53248
    ds_read_b64_tr_b16 v[26:27], v8 offset:53760
    v_cvt_pk_bf16_f32 v85, v90, v91
    v_cvt_pk_bf16_f32 v86, v92, v93
    v_cvt_pk_bf16_f32 v87, v94, v95
    v_mad_u32_u24 v11, v0, s71, v15
    buffer_store_dwordx2 v[70:71], v11, s[20:23], s55 offen sc1
    v_mfma_f32_32x32x16_bf16 v[48:63], v[28:31], v[252:255], v[48:63]
    s_waitcnt lgkmcnt(4)
    ds_read_b64_tr_b16 v[28:29], v8 offset:55296
    ds_read_b64_tr_b16 v[30:31], v8 offset:55808
    v_mfma_f32_32x32x16_bf16 v[32:47], v[16:19], v[96:99], 0
    s_waitcnt lgkmcnt(4)
    ds_read_b64_tr_b16 v[16:17], v8 offset:57344
    ds_read_b64_tr_b16 v[18:19], v8 offset:57856
    v_mfma_f32_32x32x16_bf16 v[32:47], v[20:23], v[100:103], v[32:47]
    s_waitcnt lgkmcnt(4)
    ds_read_b64_tr_b16 v[20:21], v8 offset:59392
    ds_read_b64_tr_b16 v[22:23], v8 offset:59904
    v_cvt_pk_bf16_f32 v88, v48, v49
    v_cvt_pk_bf16_f32 v89, v50, v51
    v_cvt_pk_bf16_f32 v90, v52, v53
    v_cvt_pk_bf16_f32 v91, v54, v55
    v_cvt_pk_bf16_f32 v92, v56, v57
    v_mad_u32_u24 v10, v0, s60, v15
    buffer_store_dwordx2 v[72:73], v10, s[20:23], s44 offen sc1
    v_mov_b32 v13, 147456
    ds_read_b32 v14, v13
    v_mfma_f32_32x32x16_bf16 v[32:47], v[24:27], v[104:107], v[32:47]
    s_waitcnt lgkmcnt(5)
    ds_read_b64_tr_b16 v[24:25], v8 offset:61440
    ds_read_b64_tr_b16 v[26:27], v8 offset:61952
    v_cvt_pk_bf16_f32 v93, v58, v59
    v_cvt_pk_bf16_f32 v94, v60, v61
    v_cvt_pk_bf16_f32 v95, v62, v63
    v_mfma_f32_32x32x16_bf16 v[32:47], v[28:31], v[108:111], v[32:47]
    s_waitcnt lgkmcnt(5)
    ds_read_b64_tr_b16 v[28:29], v8 offset:63488
    ds_read_b64_tr_b16 v[30:31], v8 offset:64000
    v_mfma_f32_32x32x16_bf16 v[32:47], v[16:19], v[112:115], v[32:47]
    s_waitcnt lgkmcnt(5)
    ds_read_b64_tr_b16 v[16:17], v9 offset:49152
    ds_read_b64_tr_b16 v[18:19], v9 offset:49664
    v_mad_u32_u24 v11, v0, s61, v15
    buffer_store_dwordx2 v[74:75], v11, s[20:23], s45 offen sc1
    v_mfma_f32_32x32x16_bf16 v[32:47], v[20:23], v[116:119], v[32:47]
    s_waitcnt lgkmcnt(4)
    ds_read_b64_tr_b16 v[20:21], v9 offset:51200
    ds_read_b64_tr_b16 v[22:23], v9 offset:51712
    v_mfma_f32_32x32x16_bf16 v[32:47], v[24:27], v[120:123], v[32:47]
    s_waitcnt lgkmcnt(4)
    ds_read_b64_tr_b16 v[24:25], v9 offset:53248
    ds_read_b64_tr_b16 v[26:27], v9 offset:53760
    v_mfma_f32_32x32x16_bf16 v[32:47], v[28:31], v[124:127], v[32:47]
    s_waitcnt lgkmcnt(4)
    ds_read_b64_tr_b16 v[28:29], v9 offset:55296
    ds_read_b64_tr_b16 v[30:31], v9 offset:55808
    v_mad_u32_u24 v10, v0, s62, v15
    buffer_store_dwordx2 v[76:77], v10, s[20:23], s46 offen sc1
    v_readfirstlane_b32 s17, v14
    s_add_u32 s17, s17, 3
    v_mfma_f32_32x32x16_bf16 v[48:63], v[16:19], v[96:99], 0
    s_waitcnt lgkmcnt(4)
    ds_read_b64_tr_b16 v[16:17], v9 offset:57344
    ds_read_b64_tr_b16 v[18:19], v9 offset:57856
    v_mfma_f32_32x32x16_bf16 v[48:63], v[20:23], v[100:103], v[48:63]
    s_waitcnt lgkmcnt(4)
    ds_read_b64_tr_b16 v[20:21], v9 offset:59392
    ds_read_b64_tr_b16 v[22:23], v9 offset:59904
    v_mfma_f32_32x32x16_bf16 v[48:63], v[24:27], v[104:107], v[48:63]
    s_waitcnt lgkmcnt(4)
    ds_read_b64_tr_b16 v[24:25], v9 offset:61440
    ds_read_b64_tr_b16 v[26:27], v9 offset:61952
    v_mad_u32_u24 v11, v0, s63, v15
    buffer_store_dwordx2 v[78:79], v11, s[20:23], s47 offen sc1
    v_mfma_f32_32x32x16_bf16 v[48:63], v[28:31], v[108:111], v[48:63]
    s_waitcnt lgkmcnt(4)
    ds_read_b64_tr_b16 v[28:29], v9 offset:63488
    ds_read_b64_tr_b16 v[30:31], v9 offset:64000
    v_mfma_f32_32x32x16_bf16 v[48:63], v[16:19], v[112:115], v[48:63]
    s_barrier
    ds_read_b64_tr_b16 v[16:17], v4 offset:0
    ds_read_b64_tr_b16 v[18:19], v4 offset:512
    s_waitcnt lgkmcnt(6)
    v_mfma_f32_32x32x16_bf16 v[48:63], v[20:23], v[116:119], v[48:63]
    s_waitcnt lgkmcnt(4)
    ds_read_b64_tr_b16 v[20:21], v4 offset:2048
    ds_read_b64_tr_b16 v[22:23], v4 offset:2560
    v_mad_u32_u24 v10, v0, s72, v15
    buffer_store_dwordx2 v[80:81], v10, s[20:23], s56 offen sc1
    v_mfma_f32_32x32x16_bf16 v[48:63], v[24:27], v[120:123], v[48:63]
    s_waitcnt lgkmcnt(4)
    ds_read_b64_tr_b16 v[24:25], v5 offset:0
    ds_read_b64_tr_b16 v[26:27], v5 offset:512
    v_mfma_f32_32x32x16_bf16 v[48:63], v[28:31], v[124:127], v[48:63]
    s_waitcnt lgkmcnt(4)
    ds_read_b64_tr_b16 v[28:29], v5 offset:2048
    ds_read_b64_tr_b16 v[30:31], v5 offset:2560
    v_mfma_f32_32x32x16_bf16 v[32:47], v[16:19], v[128:131], v[32:47]
    s_waitcnt lgkmcnt(4)
    ds_read_b64_tr_b16 v[16:17], v4 offset:4096
    ds_read_b64_tr_b16 v[18:19], v4 offset:4608
    v_mad_u32_u24 v11, v0, s73, v15
    buffer_store_dwordx2 v[82:83], v11, s[20:23], s57 offen sc1
    v_mfma_f32_32x32x16_bf16 v[32:47], v[20:23], v[132:135], v[32:47]
    s_waitcnt lgkmcnt(4)
    ds_read_b64_tr_b16 v[20:21], v4 offset:6144
    ds_read_b64_tr_b16 v[22:23], v4 offset:6656
    v_mfma_f32_32x32x16_bf16 v[48:63], v[24:27], v[128:131], v[48:63]
    s_waitcnt lgkmcnt(4)
    ds_read_b64_tr_b16 v[24:25], v5 offset:4096
    ds_read_b64_tr_b16 v[26:27], v5 offset:4608
    v_mfma_f32_32x32x16_bf16 v[48:63], v[28:31], v[132:135], v[48:63]
    s_waitcnt lgkmcnt(4)
    ds_read_b64_tr_b16 v[28:29], v5 offset:6144
    ds_read_b64_tr_b16 v[30:31], v5 offset:6656
    v_mad_u32_u24 v10, v0, s74, v15
    buffer_store_dwordx2 v[84:85], v10, s[20:23], s58 offen sc1
    v_mfma_f32_32x32x16_bf16 v[32:47], v[16:19], v[136:139], v[32:47]
    s_waitcnt lgkmcnt(4)
    ds_read_b64_tr_b16 v[16:17], v4 offset:8192
    ds_read_b64_tr_b16 v[18:19], v4 offset:8704
    v_mfma_f32_32x32x16_bf16 v[32:47], v[20:23], v[140:143], v[32:47]
    s_waitcnt lgkmcnt(4)
    ds_read_b64_tr_b16 v[20:21], v4 offset:10240
    ds_read_b64_tr_b16 v[22:23], v4 offset:10752
    v_mfma_f32_32x32x16_bf16 v[48:63], v[24:27], v[136:139], v[48:63]
    s_waitcnt lgkmcnt(4)
    ds_read_b64_tr_b16 v[24:25], v5 offset:8192
    ds_read_b64_tr_b16 v[26:27], v5 offset:8704
    v_mad_u32_u24 v11, v0, s75, v15
    buffer_store_dwordx2 v[86:87], v11, s[20:23], s59 offen sc1
    v_mfma_f32_32x32x16_bf16 v[48:63], v[28:31], v[140:143], v[48:63]
    s_waitcnt lgkmcnt(4)
    ds_read_b64_tr_b16 v[28:29], v5 offset:10240
    ds_read_b64_tr_b16 v[30:31], v5 offset:10752
    v_mfma_f32_32x32x16_bf16 v[32:47], v[16:19], v[144:147], v[32:47]
    s_waitcnt lgkmcnt(4)
    ds_read_b64_tr_b16 v[16:17], v4 offset:12288
    ds_read_b64_tr_b16 v[18:19], v4 offset:12800
    v_mfma_f32_32x32x16_bf16 v[32:47], v[20:23], v[148:151], v[32:47]
    s_waitcnt lgkmcnt(4)
    ds_read_b64_tr_b16 v[20:21], v4 offset:14336
    ds_read_b64_tr_b16 v[22:23], v4 offset:14848
    v_mad_u32_u24 v10, v0, s64, v15
    buffer_store_dwordx2 v[88:89], v10, s[20:23], s48 offen sc1
    v_mfma_f32_32x32x16_bf16 v[48:63], v[24:27], v[144:147], v[48:63]
    s_waitcnt lgkmcnt(4)
    ds_read_b64_tr_b16 v[24:25], v5 offset:12288
    ds_read_b64_tr_b16 v[26:27], v5 offset:12800
    v_mfma_f32_32x32x16_bf16 v[48:63], v[28:31], v[148:151], v[48:63]
    s_waitcnt lgkmcnt(4)
    ds_read_b64_tr_b16 v[28:29], v5 offset:14336
    ds_read_b64_tr_b16 v[30:31], v5 offset:14848
    v_mfma_f32_32x32x16_bf16 v[32:47], v[16:19], v[152:155], v[32:47]
    s_waitcnt lgkmcnt(4)
    ds_read_b64_tr_b16 v[16:17], v4 offset:16384
    ds_read_b64_tr_b16 v[18:19], v4 offset:16896
    v_mad_u32_u24 v11, v0, s65, v15
    buffer_store_dwordx2 v[90:91], v11, s[20:23], s49 offen sc1
    v_mfma_f32_32x32x16_bf16 v[32:47], v[20:23], v[156:159], v[32:47]
    s_waitcnt lgkmcnt(4)
    ds_read_b64_tr_b16 v[20:21], v4 offset:18432
    ds_read_b64_tr_b16 v[22:23], v4 offset:18944
    v_mfma_f32_32x32x16_bf16 v[48:63], v[24:27], v[152:155], v[48:63]
    s_waitcnt lgkmcnt(4)
    ds_read_b64_tr_b16 v[24:25], v5 offset:16384
    ds_read_b64_tr_b16 v[26:27], v5 offset:16896
    v_mfma_f32_32x32x16_bf16 v[48:63], v[28:31], v[156:159], v[48:63]
    s_waitcnt lgkmcnt(4)
    ds_read_b64_tr_b16 v[28:29], v5 offset:18432
    ds_read_b64_tr_b16 v[30:31], v5 offset:18944
    v_mad_u32_u24 v10, v0, s66, v15
    buffer_store_dwordx2 v[92:93], v10, s[20:23], s50 offen sc1
    v_mfma_f32_32x32x16_bf16 v[32:47], v[16:19], v[160:163], v[32:47]
    s_waitcnt lgkmcnt(4)
    ds_read_b64_tr_b16 v[16:17], v4 offset:20480
    ds_read_b64_tr_b16 v[18:19], v4 offset:20992
    v_mfma_f32_32x32x16_bf16 v[32:47], v[20:23], v[164:167], v[32:47]
    s_waitcnt lgkmcnt(4)
    ds_read_b64_tr_b16 v[20:21], v4 offset:22528
    ds_read_b64_tr_b16 v[22:23], v4 offset:23040
    v_mfma_f32_32x32x16_bf16 v[48:63], v[24:27], v[160:163], v[48:63]
    s_waitcnt lgkmcnt(4)
    ds_read_b64_tr_b16 v[24:25], v5 offset:20480
    ds_read_b64_tr_b16 v[26:27], v5 offset:20992
    v_mad_u32_u24 v11, v0, s67, v15
    buffer_store_dwordx2 v[94:95], v11, s[20:23], s51 offen sc1
    v_mfma_f32_32x32x16_bf16 v[48:63], v[28:31], v[164:167], v[48:63]
    s_waitcnt lgkmcnt(4)
    ds_read_b64_tr_b16 v[28:29], v5 offset:22528
    ds_read_b64_tr_b16 v[30:31], v5 offset:23040
    v_mfma_f32_32x32x16_bf16 v[32:47], v[16:19], v[168:171], v[32:47]
    s_waitcnt lgkmcnt(4)
    ds_read_b64_tr_b16 v[16:17], v4 offset:24576
    ds_read_b64_tr_b16 v[18:19], v4 offset:25088
    v_mfma_f32_32x32x16_bf16 v[32:47], v[20:23], v[172:175], v[32:47]
    s_waitcnt lgkmcnt(4)
    ds_read_b64_tr_b16 v[20:21], v4 offset:26624
    ds_read_b64_tr_b16 v[22:23], v4 offset:27136
    v_mfma_f32_32x32x16_bf16 v[48:63], v[24:27], v[168:171], v[48:63]
    s_waitcnt lgkmcnt(4)
    ds_read_b64_tr_b16 v[24:25], v5 offset:24576
    ds_read_b64_tr_b16 v[26:27], v5 offset:25088
    v_mfma_f32_32x32x16_bf16 v[48:63], v[28:31], v[172:175], v[48:63]
    s_waitcnt lgkmcnt(4)
    ds_read_b64_tr_b16 v[28:29], v5 offset:26624
    ds_read_b64_tr_b16 v[30:31], v5 offset:27136
    v_mfma_f32_32x32x16_bf16 v[32:47], v[16:19], v[176:179], v[32:47]
    s_waitcnt lgkmcnt(4)
    ds_read_b64_tr_b16 v[16:17], v4 offset:28672
    ds_read_b64_tr_b16 v[18:19], v4 offset:29184
    v_mfma_f32_32x32x16_bf16 v[32:47], v[20:23], v[180:183], v[32:47]
    s_waitcnt lgkmcnt(4)
    ds_read_b64_tr_b16 v[20:21], v4 offset:30720
    ds_read_b64_tr_b16 v[22:23], v4 offset:31232
    v_mfma_f32_32x32x16_bf16 v[48:63], v[24:27], v[176:179], v[48:63]
    s_waitcnt lgkmcnt(4)
    ds_read_b64_tr_b16 v[24:25], v5 offset:28672
    ds_read_b64_tr_b16 v[26:27], v5 offset:29184
    v_mfma_f32_32x32x16_bf16 v[48:63], v[28:31], v[180:183], v[48:63]
    s_branch PA_JOIN
    s_nop 0
    s_nop 0
    s_nop 0
    s_nop 0
    s_nop 0
    s_nop 0
    s_nop 0
    s_nop 0
    s_nop 0
    s_nop 0
    s_nop 0
    s_nop 0
    s_nop 0
    s_nop 0
    s_nop 0
    s_nop 0
    s_nop 0
    s_nop 0
    s_nop 0
    s_nop 0
    s_nop 0
    s_nop 0
    s_nop 0
    s_nop 0
    s_nop 0
    s_nop 0
    s_nop 0
    s_nop 0
    s_nop 0
    s_nop 0
    s_nop 0
    s_nop 0
    s_nop 0
    s_nop 0
    s_nop 0
    s_nop 0
    s_nop 0
    s_nop 0
    s_nop 0
    s_nop 0
    s_nop 0
    s_nop 0
    s_nop 0
    s_nop 0
    s_nop 0
    s_nop 0
    s_nop 0
    s_nop 0
    s_nop 0
    s_nop 0
    s_nop 0
    s_nop 0
    s_nop 0
    s_nop 0
    s_nop 0
    s_nop 0
    s_nop 0
    s_nop 0
    s_nop 0
    s_nop 0
    s_nop 0
    s_nop 0
    s_nop 0
    s_nop 0
    s_nop 0
    s_nop 0
    s_nop 0
    s_nop 0
    s_nop 0
    s_nop 0
    s_nop 0
    s_nop 0
    s_nop 0
    s_nop 0
    s_nop 0
    s_nop 0
    s_nop 0
    s_nop 0
    s_nop 0
    s_nop 0
    s_nop 0
    s_nop 0
    s_nop 0
    s_nop 0
    s_nop 0
    s_nop 0
    s_nop 0
    s_nop 0
    s_nop 0
    s_nop 0
    s_nop 0
    s_nop 0
    s_nop 0
    s_nop 0
    s_nop 0
    s_nop 0
    s_nop 0
    s_nop 0
    s_nop 0
    s_nop 0
    s_nop 0
    s_nop 0
    s_nop 0
    s_nop 0
    s_nop 0
    s_nop 0
    s_nop 0
    s_nop 0
    s_nop 0
    s_nop 0
    s_nop 0
    s_nop 0
    s_nop 0
    s_nop 0
    s_nop 0
    s_nop 0
    s_nop 0
    s_nop 0
    s_nop 0
    s_nop 0
    s_nop 0
    s_nop 0
    s_nop 0
    s_nop 0
    s_nop 0
    s_nop 0
    s_nop 0
    s_nop 0
    s_nop 0
    s_nop 0
    s_nop 0
    s_nop 0
    s_nop 0
    s_nop 0
    s_nop 0
    s_nop 0
    s_nop 0
    s_nop 0
    s_nop 0
    s_nop 0
    s_nop 0
    s_nop 0
    s_nop 0
    s_nop 0
    s_nop 0
    s_nop 0
    s_nop 0
    s_nop 0
    s_nop 0
    s_nop 0
    s_nop 0
    s_nop 0
    s_nop 0
    s_nop 0
    s_nop 0
    s_nop 0
    s_nop 0
    s_nop 0
    s_nop 0
    s_nop 0
    s_nop 0
    s_nop 0
    s_nop 0
    s_nop 0
    s_nop 0
    s_nop 0
    s_nop 0
    s_nop 0
    s_nop 0
    s_nop 0
    s_nop 0
    s_nop 0
    s_nop 0
    s_nop 0
    s_nop 0
    s_nop 0
    s_nop 0
    s_nop 0
    s_nop 0
    s_nop 0
    s_nop 0
    s_nop 0
    s_nop 0
    s_nop 0
    s_nop 0
    s_nop 0
    s_nop 0
    s_nop 0
    s_nop 0
    s_nop 0
    s_nop 0
    s_nop 0
    s_nop 0
    s_nop 0
    s_nop 0
    s_nop 0
    s_nop 0
    s_nop 0
    s_nop 0
    s_nop 0
    s_nop 0
    s_nop 0
    s_nop 0
    s_nop 0
    s_nop 0
    s_nop 0
    s_nop 0
    s_nop 0
    s_nop 0
    s_nop 0
    s_nop 0
    s_nop 0
    s_nop 0
    s_nop 0
    s_nop 0
    s_nop 0
    s_nop 0
    s_nop 0
    s_nop 0
    s_nop 0
    s_nop 0
    s_nop 0
    s_nop 0
    s_nop 0
    s_nop 0
    s_nop 0
    s_nop 0
    s_nop 0
    s_nop 0
    s_nop 0
    s_nop 0
    s_nop 0
    s_nop 0
    s_nop 0
    s_nop 0
    s_nop 0
    s_nop 0
    s_nop 0
    s_nop 0
    s_nop 0
    s_nop 0
    s_nop 0
    s_nop 0
    s_nop 0
    s_nop 0
    s_nop 0
    s_nop 0
    s_nop 0
    s_nop 0
    s_nop 0
    s_nop 0
    s_nop 0
    s_nop 0
    s_nop 0
    s_nop 0
    s_nop 0
    s_nop 0
    s_nop 0
    s_nop 0
    s_nop 0
    s_nop 0
    s_nop 0
    s_nop 0
    s_nop 0
    s_nop 0
    s_nop 0
    s_nop 0
    s_nop 0
    s_nop 0
    s_nop 0
    s_nop 0
    s_nop 0
    s_nop 0
    s_nop 0
    s_nop 0
    s_nop 0
    s_nop 0
    s_nop 0
    s_nop 0
    s_nop 0
    s_nop 0
    s_nop 0
    s_nop 0
    s_nop 0
    s_nop 0
    s_nop 0
    s_nop 0
    s_nop 0
    s_nop 0
    s_nop 0
    s_nop 0
    s_nop 0
    s_nop 0
    s_nop 0
    s_nop 0
    s_nop 0
    s_nop 0
    s_nop 0
    s_nop 0
    s_nop 0
    s_nop 0
    s_nop 0
    s_nop 0
    s_nop 0
    s_nop 0
    s_nop 0
    s_nop 0
    s_nop 0
    s_nop 0
    s_nop 0
    s_nop 0
    s_nop 0
    s_nop 0
    s_nop 0
    s_nop 0
    s_nop 0
    s_nop 0
    s_nop 0
    s_nop 0
    s_nop 0
    s_nop 0
    s_nop 0
    s_nop 0
    s_nop 0
    s_nop 0
    s_nop 0
    s_nop 0
    s_nop 0
    s_nop 0
    s_nop 0
    s_nop 0
    s_nop 0
    s_nop 0
    s_nop 0
    s_nop 0
    s_nop 0
    s_nop 0
    s_nop 0
    s_nop 0
    s_nop 0
    s_nop 0
    s_nop 0
    s_nop 0
    s_nop 0
    s_nop 0
    s_nop 0
    s_nop 0
    s_nop 0
    s_nop 0
    s_nop 0
    s_nop 0
    s_nop 0
    s_nop 0
    s_nop 0
    s_nop 0
    s_nop 0
    s_nop 0
    s_nop 0
    s_nop 0
    s_nop 0
    s_nop 0
    s_nop 0
    s_nop 0
    s_nop 0
    s_nop 0
    s_nop 0
    s_nop 0
    s_nop 0
    s_nop 0
    s_nop 0
    s_nop 0
    s_nop 0
    s_nop 0
    s_nop 0
    s_nop 0
    s_nop 0
    s_nop 0
    s_nop 0
    s_nop 0
    s_nop 0
    s_nop 0
    s_nop 0
    s_nop 0
    s_nop 0
    s_nop 0
    s_nop 0
PAD_4:
    s_branch PAD_8
    s_nop 0
    s_nop 0
    s_nop 0
    s_nop 0
    s_nop 0
    s_nop 0
    s_nop 0
    s_nop 0
    s_nop 0
    s_nop 0
    s_nop 0
    s_nop 0
    s_nop 0
    s_nop 0
    s_nop 0
    s_nop 0
    s_nop 0
    s_nop 0
    s_nop 0
    s_nop 0
    s_nop 0
    s_nop 0
    s_nop 0
    s_nop 0
    s_nop 0
    s_nop 0
    s_nop 0
    s_nop 0
    s_nop 0
    s_nop 0
    s_nop 0
    s_nop 0
    s_nop 0
    s_nop 0
    s_nop 0
    s_nop 0
    s_nop 0
    s_nop 0
    s_nop 0
    s_nop 0
    s_nop 0
    s_nop 0
    s_nop 0
    s_nop 0
    s_nop 0
    s_nop 0
    s_nop 0
    s_nop 0
    s_nop 0
    s_nop 0
    s_nop 0
    s_nop 0
    s_nop 0
    s_nop 0
    s_nop 0
    s_nop 0
    s_nop 0
    s_nop 0
    s_nop 0
    s_nop 0
    s_nop 0
    s_nop 0
    s_nop 0
    s_nop 0
    s_nop 0
    s_nop 0
    s_nop 0
    s_nop 0
    s_nop 0
    s_nop 0
    s_nop 0
    s_nop 0
    s_nop 0
    s_nop 0
    s_nop 0
    s_nop 0
    s_nop 0
    s_nop 0
    s_nop 0
    s_nop 0
    s_nop 0
    s_nop 0
    s_nop 0
    s_nop 0
    s_nop 0
    s_nop 0
    s_nop 0
    s_nop 0
    s_nop 0
    s_nop 0
    s_nop 0
    s_nop 0
    s_nop 0
    s_nop 0
    s_nop 0
    s_nop 0
    s_nop 0
    s_nop 0
    s_nop 0
    s_nop 0
    s_nop 0
    s_nop 0
    s_nop 0
    s_nop 0
    s_nop 0
    s_nop 0
    s_nop 0
    s_nop 0
    s_nop 0
    s_nop 0
    s_nop 0
    s_nop 0
    s_nop 0
    s_nop 0
    s_nop 0
    s_nop 0
    s_nop 0
    s_nop 0
    s_nop 0
    s_nop 0
    s_nop 0
    s_nop 0
    s_nop 0
    s_nop 0
    s_nop 0
    s_nop 0
    s_nop 0
    s_nop 0
    s_nop 0
    s_nop 0
    s_nop 0
    s_nop 0
    s_nop 0
    s_nop 0
    s_nop 0
    s_nop 0
    s_nop 0
    s_nop 0
    s_nop 0
    s_nop 0
    s_nop 0
    s_nop 0
    s_nop 0
    s_nop 0
    s_nop 0
    s_nop 0
    s_nop 0
    s_nop 0
    s_nop 0
    s_nop 0
    s_nop 0
    s_nop 0
    s_nop 0
    s_nop 0
    s_nop 0
    s_nop 0
    s_nop 0
    s_nop 0
    s_nop 0
    s_nop 0
    s_nop 0
    s_nop 0
    s_nop 0
    s_nop 0
    s_nop 0
    s_nop 0
    s_nop 0
    s_nop 0
    s_nop 0
    s_nop 0
    s_nop 0
    s_nop 0
    s_nop 0
    s_nop 0
    s_nop 0
    s_nop 0
    s_nop 0
    s_nop 0
    s_nop 0
    s_nop 0
    s_nop 0
    s_nop 0
    s_nop 0
    s_nop 0
    s_nop 0
    s_nop 0
    s_nop 0
    s_nop 0
    s_nop 0
    s_nop 0
    s_nop 0
    s_nop 0
    s_nop 0
    s_nop 0
    s_nop 0
    s_nop 0
    s_nop 0
    s_nop 0
    s_nop 0
    s_nop 0
    s_nop 0
    s_nop 0
    s_nop 0
    s_nop 0
    s_nop 0
    s_nop 0
    s_nop 0
    s_nop 0
    s_nop 0
    s_nop 0
    s_nop 0
    s_nop 0
    s_nop 0
    s_nop 0
    s_nop 0
    s_nop 0
    s_nop 0
    s_nop 0
    s_nop 0
    s_nop 0
    s_nop 0
    s_nop 0
    s_nop 0
    s_nop 0
    s_nop 0
    s_nop 0
    s_nop 0
    s_nop 0
    s_nop 0
    s_nop 0
    s_nop 0
    s_nop 0
    s_nop 0
    s_nop 0
    s_nop 0
PA_V:
    s_mul_i32 s45, s32, 1664
    s_add_u32 s45, s45, s27
    s_add_u32 s45, s45, 8192
    s_mov_b32 s27, 0x00020000
    s_mov_b32 s44, 171712
    s_sub_u32 s3, s79, 10
    s_lshl_b32 s3, s3, 7
    v_add_u32 v15, s3, v2
    v_mul_u32_u24 v0, 320, v0
    v_lshrrev_b32 v13, 2, v1
    v_add_u32 v13, s16, v13
    v_mul_u32_u24 v13, 172032, v13
    v_and_b32 v14, 3, v1
    v_lshl_add_u32 v13, v14, 4, v13
    v_mov_b32 v35, 0x3f803f80
    v_cmp_gt_u32 vcc, 2, v14
    v_cndmask_b32 v32, 0, v35, vcc
    v_cmp_eq_u32 vcc, 1, v14
    v_and_b32 v14, 0xffff, v32
    v_cndmask_b32 v33, v14, v35, vcc
    v_cndmask_b32 v34, 0, v35, vcc
    v_mov_b32 v35, v34
    s_mov_b32 exec_hi, 0
    buffer_store_dwordx4 v[32:35], v13, s[20:23], s45 offen offset:1536 sc1
    s_mov_b64 exec, -1
    v_lshlrev_b32 v1, 4, v1
    s_barrier
    v_xor_b32 v13, 65536, v12
    ds_read_b128 v[96:99], v13
    ds_read_b64_tr_b16 v[16:17], v6 offset:16384
    ds_read_b64_tr_b16 v[18:19], v6 offset:16896
    ds_read_b64_tr_b16 v[20:21], v7 offset:16384
    ds_read_b64_tr_b16 v[22:23], v7 offset:16896
    ds_read_b64_tr_b16 v[24:25], v6 offset:20480
    ds_read_b64_tr_b16 v[26:27], v6 offset:20992
    ds_read_b64_tr_b16 v[28:29], v7 offset:20480
    ds_read_b64_tr_b16 v[30:31], v7 offset:20992
    s_waitcnt lgkmcnt(6)
    v_mfma_f32_32x32x16_bf16 v[32:47], v[96:99], v[16:19], 0
    s_waitcnt lgkmcnt(4)
    v_xor_b32 v14, 65568, v12
    ds_read_b128 v[100:103], v14
    ds_read_b64_tr_b16 v[16:17], v6 offset:18432
    ds_read_b64_tr_b16 v[18:19], v6 offset:18944
    v_mfma_f32_32x32x16_bf16 v[48:63], v[96:99], v[20:23], 0
    s_waitcnt lgkmcnt(5)
    ds_read_b64_tr_b16 v[20:21], v7 offset:18432
    ds_read_b64_tr_b16 v[22:23], v7 offset:18944
    v_mfma_f32_32x32x16_bf16 v[64:79], v[96:99], v[24:27], 0
    s_waitcnt lgkmcnt(5)
    ds_read_b64_tr_b16 v[24:25], v6 offset:22528
    ds_read_b64_tr_b16 v[26:27], v6 offset:23040
    v_mfma_f32_32x32x16_bf16 v[80:95], v[96:99], v[28:31], 0
    s_waitcnt lgkmcnt(4)
    ds_read_b64_tr_b16 v[28:29], v7 offset:22528
    ds_read_b64_tr_b16 v[30:31], v7 offset:23040
    v_mfma_f32_32x32x16_bf16 v[32:47], v[100:103], v[16:19], v[32:47]
    s_waitcnt lgkmcnt(4)
    v_xor_b32 v13, 65600, v12
    ds_read_b128 v[104:107], v13
    ds_read_b64_tr_b16 v[16:17], v6 offset:24576
    ds_read_b64_tr_b16 v[18:19], v6 offset:25088
    v_mfma_f32_32x32x16_bf16 v[48:63], v[100:103], v[20:23], v[48:63]
    s_waitcnt lgkmcnt(5)
    ds_read_b64_tr_b16 v[20:21], v7 offset:24576
    ds_read_b64_tr_b16 v[22:23], v7 offset:25088
    v_mfma_f32_32x32x16_bf16 v[64:79], v[100:103], v[24:27], v[64:79]
    s_waitcnt lgkmcnt(5)
    ds_read_b64_tr_b16 v[24:25], v6 offset:28672
    ds_read_b64_tr_b16 v[26:27], v6 offset:29184
    v_mfma_f32_32x32x16_bf16 v[80:95], v[100:103], v[28:31], v[80:95]
    s_waitcnt lgkmcnt(4)
    ds_read_b64_tr_b16 v[28:29], v7 offset:28672
    ds_read_b64_tr_b16 v[30:31], v7 offset:29184
    v_mfma_f32_32x32x16_bf16 v[32:47], v[104:107], v[16:19], v[32:47]
    s_waitcnt lgkmcnt(4)
    v_xor_b32 v14, 65632, v12
    ds_read_b128 v[108:111], v14
    ds_read_b64_tr_b16 v[16:17], v6 offset:26624
    ds_read_b64_tr_b16 v[18:19], v6 offset:27136
    v_mfma_f32_32x32x16_bf16 v[48:63], v[104:107], v[20:23], v[48:63]
    s_waitcnt lgkmcnt(5)
    ds_read_b64_tr_b16 v[20:21], v7 offset:26624
    ds_read_b64_tr_b16 v[22:23], v7 offset:27136
    v_mfma_f32_32x32x16_bf16 v[64:79], v[104:107], v[24:27], v[64:79]
    s_waitcnt lgkmcnt(5)
    ds_read_b64_tr_b16 v[24:25], v6 offset:30720
    ds_read_b64_tr_b16 v[26:27], v6 offset:31232
    v_mfma_f32_32x32x16_bf16 v[80:95], v[104:107], v[28:31], v[80:95]
    s_waitcnt lgkmcnt(4)
    ds_read_b64_tr_b16 v[28:29], v7 offset:30720
    ds_read_b64_tr_b16 v[30:31], v7 offset:31232
    v_mfma_f32_32x32x16_bf16 v[32:47], v[108:111], v[16:19], v[32:47]
    s_barrier
    s_waitcnt vmcnt(0)
    v_xor_b32 v13, 98304, v12
    ds_read_b128 v[112:115], v13
    ds_read_b64_tr_b16 v[16:17], v8 offset:16384
    ds_read_b64_tr_b16 v[18:19], v8 offset:16896
    s_waitcnt lgkmcnt(7)
    v_mfma_f32_32x32x16_bf16 v[48:63], v[108:111], v[20:23], v[48:63]
    s_waitcnt lgkmcnt(5)
    ds_read_b64_tr_b16 v[20:21], v9 offset:16384
    ds_read_b64_tr_b16 v[22:23], v9 offset:16896
    v_mfma_f32_32x32x16_bf16 v[64:79], v[108:111], v[24:27], v[64:79]
    s_waitcnt lgkmcnt(5)
    ds_read_b64_tr_b16 v[24:25], v8 offset:20480
    ds_read_b64_tr_b16 v[26:27], v8 offset:20992
    v_mfma_f32_32x32x16_bf16 v[80:95], v[108:111], v[28:31], v[80:95]
    s_waitcnt lgkmcnt(4)
    ds_read_b64_tr_b16 v[28:29], v9 offset:20480
    ds_read_b64_tr_b16 v[30:31], v9 offset:20992
    v_mfma_f32_32x32x16_bf16 v[32:47], v[112:115], v[16:19], v[32:47]
    s_waitcnt lgkmcnt(4)
    v_xor_b32 v14, 98336, v12
    ds_read_b128 v[116:119], v14
    ds_read_b64_tr_b16 v[16:17], v8 offset:18432
    ds_read_b64_tr_b16 v[18:19], v8 offset:18944
    v_mfma_f32_32x32x16_bf16 v[48:63], v[112:115], v[20:23], v[48:63]
    s_waitcnt lgkmcnt(5)
    ds_read_b64_tr_b16 v[20:21], v9 offset:18432
    ds_read_b64_tr_b16 v[22:23], v9 offset:18944
    v_mfma_f32_32x32x16_bf16 v[64:79], v[112:115], v[24:27], v[64:79]
    s_waitcnt lgkmcnt(5)
    ds_read_b64_tr_b16 v[24:25], v8 offset:22528
    ds_read_b64_tr_b16 v[26:27], v8 offset:23040
    v_mfma_f32_32x32x16_bf16 v[80:95], v[112:115], v[28:31], v[80:95]
    s_waitcnt lgkmcnt(4)
    ds_read_b64_tr_b16 v[28:29], v9 offset:22528
    ds_read_b64_tr_b16 v[30:31], v9 offset:23040
    v_mfma_f32_32x32x16_bf16 v[32:47], v[116:119], v[16:19], v[32:47]
    s_waitcnt lgkmcnt(4)
    v_xor_b32 v13, 98368, v12
    ds_read_b128 v[120:123], v13
    ds_read_b64_tr_b16 v[16:17], v8 offset:24576
    ds_read_b64_tr_b16 v[18:19], v8 offset:25088
    v_mfma_f32_32x32x16_bf16 v[48:63], v[116:119], v[20:23], v[48:63]
    s_waitcnt lgkmcnt(5)
    ds_read_b64_tr_b16 v[20:21], v9 offset:24576
    ds_read_b64_tr_b16 v[22:23], v9 offset:25088
    v_mfma_f32_32x32x16_bf16 v[64:79], v[116:119], v[24:27], v[64:79]
    s_waitcnt lgkmcnt(5)
    ds_read_b64_tr_b16 v[24:25], v8 offset:28672
    ds_read_b64_tr_b16 v[26:27], v8 offset:29184
    v_mfma_f32_32x32x16_bf16 v[80:95], v[116:119], v[28:31], v[80:95]
    s_waitcnt lgkmcnt(4)
    ds_read_b64_tr_b16 v[28:29], v9 offset:28672
    ds_read_b64_tr_b16 v[30:31], v9 offset:29184
    v_mfma_f32_32x32x16_bf16 v[32:47], v[120:123], v[16:19], v[32:47]
    s_waitcnt lgkmcnt(4)
    v_xor_b32 v14, 98400, v12
    ds_read_b128 v[124:127], v14
    ds_read_b64_tr_b16 v[16:17], v8 offset:26624
    ds_read_b64_tr_b16 v[18:19], v8 offset:27136
    v_mfma_f32_32x32x16_bf16 v[48:63], v[120:123], v[20:23], v[48:63]
    s_waitcnt lgkmcnt(5)
    ds_read_b64_tr_b16 v[20:21], v9 offset:26624
    ds_read_b64_tr_b16 v[22:23], v9 offset:27136
    v_mfma_f32_32x32x16_bf16 v[64:79], v[120:123], v[24:27], v[64:79]
    s_waitcnt lgkmcnt(5)
    ds_read_b64_tr_b16 v[24:25], v8 offset:30720
    ds_read_b64_tr_b16 v[26:27], v8 offset:31232
    v_mfma_f32_32x32x16_bf16 v[80:95], v[120:123], v[28:31], v[80:95]
    s_waitcnt lgkmcnt(4)
    ds_read_b64_tr_b16 v[28:29], v9 offset:30720
    ds_read_b64_tr_b16 v[30:31], v9 offset:31232
    v_mfma_f32_32x32x16_bf16 v[32:47], v[124:127], v[16:19], v[32:47]
    s_barrier
    v_xor_b32 v13, 0, v12
    ds_read_b128 v[128:131], v13
    ds_read_b64_tr_b16 v[16:17], v4 offset:16384
    ds_read_b64_tr_b16 v[18:19], v4 offset:16896
    s_waitcnt lgkmcnt(7)
    v_mfma_f32_32x32x16_bf16 v[48:63], v[124:127], v[20:23], v[48:63]
    s_waitcnt lgkmcnt(5)
    ds_read_b64_tr_b16 v[20:21], v5 offset:16384
    ds_read_b64_tr_b16 v[22:23], v5 offset:16896
    v_mfma_f32_32x32x16_bf16 v[64:79], v[124:127], v[24:27], v[64:79]
    s_waitcnt lgkmcnt(5)
    ds_read_b64_tr_b16 v[24:25], v4 offset:20480
    ds_read_b64_tr_b16 v[26:27], v4 offset:20992
    v_mfma_f32_32x32x16_bf16 v[80:95], v[124:127], v[28:31], v[80:95]
    s_waitcnt lgkmcnt(4)
    ds_read_b64_tr_b16 v[28:29], v5 offset:20480
    ds_read_b64_tr_b16 v[30:31], v5 offset:20992
    v_mfma_f32_32x32x16_bf16 v[32:47], v[128:131], v[16:19], v[32:47]
    s_waitcnt lgkmcnt(4)
    v_xor_b32 v14, 32, v12
    ds_read_b128 v[132:135], v14
    ds_read_b64_tr_b16 v[16:17], v4 offset:18432
    ds_read_b64_tr_b16 v[18:19], v4 offset:18944
    v_mfma_f32_32x32x16_bf16 v[48:63], v[128:131], v[20:23], v[48:63]
    s_waitcnt lgkmcnt(5)
    ds_read_b64_tr_b16 v[20:21], v5 offset:18432
    ds_read_b64_tr_b16 v[22:23], v5 offset:18944
    v_mfma_f32_32x32x16_bf16 v[64:79], v[128:131], v[24:27], v[64:79]
    s_waitcnt lgkmcnt(5)
    ds_read_b64_tr_b16 v[24:25], v4 offset:22528
    ds_read_b64_tr_b16 v[26:27], v4 offset:23040
    v_mfma_f32_32x32x16_bf16 v[80:95], v[128:131], v[28:31], v[80:95]
    s_waitcnt lgkmcnt(4)
    ds_read_b64_tr_b16 v[28:29], v5 offset:22528
    ds_read_b64_tr_b16 v[30:31], v5 offset:23040
    v_mfma_f32_32x32x16_bf16 v[32:47], v[132:135], v[16:19], v[32:47]
    s_waitcnt lgkmcnt(4)
    v_xor_b32 v13, 64, v12
    ds_read_b128 v[136:139], v13
    ds_read_b64_tr_b16 v[16:17], v4 offset:24576
    ds_read_b64_tr_b16 v[18:19], v4 offset:25088
    v_mfma_f32_32x32x16_bf16 v[48:63], v[132:135], v[20:23], v[48:63]
    s_waitcnt lgkmcnt(5)
    ds_read_b64_tr_b16 v[20:21], v5 offset:24576
    ds_read_b64_tr_b16 v[22:23], v5 offset:25088
    v_mfma_f32_32x32x16_bf16 v[64:79], v[132:135], v[24:27], v[64:79]
    s_waitcnt lgkmcnt(5)
    ds_read_b64_tr_b16 v[24:25], v4 offset:28672
    ds_read_b64_tr_b16 v[26:27], v4 offset:29184
    v_mfma_f32_32x32x16_bf16 v[80:95], v[132:135], v[28:31], v[80:95]
    s_waitcnt lgkmcnt(4)
    ds_read_b64_tr_b16 v[28:29], v5 offset:28672
    ds_read_b64_tr_b16 v[30:31], v5 offset:29184
    v_mfma_f32_32x32x16_bf16 v[32:47], v[136:139], v[16:19], v[32:47]
    s_waitcnt lgkmcnt(4)
    v_xor_b32 v14, 96, v12
    ds_read_b128 v[140:143], v14
    ds_read_b64_tr_b16 v[16:17], v4 offset:26624
    ds_read_b64_tr_b16 v[18:19], v4 offset:27136
    v_mfma_f32_32x32x16_bf16 v[48:63], v[136:139], v[20:23], v[48:63]
    s_waitcnt lgkmcnt(5)
    ds_read_b64_tr_b16 v[20:21], v5 offset:26624
    ds_read_b64_tr_b16 v[22:23], v5 offset:27136
    v_mfma_f32_32x32x16_bf16 v[64:79], v[136:139], v[24:27], v[64:79]
    s_waitcnt lgkmcnt(5)
    ds_read_b64_tr_b16 v[24:25], v4 offset:30720
    ds_read_b64_tr_b16 v[26:27], v4 offset:31232
    v_mfma_f32_32x32x16_bf16 v[80:95], v[136:139], v[28:31], v[80:95]
    s_waitcnt lgkmcnt(4)
    ds_read_b64_tr_b16 v[28:29], v5 offset:30720
    ds_read_b64_tr_b16 v[30:31], v5 offset:31232
    v_mfma_f32_32x32x16_bf16 v[32:47], v[140:143], v[16:19], v[32:47]
    s_barrier
    v_xor_b32 v13, 32768, v12
    ds_read_b128 v[144:147], v13
    ds_read_b64_tr_b16 v[16:17], v4 offset:49152
    ds_read_b64_tr_b16 v[18:19], v4 offset:49664
    s_waitcnt lgkmcnt(7)
    v_mfma_f32_32x32x16_bf16 v[48:63], v[140:143], v[20:23], v[48:63]
    s_waitcnt lgkmcnt(5)
    ds_read_b64_tr_b16 v[20:21], v5 offset:49152
    ds_read_b64_tr_b16 v[22:23], v5 offset:49664
    v_mfma_f32_32x32x16_bf16 v[64:79], v[140:143], v[24:27], v[64:79]
    s_waitcnt lgkmcnt(5)
    ds_read_b64_tr_b16 v[24:25], v4 offset:53248
    ds_read_b64_tr_b16 v[26:27], v4 offset:53760
    v_mfma_f32_32x32x16_bf16 v[80:95], v[140:143], v[28:31], v[80:95]
    s_waitcnt lgkmcnt(4)
    ds_read_b64_tr_b16 v[28:29], v5 offset:53248
    ds_read_b64_tr_b16 v[30:31], v5 offset:53760
    v_mfma_f32_32x32x16_bf16 v[32:47], v[144:147], v[16:19], v[32:47]
    s_waitcnt lgkmcnt(4)
    v_xor_b32 v14, 32800, v12
    ds_read_b128 v[148:151], v14
    ds_read_b64_tr_b16 v[16:17], v4 offset:51200
    ds_read_b64_tr_b16 v[18:19], v4 offset:51712
    v_mfma_f32_32x32x16_bf16 v[48:63], v[144:147], v[20:23], v[48:63]
    s_waitcnt lgkmcnt(5)
    ds_read_b64_tr_b16 v[20:21], v5 offset:51200
    ds_read_b64_tr_b16 v[22:23], v5 offset:51712
    v_mfma_f32_32x32x16_bf16 v[64:79], v[144:147], v[24:27], v[64:79]
    s_waitcnt lgkmcnt(5)
    ds_read_b64_tr_b16 v[24:25], v4 offset:55296
    ds_read_b64_tr_b16 v[26:27], v4 offset:55808
    v_mfma_f32_32x32x16_bf16 v[80:95], v[144:147], v[28:31], v[80:95]
    s_waitcnt lgkmcnt(4)
    ds_read_b64_tr_b16 v[28:29], v5 offset:55296
    ds_read_b64_tr_b16 v[30:31], v5 offset:55808
    v_mfma_f32_32x32x16_bf16 v[32:47], v[148:151], v[16:19], v[32:47]
    s_waitcnt lgkmcnt(4)
    v_xor_b32 v13, 32832, v12
    ds_read_b128 v[152:155], v13
    ds_read_b64_tr_b16 v[16:17], v4 offset:57344
    ds_read_b64_tr_b16 v[18:19], v4 offset:57856
    v_mfma_f32_32x32x16_bf16 v[48:63], v[148:151], v[20:23], v[48:63]
    s_waitcnt lgkmcnt(5)
    ds_read_b64_tr_b16 v[20:21], v5 offset:57344
    ds_read_b64_tr_b16 v[22:23], v5 offset:57856
    v_mfma_f32_32x32x16_bf16 v[64:79], v[148:151], v[24:27], v[64:79]
    s_waitcnt lgkmcnt(5)
    ds_read_b64_tr_b16 v[24:25], v4 offset:61440
    ds_read_b64_tr_b16 v[26:27], v4 offset:61952
    v_mfma_f32_32x32x16_bf16 v[80:95], v[148:151], v[28:31], v[80:95]
    s_waitcnt lgkmcnt(4)
    ds_read_b64_tr_b16 v[28:29], v5 offset:61440
    ds_read_b64_tr_b16 v[30:31], v5 offset:61952
    v_mfma_f32_32x32x16_bf16 v[32:47], v[152:155], v[16:19], v[32:47]
    s_waitcnt lgkmcnt(4)
    v_xor_b32 v14, 32864, v12
    ds_read_b128 v[156:159], v14
    ds_read_b64_tr_b16 v[16:17], v4 offset:59392
    ds_read_b64_tr_b16 v[18:19], v4 offset:59904
    v_mfma_f32_32x32x16_bf16 v[48:63], v[152:155], v[20:23], v[48:63]
    s_waitcnt lgkmcnt(5)
    ds_read_b64_tr_b16 v[20:21], v5 offset:59392
    ds_read_b64_tr_b16 v[22:23], v5 offset:59904
    v_mfma_f32_32x32x16_bf16 v[64:79], v[152:155], v[24:27], v[64:79]
    s_waitcnt lgkmcnt(5)
    ds_read_b64_tr_b16 v[24:25], v4 offset:63488
    ds_read_b64_tr_b16 v[26:27], v4 offset:64000
    v_mfma_f32_32x32x16_bf16 v[80:95], v[152:155], v[28:31], v[80:95]
    s_waitcnt lgkmcnt(4)
    ds_read_b64_tr_b16 v[28:29], v5 offset:63488
    ds_read_b64_tr_b16 v[30:31], v5 offset:64000
    v_mfma_f32_32x32x16_bf16 v[32:47], v[156:159], v[16:19], v[32:47]
    s_barrier
    v_xor_b32 v13, 65536, v12
    ds_read_b128 v[160:163], v13
    ds_read_b64_tr_b16 v[16:17], v6 offset:16384
    ds_read_b64_tr_b16 v[18:19], v6 offset:16896
    s_waitcnt lgkmcnt(7)
    v_mfma_f32_32x32x16_bf16 v[48:63], v[156:159], v[20:23], v[48:63]
    s_waitcnt lgkmcnt(5)
    ds_read_b64_tr_b16 v[20:21], v7 offset:16384
    ds_read_b64_tr_b16 v[22:23], v7 offset:16896
    v_mfma_f32_32x32x16_bf16 v[64:79], v[156:159], v[24:27], v[64:79]
    s_waitcnt lgkmcnt(5)
    ds_read_b64_tr_b16 v[24:25], v6 offset:20480
    ds_read_b64_tr_b16 v[26:27], v6 offset:20992
    v_mfma_f32_32x32x16_bf16 v[80:95], v[156:159], v[28:31], v[80:95]
    s_waitcnt lgkmcnt(4)
    ds_read_b64_tr_b16 v[28:29], v7 offset:20480
    ds_read_b64_tr_b16 v[30:31], v7 offset:20992
    v_mfma_f32_32x32x16_bf16 v[32:47], v[160:163], v[16:19], v[32:47]
    s_waitcnt lgkmcnt(4)
    v_xor_b32 v14, 65568, v12
    ds_read_b128 v[164:167], v14
    ds_read_b64_tr_b16 v[16:17], v6 offset:18432
    ds_read_b64_tr_b16 v[18:19], v6 offset:18944
    v_mfma_f32_32x32x16_bf16 v[48:63], v[160:163], v[20:23], v[48:63]
    s_waitcnt lgkmcnt(5)
    ds_read_b64_tr_b16 v[20:21], v7 offset:18432
    ds_read_b64_tr_b16 v[22:23], v7 offset:18944
    v_mfma_f32_32x32x16_bf16 v[64:79], v[160:163], v[24:27], v[64:79]
    s_waitcnt lgkmcnt(5)
    ds_read_b64_tr_b16 v[24:25], v6 offset:22528
    ds_read_b64_tr_b16 v[26:27], v6 offset:23040
    v_mfma_f32_32x32x16_bf16 v[80:95], v[160:163], v[28:31], v[80:95]
    s_waitcnt lgkmcnt(4)
    ds_read_b64_tr_b16 v[28:29], v7 offset:22528
    ds_read_b64_tr_b16 v[30:31], v7 offset:23040
    v_mfma_f32_32x32x16_bf16 v[32:47], v[164:167], v[16:19], v[32:47]
    s_waitcnt lgkmcnt(4)
    v_xor_b32 v13, 65600, v12
    ds_read_b128 v[168:171], v13
    ds_read_b64_tr_b16 v[16:17], v6 offset:24576
    ds_read_b64_tr_b16 v[18:19], v6 offset:25088
    v_mfma_f32_32x32x16_bf16 v[48:63], v[164:167], v[20:23], v[48:63]
    s_waitcnt lgkmcnt(5)
    ds_read_b64_tr_b16 v[20:21], v7 offset:24576
    ds_read_b64_tr_b16 v[22:23], v7 offset:25088
    v_mfma_f32_32x32x16_bf16 v[64:79], v[164:167], v[24:27], v[64:79]
    s_waitcnt lgkmcnt(5)
    ds_read_b64_tr_b16 v[24:25], v6 offset:28672
    ds_read_b64_tr_b16 v[26:27], v6 offset:29184
    v_mfma_f32_32x32x16_bf16 v[80:95], v[164:167], v[28:31], v[80:95]
    s_waitcnt lgkmcnt(4)
    ds_read_b64_tr_b16 v[28:29], v7 offset:28672
    ds_read_b64_tr_b16 v[30:31], v7 offset:29184
    v_mfma_f32_32x32x16_bf16 v[32:47], v[168:171], v[16:19], v[32:47]
    s_waitcnt lgkmcnt(4)
    v_xor_b32 v14, 65632, v12
    ds_read_b128 v[172:175], v14
    ds_read_b64_tr_b16 v[16:17], v6 offset:26624
    ds_read_b64_tr_b16 v[18:19], v6 offset:27136
    v_mfma_f32_32x32x16_bf16 v[48:63], v[168:171], v[20:23], v[48:63]
    s_waitcnt lgkmcnt(5)
    ds_read_b64_tr_b16 v[20:21], v7 offset:26624
    ds_read_b64_tr_b16 v[22:23], v7 offset:27136
    v_mfma_f32_32x32x16_bf16 v[64:79], v[168:171], v[24:27], v[64:79]
    s_waitcnt lgkmcnt(5)
    ds_read_b64_tr_b16 v[24:25], v6 offset:30720
    ds_read_b64_tr_b16 v[26:27], v6 offset:31232
    v_mfma_f32_32x32x16_bf16 v[80:95], v[168:171], v[28:31], v[80:95]
    s_waitcnt lgkmcnt(4)
    ds_read_b64_tr_b16 v[28:29], v7 offset:30720
    ds_read_b64_tr_b16 v[30:31], v7 offset:31232
    v_mfma_f32_32x32x16_bf16 v[32:47], v[172:175], v[16:19], v[32:47]
    s_barrier
    v_xor_b32 v13, 98304, v12
    ds_read_b128 v[176:179], v13
    ds_read_b64_tr_b16 v[16:17], v8 offset:16384
    ds_read_b64_tr_b16 v[18:19], v8 offset:16896
    s_waitcnt lgkmcnt(7)
    v_mfma_f32_32x32x16_bf16 v[48:63], v[172:175], v[20:23], v[48:63]
    s_waitcnt lgkmcnt(5)
    ds_read_b64_tr_b16 v[20:21], v9 offset:16384
    ds_read_b64_tr_b16 v[22:23], v9 offset:16896
    v_mfma_f32_32x32x16_bf16 v[64:79], v[172:175], v[24:27], v[64:79]
    s_waitcnt lgkmcnt(5)
    ds_read_b64_tr_b16 v[24:25], v8 offset:20480
    ds_read_b64_tr_b16 v[26:27], v8 offset:20992
    v_mfma_f32_32x32x16_bf16 v[80:95], v[172:175], v[28:31], v[80:95]
    s_waitcnt lgkmcnt(4)
    ds_read_b64_tr_b16 v[28:29], v9 offset:20480
    ds_read_b64_tr_b16 v[30:31], v9 offset:20992
    v_mfma_f32_32x32x16_bf16 v[32:47], v[176:179], v[16:19], v[32:47]
    s_waitcnt lgkmcnt(4)
    v_xor_b32 v14, 98336, v12
    ds_read_b128 v[180:183], v14
    ds_read_b64_tr_b16 v[16:17], v8 offset:18432
    ds_read_b64_tr_b16 v[18:19], v8 offset:18944
    v_mfma_f32_32x32x16_bf16 v[48:63], v[176:179], v[20:23], v[48:63]
    s_waitcnt lgkmcnt(5)
    ds_read_b64_tr_b16 v[20:21], v9 offset:18432
    ds_read_b64_tr_b16 v[22:23], v9 offset:18944
    v_mfma_f32_32x32x16_bf16 v[64:79], v[176:179], v[24:27], v[64:79]
    s_waitcnt lgkmcnt(5)
    ds_read_b64_tr_b16 v[24:25], v8 offset:22528
    ds_read_b64_tr_b16 v[26:27], v8 offset:23040
    v_mfma_f32_32x32x16_bf16 v[80:95], v[176:179], v[28:31], v[80:95]
    s_waitcnt lgkmcnt(4)
    ds_read_b64_tr_b16 v[28:29], v9 offset:22528
    ds_read_b64_tr_b16 v[30:31], v9 offset:23040
    v_mfma_f32_32x32x16_bf16 v[32:47], v[180:183], v[16:19], v[32:47]
    s_waitcnt lgkmcnt(4)
    v_xor_b32 v13, 98368, v12
    ds_read_b128 v[184:187], v13
    ds_read_b64_tr_b16 v[16:17], v8 offset:24576
    ds_read_b64_tr_b16 v[18:19], v8 offset:25088
    v_mfma_f32_32x32x16_bf16 v[48:63], v[180:183], v[20:23], v[48:63]
    s_waitcnt lgkmcnt(5)
    ds_read_b64_tr_b16 v[20:21], v9 offset:24576
    ds_read_b64_tr_b16 v[22:23], v9 offset:25088
    v_mfma_f32_32x32x16_bf16 v[64:79], v[180:183], v[24:27], v[64:79]
    s_waitcnt lgkmcnt(5)
    ds_read_b64_tr_b16 v[24:25], v8 offset:28672
    ds_read_b64_tr_b16 v[26:27], v8 offset:29184
    v_mfma_f32_32x32x16_bf16 v[80:95], v[180:183], v[28:31], v[80:95]
    s_waitcnt lgkmcnt(4)
    ds_read_b64_tr_b16 v[28:29], v9 offset:28672
    ds_read_b64_tr_b16 v[30:31], v9 offset:29184
    v_mfma_f32_32x32x16_bf16 v[32:47], v[184:187], v[16:19], v[32:47]
    s_waitcnt lgkmcnt(4)
    v_xor_b32 v14, 98400, v12
    ds_read_b128 v[188:191], v14
    ds_read_b64_tr_b16 v[16:17], v8 offset:26624
    ds_read_b64_tr_b16 v[18:19], v8 offset:27136
    v_mfma_f32_32x32x16_bf16 v[48:63], v[184:187], v[20:23], v[48:63]
    s_waitcnt lgkmcnt(5)
    ds_read_b64_tr_b16 v[20:21], v9 offset:26624
    ds_read_b64_tr_b16 v[22:23], v9 offset:27136
    v_mfma_f32_32x32x16_bf16 v[64:79], v[184:187], v[24:27], v[64:79]
    s_waitcnt lgkmcnt(5)
    ds_read_b64_tr_b16 v[24:25], v8 offset:30720
    s_branch PADX_5
PAD_5:
    s_branch PAD_9
PADX_5:
    ds_read_b64_tr_b16 v[26:27], v8 offset:31232
    v_mfma_f32_32x32x16_bf16 v[80:95], v[184:187], v[28:31], v[80:95]
    s_waitcnt lgkmcnt(4)
    ds_read_b64_tr_b16 v[28:29], v9 offset:30720
    ds_read_b64_tr_b16 v[30:31], v9 offset:31232
    v_mfma_f32_32x32x16_bf16 v[32:47], v[188:191], v[16:19], v[32:47]
    s_barrier
    v_xor_b32 v13, 0, v12
    ds_read_b128 v[192:195], v13
    ds_read_b64_tr_b16 v[16:17], v4 offset:16384
    ds_read_b64_tr_b16 v[18:19], v4 offset:16896
    s_waitcnt lgkmcnt(7)
    v_mfma_f32_32x32x16_bf16 v[48:63], v[188:191], v[20:23], v[48:63]
    s_waitcnt lgkmcnt(5)
    ds_read_b64_tr_b16 v[20:21], v5 offset:16384
    ds_read_b64_tr_b16 v[22:23], v5 offset:16896
    v_mfma_f32_32x32x16_bf16 v[64:79], v[188:191], v[24:27], v[64:79]
    s_waitcnt lgkmcnt(5)
    ds_read_b64_tr_b16 v[24:25], v4 offset:20480
    ds_read_b64_tr_b16 v[26:27], v4 offset:20992
    v_mfma_f32_32x32x16_bf16 v[80:95], v[188:191], v[28:31], v[80:95]
    s_waitcnt lgkmcnt(4)
    ds_read_b64_tr_b16 v[28:29], v5 offset:20480
    ds_read_b64_tr_b16 v[30:31], v5 offset:20992
    v_mfma_f32_32x32x16_bf16 v[32:47], v[192:195], v[16:19], v[32:47]
    s_waitcnt lgkmcnt(4)
    v_xor_b32 v14, 32, v12
    ds_read_b128 v[196:199], v14
    ds_read_b64_tr_b16 v[16:17], v4 offset:18432
    ds_read_b64_tr_b16 v[18:19], v4 offset:18944
    v_mfma_f32_32x32x16_bf16 v[48:63], v[192:195], v[20:23], v[48:63]
    s_waitcnt lgkmcnt(5)
    ds_read_b64_tr_b16 v[20:21], v5 offset:18432
    ds_read_b64_tr_b16 v[22:23], v5 offset:18944
    v_mfma_f32_32x32x16_bf16 v[64:79], v[192:195], v[24:27], v[64:79]
    s_waitcnt lgkmcnt(5)
    ds_read_b64_tr_b16 v[24:25], v4 offset:22528
    ds_read_b64_tr_b16 v[26:27], v4 offset:23040
    v_mfma_f32_32x32x16_bf16 v[80:95], v[192:195], v[28:31], v[80:95]
    s_waitcnt lgkmcnt(4)
    ds_read_b64_tr_b16 v[28:29], v5 offset:22528
    ds_read_b64_tr_b16 v[30:31], v5 offset:23040
    v_mfma_f32_32x32x16_bf16 v[32:47], v[196:199], v[16:19], v[32:47]
    s_waitcnt lgkmcnt(4)
    v_xor_b32 v13, 64, v12
    ds_read_b128 v[200:203], v13
    ds_read_b64_tr_b16 v[16:17], v4 offset:24576
    ds_read_b64_tr_b16 v[18:19], v4 offset:25088
    v_mfma_f32_32x32x16_bf16 v[48:63], v[196:199], v[20:23], v[48:63]
    s_waitcnt lgkmcnt(5)
    ds_read_b64_tr_b16 v[20:21], v5 offset:24576
    ds_read_b64_tr_b16 v[22:23], v5 offset:25088
    v_mfma_f32_32x32x16_bf16 v[64:79], v[196:199], v[24:27], v[64:79]
    s_waitcnt lgkmcnt(5)
    ds_read_b64_tr_b16 v[24:25], v4 offset:28672
    ds_read_b64_tr_b16 v[26:27], v4 offset:29184
    v_mfma_f32_32x32x16_bf16 v[80:95], v[196:199], v[28:31], v[80:95]
    s_waitcnt lgkmcnt(4)
    ds_read_b64_tr_b16 v[28:29], v5 offset:28672
    ds_read_b64_tr_b16 v[30:31], v5 offset:29184
    v_mfma_f32_32x32x16_bf16 v[32:47], v[200:203], v[16:19], v[32:47]
    s_waitcnt lgkmcnt(4)
    v_xor_b32 v14, 96, v12
    ds_read_b128 v[204:207], v14
    ds_read_b64_tr_b16 v[16:17], v4 offset:26624
    ds_read_b64_tr_b16 v[18:19], v4 offset:27136
    v_mfma_f32_32x32x16_bf16 v[48:63], v[200:203], v[20:23], v[48:63]
    s_waitcnt lgkmcnt(5)
    ds_read_b64_tr_b16 v[20:21], v5 offset:26624
    ds_read_b64_tr_b16 v[22:23], v5 offset:27136
    v_mfma_f32_32x32x16_bf16 v[64:79], v[200:203], v[24:27], v[64:79]
    s_waitcnt lgkmcnt(5)
    ds_read_b64_tr_b16 v[24:25], v4 offset:30720
    ds_read_b64_tr_b16 v[26:27], v4 offset:31232
    v_mfma_f32_32x32x16_bf16 v[80:95], v[200:203], v[28:31], v[80:95]
    s_waitcnt lgkmcnt(4)
    ds_read_b64_tr_b16 v[28:29], v5 offset:30720
    ds_read_b64_tr_b16 v[30:31], v5 offset:31232
    v_mfma_f32_32x32x16_bf16 v[32:47], v[204:207], v[16:19], v[32:47]
    s_barrier
    v_xor_b32 v13, 32768, v12
    ds_read_b128 v[208:211], v13
    ds_read_b64_tr_b16 v[16:17], v4 offset:49152
    ds_read_b64_tr_b16 v[18:19], v4 offset:49664
    s_waitcnt lgkmcnt(7)
    v_mfma_f32_32x32x16_bf16 v[48:63], v[204:207], v[20:23], v[48:63]
    s_waitcnt lgkmcnt(5)
    ds_read_b64_tr_b16 v[20:21], v5 offset:49152
    ds_read_b64_tr_b16 v[22:23], v5 offset:49664
    v_mfma_f32_32x32x16_bf16 v[64:79], v[204:207], v[24:27], v[64:79]
    s_waitcnt lgkmcnt(5)
    ds_read_b64_tr_b16 v[24:25], v4 offset:53248
    ds_read_b64_tr_b16 v[26:27], v4 offset:53760
    v_mfma_f32_32x32x16_bf16 v[80:95], v[204:207], v[28:31], v[80:95]
    s_waitcnt lgkmcnt(4)
    ds_read_b64_tr_b16 v[28:29], v5 offset:53248
    ds_read_b64_tr_b16 v[30:31], v5 offset:53760
    v_mfma_f32_32x32x16_bf16 v[32:47], v[208:211], v[16:19], v[32:47]
    s_waitcnt lgkmcnt(4)
    v_xor_b32 v14, 32800, v12
    ds_read_b128 v[212:215], v14
    ds_read_b64_tr_b16 v[16:17], v4 offset:51200
    ds_read_b64_tr_b16 v[18:19], v4 offset:51712
    v_mfma_f32_32x32x16_bf16 v[48:63], v[208:211], v[20:23], v[48:63]
    s_waitcnt lgkmcnt(5)
    ds_read_b64_tr_b16 v[20:21], v5 offset:51200
    ds_read_b64_tr_b16 v[22:23], v5 offset:51712
    v_mfma_f32_32x32x16_bf16 v[64:79], v[208:211], v[24:27], v[64:79]
    s_waitcnt lgkmcnt(5)
    ds_read_b64_tr_b16 v[24:25], v4 offset:55296
    ds_read_b64_tr_b16 v[26:27], v4 offset:55808
    v_mfma_f32_32x32x16_bf16 v[80:95], v[208:211], v[28:31], v[80:95]
    s_waitcnt lgkmcnt(4)
    ds_read_b64_tr_b16 v[28:29], v5 offset:55296
    ds_read_b64_tr_b16 v[30:31], v5 offset:55808
    v_mfma_f32_32x32x16_bf16 v[32:47], v[212:215], v[16:19], v[32:47]
    s_waitcnt lgkmcnt(4)
    v_xor_b32 v13, 32832, v12
    ds_read_b128 v[216:219], v13
    ds_read_b64_tr_b16 v[16:17], v4 offset:57344
    ds_read_b64_tr_b16 v[18:19], v4 offset:57856
    v_mfma_f32_32x32x16_bf16 v[48:63], v[212:215], v[20:23], v[48:63]
    s_waitcnt lgkmcnt(5)
    ds_read_b64_tr_b16 v[20:21], v5 offset:57344
    ds_read_b64_tr_b16 v[22:23], v5 offset:57856
    v_mfma_f32_32x32x16_bf16 v[64:79], v[212:215], v[24:27], v[64:79]
    s_waitcnt lgkmcnt(5)
    ds_read_b64_tr_b16 v[24:25], v4 offset:61440
    ds_read_b64_tr_b16 v[26:27], v4 offset:61952
    v_mfma_f32_32x32x16_bf16 v[80:95], v[212:215], v[28:31], v[80:95]
    s_waitcnt lgkmcnt(4)
    ds_read_b64_tr_b16 v[28:29], v5 offset:61440
    ds_read_b64_tr_b16 v[30:31], v5 offset:61952
    v_mfma_f32_32x32x16_bf16 v[32:47], v[216:219], v[16:19], v[32:47]
    s_waitcnt lgkmcnt(4)
    v_xor_b32 v14, 32864, v12
    ds_read_b128 v[220:223], v14
    ds_read_b64_tr_b16 v[16:17], v4 offset:59392
    ds_read_b64_tr_b16 v[18:19], v4 offset:59904
    v_mfma_f32_32x32x16_bf16 v[48:63], v[216:219], v[20:23], v[48:63]
    s_waitcnt lgkmcnt(5)
    ds_read_b64_tr_b16 v[20:21], v5 offset:59392
    ds_read_b64_tr_b16 v[22:23], v5 offset:59904
    v_mfma_f32_32x32x16_bf16 v[64:79], v[216:219], v[24:27], v[64:79]
    s_waitcnt lgkmcnt(5)
    ds_read_b64_tr_b16 v[24:25], v4 offset:63488
    ds_read_b64_tr_b16 v[26:27], v4 offset:64000
    v_mfma_f32_32x32x16_bf16 v[80:95], v[216:219], v[28:31], v[80:95]
    s_waitcnt lgkmcnt(4)
    ds_read_b64_tr_b16 v[28:29], v5 offset:63488
    ds_read_b64_tr_b16 v[30:31], v5 offset:64000
    v_mfma_f32_32x32x16_bf16 v[32:47], v[220:223], v[16:19], v[32:47]
    s_barrier
    v_xor_b32 v13, 65536, v12
    ds_read_b128 v[224:227], v13
    ds_read_b64_tr_b16 v[16:17], v6 offset:16384
    ds_read_b64_tr_b16 v[18:19], v6 offset:16896
    s_waitcnt lgkmcnt(7)
    v_mfma_f32_32x32x16_bf16 v[48:63], v[220:223], v[20:23], v[48:63]
    s_waitcnt lgkmcnt(5)
    ds_read_b64_tr_b16 v[20:21], v7 offset:16384
    ds_read_b64_tr_b16 v[22:23], v7 offset:16896
    v_mfma_f32_32x32x16_bf16 v[64:79], v[220:223], v[24:27], v[64:79]
    s_waitcnt lgkmcnt(5)
    ds_read_b64_tr_b16 v[24:25], v6 offset:20480
    ds_read_b64_tr_b16 v[26:27], v6 offset:20992
    v_mfma_f32_32x32x16_bf16 v[80:95], v[220:223], v[28:31], v[80:95]
    s_waitcnt lgkmcnt(4)
    ds_read_b64_tr_b16 v[28:29], v7 offset:20480
    ds_read_b64_tr_b16 v[30:31], v7 offset:20992
    v_mfma_f32_32x32x16_bf16 v[32:47], v[224:227], v[16:19], v[32:47]
    s_waitcnt lgkmcnt(4)
    v_xor_b32 v14, 65568, v12
    ds_read_b128 v[228:231], v14
    ds_read_b64_tr_b16 v[16:17], v6 offset:18432
    ds_read_b64_tr_b16 v[18:19], v6 offset:18944
    v_mfma_f32_32x32x16_bf16 v[48:63], v[224:227], v[20:23], v[48:63]
    s_waitcnt lgkmcnt(5)
    ds_read_b64_tr_b16 v[20:21], v7 offset:18432
    ds_read_b64_tr_b16 v[22:23], v7 offset:18944
    v_mfma_f32_32x32x16_bf16 v[64:79], v[224:227], v[24:27], v[64:79]
    s_waitcnt lgkmcnt(5)
    ds_read_b64_tr_b16 v[24:25], v6 offset:22528
    ds_read_b64_tr_b16 v[26:27], v6 offset:23040
    v_mfma_f32_32x32x16_bf16 v[80:95], v[224:227], v[28:31], v[80:95]
    s_waitcnt lgkmcnt(4)
    ds_read_b64_tr_b16 v[28:29], v7 offset:22528
    ds_read_b64_tr_b16 v[30:31], v7 offset:23040
    v_mfma_f32_32x32x16_bf16 v[32:47], v[228:231], v[16:19], v[32:47]
    s_waitcnt lgkmcnt(4)
    v_xor_b32 v13, 65600, v12
    ds_read_b128 v[232:235], v13
    ds_read_b64_tr_b16 v[16:17], v6 offset:24576
    ds_read_b64_tr_b16 v[18:19], v6 offset:25088
    v_mfma_f32_32x32x16_bf16 v[48:63], v[228:231], v[20:23], v[48:63]
    s_waitcnt lgkmcnt(5)
    ds_read_b64_tr_b16 v[20:21], v7 offset:24576
    ds_read_b64_tr_b16 v[22:23], v7 offset:25088
    v_mfma_f32_32x32x16_bf16 v[64:79], v[228:231], v[24:27], v[64:79]
    s_waitcnt lgkmcnt(5)
    ds_read_b64_tr_b16 v[24:25], v6 offset:28672
    ds_read_b64_tr_b16 v[26:27], v6 offset:29184
    v_mfma_f32_32x32x16_bf16 v[80:95], v[228:231], v[28:31], v[80:95]
    s_waitcnt lgkmcnt(4)
    ds_read_b64_tr_b16 v[28:29], v7 offset:28672
    ds_read_b64_tr_b16 v[30:31], v7 offset:29184
    v_mfma_f32_32x32x16_bf16 v[32:47], v[232:235], v[16:19], v[32:47]
    s_waitcnt lgkmcnt(4)
    v_xor_b32 v14, 65632, v12
    ds_read_b128 v[236:239], v14
    ds_read_b64_tr_b16 v[16:17], v6 offset:26624
    ds_read_b64_tr_b16 v[18:19], v6 offset:27136
    v_mfma_f32_32x32x16_bf16 v[48:63], v[232:235], v[20:23], v[48:63]
    s_waitcnt lgkmcnt(5)
    ds_read_b64_tr_b16 v[20:21], v7 offset:26624
    ds_read_b64_tr_b16 v[22:23], v7 offset:27136
    v_mfma_f32_32x32x16_bf16 v[64:79], v[232:235], v[24:27], v[64:79]
    s_waitcnt lgkmcnt(5)
    ds_read_b64_tr_b16 v[24:25], v6 offset:30720
    ds_read_b64_tr_b16 v[26:27], v6 offset:31232
    v_mfma_f32_32x32x16_bf16 v[80:95], v[232:235], v[28:31], v[80:95]
    s_waitcnt lgkmcnt(4)
    ds_read_b64_tr_b16 v[28:29], v7 offset:30720
    ds_read_b64_tr_b16 v[30:31], v7 offset:31232
    v_mfma_f32_32x32x16_bf16 v[32:47], v[236:239], v[16:19], v[32:47]
    s_barrier
    v_xor_b32 v13, 98304, v12
    ds_read_b128 v[240:243], v13
    ds_read_b64_tr_b16 v[16:17], v8 offset:20480
    ds_read_b64_tr_b16 v[18:19], v8 offset:20992
    s_waitcnt lgkmcnt(7)
    v_mfma_f32_32x32x16_bf16 v[48:63], v[236:239], v[20:23], v[48:63]
    s_waitcnt lgkmcnt(5)
    v_xor_b32 v14, 98336, v12
    ds_read_b128 v[244:247], v14
    ds_read_b64_tr_b16 v[20:21], v8 offset:22528
    ds_read_b64_tr_b16 v[22:23], v8 offset:23040
    v_mfma_f32_32x32x16_bf16 v[64:79], v[236:239], v[24:27], v[64:79]
    s_waitcnt lgkmcnt(6)
    v_xor_b32 v13, 98368, v12
    ds_read_b128 v[248:251], v13
    ds_read_b64_tr_b16 v[24:25], v8 offset:28672
    ds_read_b64_tr_b16 v[26:27], v8 offset:29184
    v_mfma_f32_32x32x16_bf16 v[80:95], v[236:239], v[28:31], v[80:95]
    v_xor_b32 v14, 98400, v12
    ds_read_b128 v[252:255], v14
    ds_read_b64_tr_b16 v[28:29], v8 offset:30720
    ds_read_b64_tr_b16 v[30:31], v8 offset:31232
    s_waitcnt lgkmcnt(9)
    v_mfma_f32_32x32x16_bf16 v[64:79], v[240:243], v[16:19], v[64:79]
    s_waitcnt lgkmcnt(6)
    ds_read_b64_tr_b16 v[16:17], v8 offset:16384
    ds_read_b64_tr_b16 v[18:19], v8 offset:16896
    v_mfma_f32_32x32x16_bf16 v[64:79], v[244:247], v[20:23], v[64:79]
    s_waitcnt lgkmcnt(5)
    ds_read_b64_tr_b16 v[20:21], v8 offset:18432
    ds_read_b64_tr_b16 v[22:23], v8 offset:18944
    v_mfma_f32_32x32x16_bf16 v[64:79], v[248:251], v[24:27], v[64:79]
    s_waitcnt lgkmcnt(4)
    ds_read_b64_tr_b16 v[24:25], v8 offset:24576
    ds_read_b64_tr_b16 v[26:27], v8 offset:25088
    v_mfma_f32_32x32x16_bf16 v[64:79], v[252:255], v[28:31], v[64:79]
    s_waitcnt lgkmcnt(4)
    ds_read_b64_tr_b16 v[28:29], v8 offset:26624
    ds_read_b64_tr_b16 v[30:31], v8 offset:27136
    v_mfma_f32_32x32x16_bf16 v[32:47], v[240:243], v[16:19], v[32:47]
    s_waitcnt lgkmcnt(4)
    ds_read_b64_tr_b16 v[16:17], v9 offset:20480
    ds_read_b64_tr_b16 v[18:19], v9 offset:20992
    v_mfma_f32_32x32x16_bf16 v[32:47], v[244:247], v[20:23], v[32:47]
    s_waitcnt lgkmcnt(4)
    ds_read_b64_tr_b16 v[20:21], v9 offset:22528
    ds_read_b64_tr_b16 v[22:23], v9 offset:23040
    v_cvt_pk_bf16_f32 v64, v64, v65
    v_cvt_pk_bf16_f32 v65, v66, v67
    v_cvt_pk_bf16_f32 v66, v68, v69
    v_cvt_pk_bf16_f32 v67, v70, v71
    v_cvt_pk_bf16_f32 v68, v72, v73
    v_mfma_f32_32x32x16_bf16 v[32:47], v[248:251], v[24:27], v[32:47]
    s_waitcnt lgkmcnt(4)
    ds_read_b64_tr_b16 v[24:25], v9 offset:28672
    ds_read_b64_tr_b16 v[26:27], v9 offset:29184
    v_cvt_pk_bf16_f32 v69, v74, v75
    v_cvt_pk_bf16_f32 v70, v76, v77
    v_cvt_pk_bf16_f32 v71, v78, v79
    v_add_u32 v11, 64, v15
    v_mul_u32_u24 v10, 3277, v11
    v_lshrrev_b32 v10, 16, v10
    v_mul_lo_u32 v10, v10, s44
    v_lshl_add_u32 v10, v11, 4, v10
    v_add_u32 v10, v0, v10
    buffer_store_dwordx4 v[64:67], v10, s[20:23], s45 offen sc1
    v_mfma_f32_32x32x16_bf16 v[32:47], v[252:255], v[28:31], v[32:47]
    s_waitcnt lgkmcnt(4)
    ds_read_b64_tr_b16 v[28:29], v9 offset:30720
    ds_read_b64_tr_b16 v[30:31], v9 offset:31232
    v_mfma_f32_32x32x16_bf16 v[80:95], v[240:243], v[16:19], v[80:95]
    s_waitcnt lgkmcnt(4)
    ds_read_b64_tr_b16 v[16:17], v9 offset:16384
    ds_read_b64_tr_b16 v[18:19], v9 offset:16896
    v_mfma_f32_32x32x16_bf16 v[80:95], v[244:247], v[20:23], v[80:95]
    s_waitcnt lgkmcnt(4)
    ds_read_b64_tr_b16 v[20:21], v9 offset:18432
    ds_read_b64_tr_b16 v[22:23], v9 offset:18944
    v_cvt_pk_bf16_f32 v72, v32, v33
    v_cvt_pk_bf16_f32 v73, v34, v35
    v_cvt_pk_bf16_f32 v74, v36, v37
    v_cvt_pk_bf16_f32 v75, v38, v39
    v_cvt_pk_bf16_f32 v76, v40, v41
    v_mfma_f32_32x32x16_bf16 v[80:95], v[248:251], v[24:27], v[80:95]
    s_waitcnt lgkmcnt(4)
    ds_read_b64_tr_b16 v[24:25], v9 offset:24576
    ds_read_b64_tr_b16 v[26:27], v9 offset:25088
    v_cvt_pk_bf16_f32 v77, v42, v43
    v_cvt_pk_bf16_f32 v78, v44, v45
    v_cvt_pk_bf16_f32 v79, v46, v47
    v_mfma_f32_32x32x16_bf16 v[80:95], v[252:255], v[28:31], v[80:95]
    s_waitcnt lgkmcnt(4)
    ds_read_b64_tr_b16 v[28:29], v9 offset:26624
    ds_read_b64_tr_b16 v[30:31], v9 offset:27136
    v_mfma_f32_32x32x16_bf16 v[48:63], v[240:243], v[16:19], v[48:63]
    s_waitcnt lgkmcnt(4)
    ds_read_b64_tr_b16 v[16:17], v8 offset:49152
    ds_read_b64_tr_b16 v[18:19], v8 offset:49664
    buffer_store_dwordx4 v[68:71], v10, s[20:23], s45 offen offset:640 sc1
    v_mfma_f32_32x32x16_bf16 v[48:63], v[244:247], v[20:23], v[48:63]
    s_waitcnt lgkmcnt(4)
    ds_read_b64_tr_b16 v[20:21], v8 offset:51200
    ds_read_b64_tr_b16 v[22:23], v8 offset:51712
    v_cvt_pk_bf16_f32 v80, v80, v81
    v_cvt_pk_bf16_f32 v81, v82, v83
    v_cvt_pk_bf16_f32 v82, v84, v85
    v_cvt_pk_bf16_f32 v83, v86, v87
    v_cvt_pk_bf16_f32 v84, v88, v89
    v_mfma_f32_32x32x16_bf16 v[48:63], v[248:251], v[24:27], v[48:63]
    s_waitcnt lgkmcnt(4)
    ds_read_b64_tr_b16 v[24:25], v8 offset:53248
    ds_read_b64_tr_b16 v[26:27], v8 offset:53760
    v_cvt_pk_bf16_f32 v85, v90, v91
    v_cvt_pk_bf16_f32 v86, v92, v93
    v_cvt_pk_bf16_f32 v87, v94, v95
    v_mfma_f32_32x32x16_bf16 v[48:63], v[252:255], v[28:31], v[48:63]
    s_waitcnt lgkmcnt(4)
    ds_read_b64_tr_b16 v[28:29], v8 offset:55296
    ds_read_b64_tr_b16 v[30:31], v8 offset:55808
    v_mfma_f32_32x32x16_bf16 v[32:47], v[16:19], v[96:99], 0
    s_waitcnt lgkmcnt(4)
    ds_read_b64_tr_b16 v[16:17], v8 offset:57344
    ds_read_b64_tr_b16 v[18:19], v8 offset:57856
    v_mfma_f32_32x32x16_bf16 v[32:47], v[20:23], v[100:103], v[32:47]
    s_waitcnt lgkmcnt(4)
    ds_read_b64_tr_b16 v[20:21], v8 offset:59392
    ds_read_b64_tr_b16 v[22:23], v8 offset:59904
    v_cvt_pk_bf16_f32 v88, v48, v49
    v_cvt_pk_bf16_f32 v89, v50, v51
    v_cvt_pk_bf16_f32 v90, v52, v53
    v_cvt_pk_bf16_f32 v91, v54, v55
    v_cvt_pk_bf16_f32 v92, v56, v57
    v_mov_b32 v13, 147456
    ds_read_b32 v14, v13
    v_mfma_f32_32x32x16_bf16 v[32:47], v[24:27], v[104:107], v[32:47]
    s_waitcnt lgkmcnt(5)
    ds_read_b64_tr_b16 v[24:25], v8 offset:61440
    ds_read_b64_tr_b16 v[26:27], v8 offset:61952
    v_cvt_pk_bf16_f32 v93, v58, v59
    v_cvt_pk_bf16_f32 v94, v60, v61
    v_cvt_pk_bf16_f32 v95, v62, v63
    v_add_u32 v11, 0, v15
    v_mul_u32_u24 v10, 3277, v11
    v_lshrrev_b32 v10, 16, v10
    v_mul_lo_u32 v10, v10, s44
    v_lshl_add_u32 v10, v11, 4, v10
    v_add_u32 v10, v0, v10
    buffer_store_dwordx4 v[72:75], v10, s[20:23], s45 offen sc1
    v_mfma_f32_32x32x16_bf16 v[32:47], v[28:31], v[108:111], v[32:47]
    s_waitcnt lgkmcnt(5)
    ds_read_b64_tr_b16 v[28:29], v8 offset:63488
    ds_read_b64_tr_b16 v[30:31], v8 offset:64000
    v_mfma_f32_32x32x16_bf16 v[32:47], v[16:19], v[112:115], v[32:47]
    s_waitcnt lgkmcnt(5)
    ds_read_b64_tr_b16 v[16:17], v9 offset:49152
    ds_read_b64_tr_b16 v[18:19], v9 offset:49664
    v_mfma_f32_32x32x16_bf16 v[32:47], v[20:23], v[116:119], v[32:47]
    s_waitcnt lgkmcnt(4)
    ds_read_b64_tr_b16 v[20:21], v9 offset:51200
    ds_read_b64_tr_b16 v[22:23], v9 offset:51712
    v_mfma_f32_32x32x16_bf16 v[32:47], v[24:27], v[120:123], v[32:47]
    s_waitcnt lgkmcnt(4)
    ds_read_b64_tr_b16 v[24:25], v9 offset:53248
    ds_read_b64_tr_b16 v[26:27], v9 offset:53760
    v_mfma_f32_32x32x16_bf16 v[32:47], v[28:31], v[124:127], v[32:47]
    s_waitcnt lgkmcnt(4)
    ds_read_b64_tr_b16 v[28:29], v9 offset:55296
    ds_read_b64_tr_b16 v[30:31], v9 offset:55808
    v_readfirstlane_b32 s17, v14
    s_add_u32 s17, s17, 3
    v_mfma_f32_32x32x16_bf16 v[48:63], v[16:19], v[96:99], 0
    s_waitcnt lgkmcnt(4)
    ds_read_b64_tr_b16 v[16:17], v9 offset:57344
    ds_read_b64_tr_b16 v[18:19], v9 offset:57856
    buffer_store_dwordx4 v[76:79], v10, s[20:23], s45 offen offset:640 sc1
    v_mfma_f32_32x32x16_bf16 v[48:63], v[20:23], v[100:103], v[48:63]
    s_waitcnt lgkmcnt(4)
    ds_read_b64_tr_b16 v[20:21], v9 offset:59392
    ds_read_b64_tr_b16 v[22:23], v9 offset:59904
    v_mfma_f32_32x32x16_bf16 v[48:63], v[24:27], v[104:107], v[48:63]
    s_waitcnt lgkmcnt(4)
    ds_read_b64_tr_b16 v[24:25], v9 offset:61440
    ds_read_b64_tr_b16 v[26:27], v9 offset:61952
    v_mfma_f32_32x32x16_bf16 v[48:63], v[28:31], v[108:111], v[48:63]
    s_waitcnt lgkmcnt(4)
    ds_read_b64_tr_b16 v[28:29], v9 offset:63488
    ds_read_b64_tr_b16 v[30:31], v9 offset:64000
    v_mfma_f32_32x32x16_bf16 v[48:63], v[16:19], v[112:115], v[48:63]
    s_barrier
    ds_read_b64_tr_b16 v[16:17], v4 offset:0
    ds_read_b64_tr_b16 v[18:19], v4 offset:512
    s_waitcnt lgkmcnt(6)
    v_mfma_f32_32x32x16_bf16 v[48:63], v[20:23], v[116:119], v[48:63]
    s_waitcnt lgkmcnt(4)
    ds_read_b64_tr_b16 v[20:21], v4 offset:2048
    ds_read_b64_tr_b16 v[22:23], v4 offset:2560
    v_mfma_f32_32x32x16_bf16 v[48:63], v[24:27], v[120:123], v[48:63]
    s_waitcnt lgkmcnt(4)
    ds_read_b64_tr_b16 v[24:25], v5 offset:0
    ds_read_b64_tr_b16 v[26:27], v5 offset:512
    v_add_u32 v11, 96, v15
    v_mul_u32_u24 v10, 3277, v11
    v_lshrrev_b32 v10, 16, v10
    v_mul_lo_u32 v10, v10, s44
    v_lshl_add_u32 v10, v11, 4, v10
    v_add_u32 v10, v0, v10
    buffer_store_dwordx4 v[80:83], v10, s[20:23], s45 offen sc1
    v_mfma_f32_32x32x16_bf16 v[48:63], v[28:31], v[124:127], v[48:63]
    s_waitcnt lgkmcnt(4)
    ds_read_b64_tr_b16 v[28:29], v5 offset:2048
    ds_read_b64_tr_b16 v[30:31], v5 offset:2560
    v_mfma_f32_32x32x16_bf16 v[32:47], v[16:19], v[128:131], v[32:47]
    s_waitcnt lgkmcnt(4)
    ds_read_b64_tr_b16 v[16:17], v4 offset:4096
    ds_read_b64_tr_b16 v[18:19], v4 offset:4608
    v_mfma_f32_32x32x16_bf16 v[32:47], v[20:23], v[132:135], v[32:47]
    s_waitcnt lgkmcnt(4)
    ds_read_b64_tr_b16 v[20:21], v4 offset:6144
    ds_read_b64_tr_b16 v[22:23], v4 offset:6656
    v_mfma_f32_32x32x16_bf16 v[48:63], v[24:27], v[128:131], v[48:63]
    s_waitcnt lgkmcnt(4)
    ds_read_b64_tr_b16 v[24:25], v5 offset:4096
    ds_read_b64_tr_b16 v[26:27], v5 offset:4608
    v_mfma_f32_32x32x16_bf16 v[48:63], v[28:31], v[132:135], v[48:63]
    s_waitcnt lgkmcnt(4)
    ds_read_b64_tr_b16 v[28:29], v5 offset:6144
    ds_read_b64_tr_b16 v[30:31], v5 offset:6656
    v_mfma_f32_32x32x16_bf16 v[32:47], v[16:19], v[136:139], v[32:47]
    s_waitcnt lgkmcnt(4)
    ds_read_b64_tr_b16 v[16:17], v4 offset:8192
    ds_read_b64_tr_b16 v[18:19], v4 offset:8704
    buffer_store_dwordx4 v[84:87], v10, s[20:23], s45 offen offset:640 sc1
    v_mfma_f32_32x32x16_bf16 v[32:47], v[20:23], v[140:143], v[32:47]
    s_waitcnt lgkmcnt(4)
    ds_read_b64_tr_b16 v[20:21], v4 offset:10240
    ds_read_b64_tr_b16 v[22:23], v4 offset:10752
    v_mfma_f32_32x32x16_bf16 v[48:63], v[24:27], v[136:139], v[48:63]
    s_waitcnt lgkmcnt(4)
    ds_read_b64_tr_b16 v[24:25], v5 offset:8192
    ds_read_b64_tr_b16 v[26:27], v5 offset:8704
    v_mfma_f32_32x32x16_bf16 v[48:63], v[28:31], v[140:143], v[48:63]
    s_waitcnt lgkmcnt(4)
    ds_read_b64_tr_b16 v[28:29], v5 offset:10240
    ds_read_b64_tr_b16 v[30:31], v5 offset:10752
    v_mfma_f32_32x32x16_bf16 v[32:47], v[16:19], v[144:147], v[32:47]
    s_waitcnt lgkmcnt(4)
    ds_read_b64_tr_b16 v[16:17], v4 offset:12288
    ds_read_b64_tr_b16 v[18:19], v4 offset:12800
    v_mfma_f32_32x32x16_bf16 v[32:47], v[20:23], v[148:151], v[32:47]
    s_waitcnt lgkmcnt(4)
    ds_read_b64_tr_b16 v[20:21], v4 offset:14336
    ds_read_b64_tr_b16 v[22:23], v4 offset:14848
    v_mfma_f32_32x32x16_bf16 v[48:63], v[24:27], v[144:147], v[48:63]
    s_waitcnt lgkmcnt(4)
    ds_read_b64_tr_b16 v[24:25], v5 offset:12288
    ds_read_b64_tr_b16 v[26:27], v5 offset:12800
    v_add_u32 v11, 32, v15
    v_mul_u32_u24 v10, 3277, v11
    v_lshrrev_b32 v10, 16, v10
    v_mul_lo_u32 v10, v10, s44
    v_lshl_add_u32 v10, v11, 4, v10
    v_add_u32 v10, v0, v10
    buffer_store_dwordx4 v[88:91], v10, s[20:23], s45 offen sc1
    v_mfma_f32_32x32x16_bf16 v[48:63], v[28:31], v[148:151], v[48:63]
    s_waitcnt lgkmcnt(4)
    ds_read_b64_tr_b16 v[28:29], v5 offset:14336
    ds_read_b64_tr_b16 v[30:31], v5 offset:14848
    v_mfma_f32_32x32x16_bf16 v[32:47], v[16:19], v[152:155], v[32:47]
    s_waitcnt lgkmcnt(4)
    ds_read_b64_tr_b16 v[16:17], v4 offset:16384
    ds_read_b64_tr_b16 v[18:19], v4 offset:16896
    v_mfma_f32_32x32x16_bf16 v[32:47], v[20:23], v[156:159], v[32:47]
    s_waitcnt lgkmcnt(4)
    ds_read_b64_tr_b16 v[20:21], v4 offset:18432
    ds_read_b64_tr_b16 v[22:23], v4 offset:18944
    v_mfma_f32_32x32x16_bf16 v[48:63], v[24:27], v[152:155], v[48:63]
    s_waitcnt lgkmcnt(4)
    ds_read_b64_tr_b16 v[24:25], v5 offset:16384
    ds_read_b64_tr_b16 v[26:27], v5 offset:16896
    v_mfma_f32_32x32x16_bf16 v[48:63], v[28:31], v[156:159], v[48:63]
    s_waitcnt lgkmcnt(4)
    ds_read_b64_tr_b16 v[28:29], v5 offset:18432
    ds_read_b64_tr_b16 v[30:31], v5 offset:18944
    v_mfma_f32_32x32x16_bf16 v[32:47], v[16:19], v[160:163], v[32:47]
    s_waitcnt lgkmcnt(4)
    ds_read_b64_tr_b16 v[16:17], v4 offset:20480
    ds_read_b64_tr_b16 v[18:19], v4 offset:20992
    buffer_store_dwordx4 v[92:95], v10, s[20:23], s45 offen offset:640 sc1
    v_mfma_f32_32x32x16_bf16 v[32:47], v[20:23], v[164:167], v[32:47]
    s_waitcnt lgkmcnt(4)
    ds_read_b64_tr_b16 v[20:21], v4 offset:22528
    ds_read_b64_tr_b16 v[22:23], v4 offset:23040
    v_mfma_f32_32x32x16_bf16 v[48:63], v[24:27], v[160:163], v[48:63]
    s_waitcnt lgkmcnt(4)
    ds_read_b64_tr_b16 v[24:25], v5 offset:20480
    ds_read_b64_tr_b16 v[26:27], v5 offset:20992
    v_mfma_f32_32x32x16_bf16 v[48:63], v[28:31], v[164:167], v[48:63]
    s_waitcnt lgkmcnt(4)
    ds_read_b64_tr_b16 v[28:29], v5 offset:22528
    ds_read_b64_tr_b16 v[30:31], v5 offset:23040
    v_mfma_f32_32x32x16_bf16 v[32:47], v[16:19], v[168:171], v[32:47]
    s_waitcnt lgkmcnt(4)
    ds_read_b64_tr_b16 v[16:17], v4 offset:24576
    ds_read_b64_tr_b16 v[18:19], v4 offset:25088
    v_mfma_f32_32x32x16_bf16 v[32:47], v[20:23], v[172:175], v[32:47]
    s_waitcnt lgkmcnt(4)
    ds_read_b64_tr_b16 v[20:21], v4 offset:26624
    ds_read_b64_tr_b16 v[22:23], v4 offset:27136
    v_mfma_f32_32x32x16_bf16 v[48:63], v[24:27], v[168:171], v[48:63]
    s_waitcnt lgkmcnt(4)
    ds_read_b64_tr_b16 v[24:25], v5 offset:24576
    ds_read_b64_tr_b16 v[26:27], v5 offset:25088
    v_mfma_f32_32x32x16_bf16 v[48:63], v[28:31], v[172:175], v[48:63]
    s_waitcnt lgkmcnt(4)
    ds_read_b64_tr_b16 v[28:29], v5 offset:26624
    ds_read_b64_tr_b16 v[30:31], v5 offset:27136
    v_mfma_f32_32x32x16_bf16 v[32:47], v[16:19], v[176:179], v[32:47]
    s_waitcnt lgkmcnt(4)
    ds_read_b64_tr_b16 v[16:17], v4 offset:28672
    ds_read_b64_tr_b16 v[18:19], v4 offset:29184
    v_mfma_f32_32x32x16_bf16 v[32:47], v[20:23], v[180:183], v[32:47]
    s_waitcnt lgkmcnt(4)
    ds_read_b64_tr_b16 v[20:21], v4 offset:30720
    ds_read_b64_tr_b16 v[22:23], v4 offset:31232
    v_mfma_f32_32x32x16_bf16 v[48:63], v[24:27], v[176:179], v[48:63]
    s_waitcnt lgkmcnt(4)
    ds_read_b64_tr_b16 v[24:25], v5 offset:28672
    ds_read_b64_tr_b16 v[26:27], v5 offset:29184
    v_mfma_f32_32x32x16_bf16 v[48:63], v[28:31], v[180:183], v[48:63]
PA_JOIN:
    ds_read_b64_tr_b16 v[28:29], v5 offset:30720
    ds_read_b64_tr_b16 v[30:31], v5 offset:31232
    s_waitcnt lgkmcnt(6)
    v_mfma_f32_32x32x16_bf16 v[32:47], v[16:19], v[184:187], v[32:47]
    s_waitcnt lgkmcnt(4)
    ds_read_b64_tr_b16 v[16:17], v4 offset:32768
    ds_read_b64_tr_b16 v[18:19], v4 offset:33280
    v_mfma_f32_32x32x16_bf16 v[32:47], v[20:23], v[188:191], v[32:47]
    s_waitcnt lgkmcnt(4)
    ds_read_b64_tr_b16 v[20:21], v4 offset:34816
    ds_read_b64_tr_b16 v[22:23], v4 offset:35328
    v_mfma_f32_32x32x16_bf16 v[48:63], v[24:27], v[184:187], v[48:63]
    s_waitcnt lgkmcnt(4)
    ds_read_b64_tr_b16 v[24:25], v5 offset:32768
    ds_read_b64_tr_b16 v[26:27], v5 offset:33280
    v_mfma_f32_32x32x16_bf16 v[48:63], v[28:31], v[188:191], v[48:63]
    s_waitcnt lgkmcnt(4)
    ds_read_b64_tr_b16 v[28:29], v5 offset:34816
    ds_read_b64_tr_b16 v[30:31], v5 offset:35328
    v_mfma_f32_32x32x16_bf16 v[32:47], v[16:19], v[192:195], v[32:47]
    s_waitcnt lgkmcnt(4)
    ds_read_b64_tr_b16 v[16:17], v4 offset:36864
    ds_read_b64_tr_b16 v[18:19], v4 offset:37376
    v_mfma_f32_32x32x16_bf16 v[32:47], v[20:23], v[196:199], v[32:47]
    s_waitcnt lgkmcnt(4)
    ds_read_b64_tr_b16 v[20:21], v4 offset:38912
    s_branch PADX_6
PAD_6:
    s_branch PAD_10
PADX_6:
    ds_read_b64_tr_b16 v[22:23], v4 offset:39424
    v_mfma_f32_32x32x16_bf16 v[48:63], v[24:27], v[192:195], v[48:63]
    s_waitcnt lgkmcnt(4)
    ds_read_b64_tr_b16 v[24:25], v5 offset:36864
    ds_read_b64_tr_b16 v[26:27], v5 offset:37376
    v_mfma_f32_32x32x16_bf16 v[48:63], v[28:31], v[196:199], v[48:63]
    s_waitcnt lgkmcnt(4)
    ds_read_b64_tr_b16 v[28:29], v5 offset:38912
    ds_read_b64_tr_b16 v[30:31], v5 offset:39424
    v_mfma_f32_32x32x16_bf16 v[32:47], v[16:19], v[200:203], v[32:47]
    s_waitcnt lgkmcnt(4)
    ds_read_b64_tr_b16 v[16:17], v4 offset:40960
    ds_read_b64_tr_b16 v[18:19], v4 offset:41472
    v_mfma_f32_32x32x16_bf16 v[32:47], v[20:23], v[204:207], v[32:47]
    s_waitcnt lgkmcnt(4)
    ds_read_b64_tr_b16 v[20:21], v4 offset:43008
    ds_read_b64_tr_b16 v[22:23], v4 offset:43520
    v_mfma_f32_32x32x16_bf16 v[48:63], v[24:27], v[200:203], v[48:63]
    s_waitcnt lgkmcnt(4)
    ds_read_b64_tr_b16 v[24:25], v5 offset:40960
    ds_read_b64_tr_b16 v[26:27], v5 offset:41472
    v_mfma_f32_32x32x16_bf16 v[48:63], v[28:31], v[204:207], v[48:63]
    s_waitcnt lgkmcnt(4)
    ds_read_b64_tr_b16 v[28:29], v5 offset:43008
    ds_read_b64_tr_b16 v[30:31], v5 offset:43520
    v_mfma_f32_32x32x16_bf16 v[32:47], v[16:19], v[208:211], v[32:47]
    s_waitcnt lgkmcnt(4)
    ds_read_b64_tr_b16 v[16:17], v4 offset:45056
    ds_read_b64_tr_b16 v[18:19], v4 offset:45568
    v_mfma_f32_32x32x16_bf16 v[32:47], v[20:23], v[212:215], v[32:47]
    s_waitcnt lgkmcnt(4)
    ds_read_b64_tr_b16 v[20:21], v4 offset:47104
    ds_read_b64_tr_b16 v[22:23], v4 offset:47616
    v_mfma_f32_32x32x16_bf16 v[48:63], v[24:27], v[208:211], v[48:63]
    s_waitcnt lgkmcnt(4)
    ds_read_b64_tr_b16 v[24:25], v5 offset:45056
    ds_read_b64_tr_b16 v[26:27], v5 offset:45568
    v_mfma_f32_32x32x16_bf16 v[48:63], v[28:31], v[212:215], v[48:63]
    s_waitcnt lgkmcnt(4)
    ds_read_b64_tr_b16 v[28:29], v5 offset:47104
    ds_read_b64_tr_b16 v[30:31], v5 offset:47616
    v_mfma_f32_32x32x16_bf16 v[32:47], v[16:19], v[216:219], v[32:47]
    s_waitcnt lgkmcnt(4)
    ds_read_b64_tr_b16 v[16:17], v4 offset:49152
    ds_read_b64_tr_b16 v[18:19], v4 offset:49664
    v_mfma_f32_32x32x16_bf16 v[32:47], v[20:23], v[220:223], v[32:47]
    s_waitcnt lgkmcnt(4)
    ds_read_b64_tr_b16 v[20:21], v4 offset:51200
    ds_read_b64_tr_b16 v[22:23], v4 offset:51712
    v_mfma_f32_32x32x16_bf16 v[48:63], v[24:27], v[216:219], v[48:63]
    s_waitcnt lgkmcnt(4)
    ds_read_b64_tr_b16 v[24:25], v5 offset:49152
    ds_read_b64_tr_b16 v[26:27], v5 offset:49664
    v_mfma_f32_32x32x16_bf16 v[48:63], v[28:31], v[220:223], v[48:63]
    s_waitcnt lgkmcnt(4)
    ds_read_b64_tr_b16 v[28:29], v5 offset:51200
    ds_read_b64_tr_b16 v[30:31], v5 offset:51712
    v_mov_b32 v14, 1
    v_lshl_add_u32 v12, v1, 7, s80
    s_waitcnt vmcnt(0)
    s_mov_b64 exec, 1
    ds_add_rtn_u32 v13, v13, v14
    s_mov_b64 exec, -1
    v_mfma_f32_32x32x16_bf16 v[32:47], v[16:19], v[224:227], v[32:47]
    s_waitcnt lgkmcnt(5)
    ds_read_b64_tr_b16 v[16:17], v4 offset:53248
    ds_read_b64_tr_b16 v[18:19], v4 offset:53760
    v_mfma_f32_32x32x16_bf16 v[32:47], v[20:23], v[228:231], v[32:47]
    s_waitcnt lgkmcnt(5)
    ds_read_b64_tr_b16 v[20:21], v4 offset:55296
    ds_read_b64_tr_b16 v[22:23], v4 offset:55808
    v_mfma_f32_32x32x16_bf16 v[48:63], v[24:27], v[224:227], v[48:63]
    s_waitcnt lgkmcnt(5)
    ds_read_b64_tr_b16 v[24:25], v5 offset:53248
    ds_read_b64_tr_b16 v[26:27], v5 offset:53760
    s_waitcnt lgkmcnt(6)
    v_readfirstlane_b32 s3, v13
    v_mov_b32 v14, s81
    s_cmp_eq_u32 s3, s17
    s_cselect_b64 exec, s[82:83], 0
    buffer_atomic_add v14, v12, s[12:15], 0 offen
    s_mov_b64 exec, -1
    v_mfma_f32_32x32x16_bf16 v[48:63], v[28:31], v[228:231], v[48:63]
    s_waitcnt lgkmcnt(4)
    ds_read_b64_tr_b16 v[28:29], v5 offset:55296
    ds_read_b64_tr_b16 v[30:31], v5 offset:55808
    v_mfma_f32_32x32x16_bf16 v[32:47], v[16:19], v[232:235], v[32:47]
    s_waitcnt lgkmcnt(4)
    ds_read_b64_tr_b16 v[16:17], v4 offset:57344
    ds_read_b64_tr_b16 v[18:19], v4 offset:57856
    v_mfma_f32_32x32x16_bf16 v[32:47], v[20:23], v[236:239], v[32:47]
    s_waitcnt lgkmcnt(4)
    ds_read_b64_tr_b16 v[20:21], v4 offset:59392
    ds_read_b64_tr_b16 v[22:23], v4 offset:59904
    v_mfma_f32_32x32x16_bf16 v[48:63], v[24:27], v[232:235], v[48:63]
    s_waitcnt lgkmcnt(4)
    ds_read_b64_tr_b16 v[24:25], v5 offset:57344
    ds_read_b64_tr_b16 v[26:27], v5 offset:57856
    v_mfma_f32_32x32x16_bf16 v[48:63], v[28:31], v[236:239], v[48:63]
    s_waitcnt lgkmcnt(4)
    ds_read_b64_tr_b16 v[28:29], v5 offset:59392
    ds_read_b64_tr_b16 v[30:31], v5 offset:59904
    v_mfma_f32_32x32x16_bf16 v[32:47], v[16:19], v[240:243], v[32:47]
    s_waitcnt lgkmcnt(4)
    ds_read_b64_tr_b16 v[16:17], v4 offset:61440
    ds_read_b64_tr_b16 v[18:19], v4 offset:61952
    v_mfma_f32_32x32x16_bf16 v[32:47], v[20:23], v[244:247], v[32:47]
    s_waitcnt lgkmcnt(4)
    ds_read_b64_tr_b16 v[20:21], v4 offset:63488
    ds_read_b64_tr_b16 v[22:23], v4 offset:64000
    v_mfma_f32_32x32x16_bf16 v[48:63], v[24:27], v[240:243], v[48:63]
    s_waitcnt lgkmcnt(4)
    ds_read_b64_tr_b16 v[24:25], v5 offset:61440
    ds_read_b64_tr_b16 v[26:27], v5 offset:61952
    v_mfma_f32_32x32x16_bf16 v[48:63], v[28:31], v[244:247], v[48:63]
    s_waitcnt lgkmcnt(4)
    ds_read_b64_tr_b16 v[28:29], v5 offset:63488
    ds_read_b64_tr_b16 v[30:31], v5 offset:64000
    v_mfma_f32_32x32x16_bf16 v[32:47], v[16:19], v[248:251], v[32:47]
    s_barrier
    ds_read_b64_tr_b16 v[16:17], v8 offset:32768
    ds_read_b64_tr_b16 v[18:19], v8 offset:33280
    s_waitcnt lgkmcnt(6)
    v_mfma_f32_32x32x16_bf16 v[32:47], v[20:23], v[252:255], v[32:47]
    s_waitcnt lgkmcnt(4)
    ds_read_b64_tr_b16 v[20:21], v8 offset:34816
    ds_read_b64_tr_b16 v[22:23], v8 offset:35328
    v_mfma_f32_32x32x16_bf16 v[48:63], v[24:27], v[248:251], v[48:63]
    s_waitcnt lgkmcnt(4)
    ds_read_b64_tr_b16 v[24:25], v9 offset:32768
    ds_read_b64_tr_b16 v[26:27], v9 offset:33280
    v_mfma_f32_32x32x16_bf16 v[48:63], v[28:31], v[252:255], v[48:63]
    v_cvt_pk_bf16_f32 v32, v32, v33
    v_cvt_pk_bf16_f32 v33, v34, v35
    s_cmp_eq_u32 s33, 0
    s_cbranch_scc1 PA_LSKIP
    ds_read_b64_tr_b16 v[28:29], v9 offset:34816
    ds_read_b64_tr_b16 v[30:31], v9 offset:35328
    s_waitcnt lgkmcnt(6)
    v_mfma_f32_32x32x16_bf16 v[64:79], v[16:19], v[96:99], 0
    s_waitcnt lgkmcnt(4)
    ds_read_b64_tr_b16 v[16:17], v8 offset:36864
    ds_read_b64_tr_b16 v[18:19], v8 offset:37376
    v_cvt_pk_bf16_f32 v34, v36, v37
    v_cvt_pk_bf16_f32 v35, v38, v39
    v_mfma_f32_32x32x16_bf16 v[64:79], v[20:23], v[100:103], v[64:79]
    s_waitcnt lgkmcnt(4)
    ds_read_b64_tr_b16 v[20:21], v8 offset:38912
    ds_read_b64_tr_b16 v[22:23], v8 offset:39424
    v_pk_max_i16 v32, v32, 0
    v_pk_max_i16 v33, v33, 0
    v_mfma_f32_32x32x16_bf16 v[80:95], v[24:27], v[96:99], 0
    s_waitcnt lgkmcnt(4)
    ds_read_b64_tr_b16 v[24:25], v9 offset:36864
    ds_read_b64_tr_b16 v[26:27], v9 offset:37376
    v_pk_max_i16 v34, v34, 0
    v_pk_max_i16 v35, v35, 0
    v_mfma_f32_32x32x16_bf16 v[80:95], v[28:31], v[100:103], v[80:95]
    s_waitcnt lgkmcnt(4)
    ds_read_b64_tr_b16 v[28:29], v9 offset:38912
    ds_read_b64_tr_b16 v[30:31], v9 offset:39424
    v_cvt_pk_bf16_f32 v36, v40, v41
    v_cvt_pk_bf16_f32 v37, v42, v43
    buffer_store_dwordx4 v[32:35], v1, s[28:31], s76 offen offset:0 sc1
    v_mfma_f32_32x32x16_bf16 v[64:79], v[16:19], v[104:107], v[64:79]
    s_waitcnt lgkmcnt(4)
    ds_read_b64_tr_b16 v[16:17], v8 offset:40960
    ds_read_b64_tr_b16 v[18:19], v8 offset:41472
    v_cvt_pk_bf16_f32 v38, v44, v45
    v_cvt_pk_bf16_f32 v39, v46, v47
    v_mfma_f32_32x32x16_bf16 v[64:79], v[20:23], v[108:111], v[64:79]
    s_waitcnt lgkmcnt(4)
    ds_read_b64_tr_b16 v[20:21], v8 offset:43008
    ds_read_b64_tr_b16 v[22:23], v8 offset:43520
    v_pk_max_i16 v36, v36, 0
    v_pk_max_i16 v37, v37, 0
    v_mfma_f32_32x32x16_bf16 v[80:95], v[24:27], v[104:107], v[80:95]
    s_waitcnt lgkmcnt(4)
    ds_read_b64_tr_b16 v[24:25], v9 offset:40960
    ds_read_b64_tr_b16 v[26:27], v9 offset:41472
    v_pk_max_i16 v38, v38, 0
    v_pk_max_i16 v39, v39, 0
    v_mfma_f32_32x32x16_bf16 v[80:95], v[28:31], v[108:111], v[80:95]
    s_waitcnt lgkmcnt(4)
    ds_read_b64_tr_b16 v[28:29], v9 offset:43008
    ds_read_b64_tr_b16 v[30:31], v9 offset:43520
    v_cvt_pk_bf16_f32 v48, v48, v49
    v_cvt_pk_bf16_f32 v49, v50, v51
    v_mfma_f32_32x32x16_bf16 v[64:79], v[16:19], v[112:115], v[64:79]
    s_waitcnt lgkmcnt(4)
    ds_read_b64_tr_b16 v[16:17], v8 offset:45056
    ds_read_b64_tr_b16 v[18:19], v8 offset:45568
    v_cvt_pk_bf16_f32 v50, v52, v53
    v_cvt_pk_bf16_f32 v51, v54, v55
    v_mfma_f32_32x32x16_bf16 v[64:79], v[20:23], v[116:119], v[64:79]
    s_waitcnt lgkmcnt(4)
    ds_read_b64_tr_b16 v[20:21], v8 offset:47104
    ds_read_b64_tr_b16 v[22:23], v8 offset:47616
    v_pk_max_i16 v48, v48, 0
    v_pk_max_i16 v49, v49, 0
    v_mfma_f32_32x32x16_bf16 v[80:95], v[24:27], v[112:115], v[80:95]
    s_waitcnt lgkmcnt(4)
    ds_read_b64_tr_b16 v[24:25], v9 offset:45056
    ds_read_b64_tr_b16 v[26:27], v9 offset:45568
    v_pk_max_i16 v50, v50, 0
    v_pk_max_i16 v51, v51, 0
    v_mfma_f32_32x32x16_bf16 v[80:95], v[28:31], v[116:119], v[80:95]
    s_waitcnt lgkmcnt(4)
    ds_read_b64_tr_b16 v[28:29], v9 offset:47104
    ds_read_b64_tr_b16 v[30:31], v9 offset:47616
    v_cvt_pk_bf16_f32 v52, v56, v57
    v_cvt_pk_bf16_f32 v53, v58, v59
    v_mfma_f32_32x32x16_bf16 v[64:79], v[16:19], v[120:123], v[64:79]
    s_waitcnt lgkmcnt(4)
    ds_read_b64_tr_b16 v[16:17], v6 offset:0
    ds_read_b64_tr_b16 v[18:19], v6 offset:512
    v_cvt_pk_bf16_f32 v54, v60, v61
    v_cvt_pk_bf16_f32 v55, v62, v63
    v_mfma_f32_32x32x16_bf16 v[64:79], v[20:23], v[124:127], v[64:79]
    s_waitcnt lgkmcnt(4)
    ds_read_b64_tr_b16 v[20:21], v6 offset:2048
    ds_read_b64_tr_b16 v[22:23], v6 offset:2560
    v_pk_max_i16 v52, v52, 0
    v_pk_max_i16 v53, v53, 0
    v_mfma_f32_32x32x16_bf16 v[80:95], v[24:27], v[120:123], v[80:95]
    s_waitcnt lgkmcnt(4)
    ds_read_b64_tr_b16 v[24:25], v7 offset:0
    ds_read_b64_tr_b16 v[26:27], v7 offset:512
    v_pk_max_i16 v54, v54, 0
    v_pk_max_i16 v55, v55, 0
    v_mfma_f32_32x32x16_bf16 v[80:95], v[28:31], v[124:127], v[80:95]
    s_waitcnt lgkmcnt(4)
    ds_read_b64_tr_b16 v[28:29], v7 offset:2048
    ds_read_b64_tr_b16 v[30:31], v7 offset:2560
    s_and_b32 s3, s2, 7
    s_lshl_b32 s3, s3, 2
    buffer_store_dwordx4 v[36:39], v1, s[28:31], s76 offen offset:1024 sc1
    s_add_u32 s76, s76, 4096
    v_mfma_f32_32x32x16_bf16 v[64:79], v[16:19], v[128:131], v[64:79]
    s_waitcnt lgkmcnt(4)
    ds_read_b64_tr_b16 v[16:17], v6 offset:4096
    ds_read_b64_tr_b16 v[18:19], v6 offset:4608
    s_bfe_u32 s36, s2, 0x20003
    s_add_u32 s36, s3, s36
    v_mfma_f32_32x32x16_bf16 v[64:79], v[20:23], v[132:135], v[64:79]
    s_waitcnt lgkmcnt(4)
    ds_read_b64_tr_b16 v[20:21], v6 offset:6144
    ds_read_b64_tr_b16 v[22:23], v6 offset:6656
    s_bfe_u32 s3, s2, 0x10005
    s_lshl_b32 s3, s3, 2
    v_mfma_f32_32x32x16_bf16 v[80:95], v[24:27], v[128:131], v[80:95]
    s_waitcnt lgkmcnt(4)
    ds_read_b64_tr_b16 v[24:25], v7 offset:4096
    ds_read_b64_tr_b16 v[26:27], v7 offset:4608
    s_lshr_b32 s37, s2, 6
    s_add_u32 s37, s37, s3
    v_mfma_f32_32x32x16_bf16 v[80:95], v[28:31], v[132:135], v[80:95]
    s_waitcnt lgkmcnt(4)
    ds_read_b64_tr_b16 v[28:29], v7 offset:6144
    ds_read_b64_tr_b16 v[30:31], v7 offset:6656
    s_add_u32 s20, s8, 20971520
    s_addc_u32 s21, s9, 0
    v_mfma_f32_32x32x16_bf16 v[64:79], v[16:19], v[136:139], v[64:79]
    s_waitcnt lgkmcnt(4)
    ds_read_b64_tr_b16 v[16:17], v6 offset:8192
    ds_read_b64_tr_b16 v[18:19], v6 offset:8704
    s_and_b32 s21, s21, 0xffff
    s_mov_b32 s22, 2621440
    v_mfma_f32_32x32x16_bf16 v[64:79], v[20:23], v[140:143], v[64:79]
    s_waitcnt lgkmcnt(4)
    ds_read_b64_tr_b16 v[20:21], v6 offset:10240
    ds_read_b64_tr_b16 v[22:23], v6 offset:10752
    s_mov_b32 s23, 0x00020000
    s_mov_b32 s39, 0
    v_mfma_f32_32x32x16_bf16 v[80:95], v[24:27], v[136:139], v[80:95]
    s_waitcnt lgkmcnt(4)
    ds_read_b64_tr_b16 v[24:25], v7 offset:8192
    ds_read_b64_tr_b16 v[26:27], v7 offset:8704
    s_mul_i32 s3, s38, 3072
    s_add_u32 s3, s3, 147456
    v_mfma_f32_32x32x16_bf16 v[80:95], v[28:31], v[140:143], v[80:95]
    s_waitcnt lgkmcnt(4)
    ds_read_b64_tr_b16 v[28:29], v7 offset:10240
    ds_read_b64_tr_b16 v[30:31], v7 offset:10752
    v_add_u32 v11, s3, v1
    v_bfe_u32 v4, v1, 4, 5
    v_mfma_f32_32x32x16_bf16 v[64:79], v[16:19], v[144:147], v[64:79]
    s_waitcnt lgkmcnt(4)
    ds_read_b64_tr_b16 v[16:17], v6 offset:12288
    ds_read_b64_tr_b16 v[18:19], v6 offset:12800
    v_lshrrev_b32 v5, 9, v1
    v_lshlrev_b32 v2, 3, v4
    v_mfma_f32_32x32x16_bf16 v[64:79], v[20:23], v[148:151], v[64:79]
    s_waitcnt lgkmcnt(4)
    ds_read_b64_tr_b16 v[20:21], v6 offset:14336
    ds_read_b64_tr_b16 v[22:23], v6 offset:14848
    v_lshl_add_u32 v12, v5, 8, v2
    v_add_u32 v2, 9472, v2
    v_mfma_f32_32x32x16_bf16 v[80:95], v[24:27], v[144:147], v[80:95]
    s_waitcnt lgkmcnt(4)
    ds_read_b64_tr_b16 v[24:25], v7 offset:12288
    ds_read_b64_tr_b16 v[26:27], v7 offset:12800
    v_mov_b32 v3, 9728
    v_cmp_eq_u32 vcc, 0, v5
    v_mfma_f32_32x32x16_bf16 v[80:95], v[28:31], v[148:151], v[80:95]
    s_waitcnt lgkmcnt(4)
    ds_read_b64_tr_b16 v[28:29], v7 offset:14336
    ds_read_b64_tr_b16 v[30:31], v7 offset:14848
    v_mul_u32_u24 v0, 320, v5
    v_cndmask_b32 v13, v3, v2, vcc
    buffer_store_dwordx4 v[48:51], v1, s[28:31], s76 offen offset:0 sc1
    v_mfma_f32_32x32x16_bf16 v[64:79], v[16:19], v[152:155], v[64:79]
    s_waitcnt lgkmcnt(4)
    ds_read_b64_tr_b16 v[16:17], v6 offset:16384
    ds_read_b64_tr_b16 v[18:19], v6 offset:16896
    v_lshl_add_u32 v2, v4, 4, v0
    v_cmp_gt_u32 vcc, 20, v4
    v_mfma_f32_32x32x16_bf16 v[64:79], v[20:23], v[156:159], v[64:79]
    s_waitcnt lgkmcnt(4)
    ds_read_b64_tr_b16 v[20:21], v6 offset:18432
    ds_read_b64_tr_b16 v[22:23], v6 offset:18944
    v_add_u32 v14, 8192, v2
    v_add_u32 v15, 8832, v2
    v_mfma_f32_32x32x16_bf16 v[80:95], v[24:27], v[152:155], v[80:95]
    s_waitcnt lgkmcnt(4)
    ds_read_b64_tr_b16 v[24:25], v7 offset:16384
    ds_read_b64_tr_b16 v[26:27], v7 offset:16896
    v_min_u32 v3, 21, v4
    v_lshlrev_b32 v3, 4, v3
    v_mfma_f32_32x32x16_bf16 v[80:95], v[28:31], v[156:159], v[80:95]
    s_waitcnt lgkmcnt(4)
    ds_read_b64_tr_b16 v[28:29], v7 offset:18432
    ds_read_b64_tr_b16 v[30:31], v7 offset:18944
    v_add_u32 v3, 9424, v3
    v_cndmask_b32 v14, v3, v14, vcc
    v_mfma_f32_32x32x16_bf16 v[64:79], v[16:19], v[160:163], v[64:79]
    s_waitcnt lgkmcnt(4)
    ds_read_b64_tr_b16 v[16:17], v6 offset:20480
    ds_read_b64_tr_b16 v[18:19], v6 offset:20992
    v_cndmask_b32 v15, v3, v15, vcc
    v_mov_b32 v96, 0
    v_mfma_f32_32x32x16_bf16 v[64:79], v[20:23], v[164:167], v[64:79]
    s_waitcnt lgkmcnt(4)
    ds_read_b64_tr_b16 v[20:21], v6 offset:22528
    ds_read_b64_tr_b16 v[22:23], v6 offset:23040
    v_mov_b32 v97, 0
    v_mov_b32 v98, 0
    v_mfma_f32_32x32x16_bf16 v[80:95], v[24:27], v[160:163], v[80:95]
    s_waitcnt lgkmcnt(4)
    ds_read_b64_tr_b16 v[24:25], v7 offset:20480
    ds_read_b64_tr_b16 v[26:27], v7 offset:20992
    v_mov_b32 v99, 0
    v_mov_b32 v100, 0
    v_mfma_f32_32x32x16_bf16 v[80:95], v[28:31], v[164:167], v[80:95]
    s_waitcnt lgkmcnt(4)
    ds_read_b64_tr_b16 v[28:29], v7 offset:22528
    ds_read_b64_tr_b16 v[30:31], v7 offset:23040
    v_mov_b32 v101, 0
    v_mov_b32 v102, 0
    v_mfma_f32_32x32x16_bf16 v[64:79], v[16:19], v[168:171], v[64:79]
    s_waitcnt lgkmcnt(4)
    ds_read_b64_tr_b16 v[16:17], v6 offset:24576
    ds_read_b64_tr_b16 v[18:19], v6 offset:25088
    v_mov_b32 v103, 0
    v_mov_b32 v104, 0
    v_mfma_f32_32x32x16_bf16 v[64:79], v[20:23], v[172:175], v[64:79]
    s_waitcnt lgkmcnt(4)
    ds_read_b64_tr_b16 v[20:21], v6 offset:26624
    ds_read_b64_tr_b16 v[22:23], v6 offset:27136
    v_mov_b32 v105, 0
    v_mov_b32 v106, 0
    v_mfma_f32_32x32x16_bf16 v[80:95], v[24:27], v[168:171], v[80:95]
    s_waitcnt lgkmcnt(4)
    ds_read_b64_tr_b16 v[24:25], v7 offset:24576
    ds_read_b64_tr_b16 v[26:27], v7 offset:25088
    v_mov_b32 v107, 0
    v_mov_b32 v108, 0
    v_mfma_f32_32x32x16_bf16 v[80:95], v[28:31], v[172:175], v[80:95]
    s_waitcnt lgkmcnt(4)
    ds_read_b64_tr_b16 v[28:29], v7 offset:26624
    ds_read_b64_tr_b16 v[30:31], v7 offset:27136
    v_mov_b32 v109, 0
    v_mov_b32 v110, 0
    buffer_store_dwordx4 v[52:55], v1, s[28:31], s76 offen offset:1024 sc1
    v_mfma_f32_32x32x16_bf16 v[64:79], v[16:19], v[176:179], v[64:79]
    s_waitcnt lgkmcnt(4)
    ds_read_b64_tr_b16 v[16:17], v6 offset:28672
    ds_read_b64_tr_b16 v[18:19], v6 offset:29184
    v_mov_b32 v111, 0
    v_mov_b32 v112, 0
    v_mfma_f32_32x32x16_bf16 v[64:79], v[20:23], v[180:183], v[64:79]
    s_waitcnt lgkmcnt(4)
    ds_read_b64_tr_b16 v[20:21], v6 offset:30720
    ds_read_b64_tr_b16 v[22:23], v6 offset:31232
    v_mov_b32 v113, 0
    v_mov_b32 v114, 0
    v_mfma_f32_32x32x16_bf16 v[80:95], v[24:27], v[176:179], v[80:95]
    s_waitcnt lgkmcnt(4)
    ds_read_b64_tr_b16 v[24:25], v7 offset:28672
    ds_read_b64_tr_b16 v[26:27], v7 offset:29184
    v_mov_b32 v115, 0
    v_mov_b32 v116, 0
    v_mfma_f32_32x32x16_bf16 v[80:95], v[28:31], v[180:183], v[80:95]
    s_waitcnt lgkmcnt(4)
    ds_read_b64_tr_b16 v[28:29], v7 offset:30720
    ds_read_b64_tr_b16 v[30:31], v7 offset:31232
    v_mov_b32 v117, 0
    v_mov_b32 v118, 0
    v_mfma_f32_32x32x16_bf16 v[64:79], v[16:19], v[184:187], v[64:79]
    s_waitcnt lgkmcnt(4)
    ds_read_b64_tr_b16 v[16:17], v6 offset:32768
    ds_read_b64_tr_b16 v[18:19], v6 offset:33280
    v_mov_b32 v119, 0
    v_mov_b32 v120, 0
    v_mfma_f32_32x32x16_bf16 v[64:79], v[20:23], v[188:191], v[64:79]
    s_waitcnt lgkmcnt(4)
    ds_read_b64_tr_b16 v[20:21], v6 offset:34816
    ds_read_b64_tr_b16 v[22:23], v6 offset:35328
    v_mov_b32 v121, 0
    v_mov_b32 v122, 0
    v_mfma_f32_32x32x16_bf16 v[80:95], v[24:27], v[184:187], v[80:95]
    s_waitcnt lgkmcnt(4)
    ds_read_b64_tr_b16 v[24:25], v7 offset:32768
    ds_read_b64_tr_b16 v[26:27], v7 offset:33280
    v_mov_b32 v123, 0
    v_mov_b32 v124, 0
    v_mfma_f32_32x32x16_bf16 v[80:95], v[28:31], v[188:191], v[80:95]
    s_waitcnt lgkmcnt(4)
    ds_read_b64_tr_b16 v[28:29], v7 offset:34816
    ds_read_b64_tr_b16 v[30:31], v7 offset:35328
    v_mov_b32 v125, 0
    v_mov_b32 v126, 0
    v_mfma_f32_32x32x16_bf16 v[64:79], v[16:19], v[192:195], v[64:79]
    s_waitcnt lgkmcnt(4)
    ds_read_b64_tr_b16 v[16:17], v6 offset:36864
    ds_read_b64_tr_b16 v[18:19], v6 offset:37376
    v_mov_b32 v127, 0
    v_mov_b32 v132, 0
    v_mfma_f32_32x32x16_bf16 v[64:79], v[20:23], v[196:199], v[64:79]
    s_waitcnt lgkmcnt(4)
    ds_read_b64_tr_b16 v[20:21], v6 offset:38912
    ds_read_b64_tr_b16 v[22:23], v6 offset:39424
    v_mov_b32 v133, 0
    v_mov_b32 v134, 0
    v_mfma_f32_32x32x16_bf16 v[80:95], v[24:27], v[192:195], v[80:95]
    s_waitcnt lgkmcnt(4)
    ds_read_b64_tr_b16 v[24:25], v7 offset:36864
    ds_read_b64_tr_b16 v[26:27], v7 offset:37376
    v_mov_b32 v135, 0
    v_mov_b32 v52, 0
    v_mfma_f32_32x32x16_bf16 v[80:95], v[28:31], v[196:199], v[80:95]
    s_waitcnt lgkmcnt(4)
    ds_read_b64_tr_b16 v[28:29], v7 offset:38912
    ds_read_b64_tr_b16 v[30:31], v7 offset:39424
    v_mov_b32 v53, 0
    v_mov_b32 v54, 0
    v_mfma_f32_32x32x16_bf16 v[64:79], v[16:19], v[200:203], v[64:79]
    s_waitcnt lgkmcnt(4)
    ds_read_b64_tr_b16 v[16:17], v6 offset:40960
    ds_read_b64_tr_b16 v[18:19], v6 offset:41472
    v_mov_b32 v55, 0
    v_mov_b32 v60, 0
    v_mfma_f32_32x32x16_bf16 v[64:79], v[20:23], v[204:207], v[64:79]
    s_waitcnt lgkmcnt(4)
    ds_read_b64_tr_b16 v[20:21], v6 offset:43008
    ds_read_b64_tr_b16 v[22:23], v6 offset:43520
    v_mov_b32 v61, 0
    v_mov_b32 v62, 0
    v_mfma_f32_32x32x16_bf16 v[80:95], v[24:27], v[200:203], v[80:95]
    s_waitcnt lgkmcnt(4)
    ds_read_b64_tr_b16 v[24:25], v7 offset:40960
    ds_read_b64_tr_b16 v[26:27], v7 offset:41472
    v_mov_b32 v63, 0
    v_mfma_f32_32x32x16_bf16 v[80:95], v[28:31], v[204:207], v[80:95]
    s_waitcnt lgkmcnt(4)
    ds_read_b64_tr_b16 v[28:29], v7 offset:43008
    ds_read_b64_tr_b16 v[30:31], v7 offset:43520
    v_mfma_f32_32x32x16_bf16 v[64:79], v[16:19], v[208:211], v[64:79]
    s_waitcnt lgkmcnt(4)
    ds_read_b64_tr_b16 v[16:17], v6 offset:45056
    ds_read_b64_tr_b16 v[18:19], v6 offset:45568
    v_mfma_f32_32x32x16_bf16 v[64:79], v[20:23], v[212:215], v[64:79]
    s_waitcnt lgkmcnt(4)
    ds_read_b64_tr_b16 v[20:21], v6 offset:47104
    ds_read_b64_tr_b16 v[22:23], v6 offset:47616
    v_mfma_f32_32x32x16_bf16 v[80:95], v[24:27], v[208:211], v[80:95]
    s_waitcnt lgkmcnt(4)
    ds_read_b64_tr_b16 v[24:25], v7 offset:45056
    ds_read_b64_tr_b16 v[26:27], v7 offset:45568
    v_mfma_f32_32x32x16_bf16 v[80:95], v[28:31], v[212:215], v[80:95]
    s_waitcnt lgkmcnt(4)
    ds_read_b64_tr_b16 v[28:29], v7 offset:47104
    ds_read_b64_tr_b16 v[30:31], v7 offset:47616
    v_mfma_f32_32x32x16_bf16 v[64:79], v[16:19], v[216:219], v[64:79]
    s_waitcnt lgkmcnt(4)
    ds_read_b64_tr_b16 v[16:17], v8 offset:16384
    ds_read_b64_tr_b16 v[18:19], v8 offset:16896
    v_mfma_f32_32x32x16_bf16 v[64:79], v[20:23], v[220:223], v[64:79]
    s_waitcnt lgkmcnt(4)
    ds_read_b64_tr_b16 v[20:21], v8 offset:18432
    ds_read_b64_tr_b16 v[22:23], v8 offset:18944
    v_mfma_f32_32x32x16_bf16 v[80:95], v[24:27], v[216:219], v[80:95]
    s_waitcnt lgkmcnt(4)
    ds_read_b64_tr_b16 v[24:25], v8 offset:20480
    ds_read_b64_tr_b16 v[26:27], v8 offset:20992
    v_mfma_f32_32x32x16_bf16 v[80:95], v[28:31], v[220:223], v[80:95]
    s_waitcnt lgkmcnt(4)
    ds_read_b64_tr_b16 v[28:29], v8 offset:22528
    ds_read_b64_tr_b16 v[30:31], v8 offset:23040
    v_mfma_f32_32x32x16_bf16 v[64:79], v[16:19], v[224:227], v[64:79]
    s_waitcnt lgkmcnt(4)
    ds_read_b64_tr_b16 v[16:17], v8 offset:24576
    ds_read_b64_tr_b16 v[18:19], v8 offset:25088
    v_mfma_f32_32x32x16_bf16 v[64:79], v[20:23], v[228:231], v[64:79]
    s_waitcnt lgkmcnt(4)
    ds_read_b64_tr_b16 v[20:21], v8 offset:26624
    ds_read_b64_tr_b16 v[22:23], v8 offset:27136
    v_mfma_f32_32x32x16_bf16 v[64:79], v[24:27], v[232:235], v[64:79]
    s_waitcnt lgkmcnt(4)
    ds_read_b64_tr_b16 v[24:25], v8 offset:28672
    ds_read_b64_tr_b16 v[26:27], v8 offset:29184
    v_mfma_f32_32x32x16_bf16 v[64:79], v[28:31], v[236:239], v[64:79]
    s_waitcnt lgkmcnt(4)
    ds_read_b64_tr_b16 v[28:29], v8 offset:30720
    ds_read_b64_tr_b16 v[30:31], v8 offset:31232
    v_mfma_f32_32x32x16_bf16 v[64:79], v[16:19], v[240:243], v[64:79]
    s_waitcnt lgkmcnt(4)
    ds_read_b64_tr_b16 v[16:17], v9 offset:16384
    ds_read_b64_tr_b16 v[18:19], v9 offset:16896
    v_mfma_f32_32x32x16_bf16 v[64:79], v[20:23], v[244:247], v[64:79]
    s_waitcnt lgkmcnt(4)
    ds_read_b64_tr_b16 v[20:21], v9 offset:18432
    ds_read_b64_tr_b16 v[22:23], v9 offset:18944
    v_mfma_f32_32x32x16_bf16 v[64:79], v[24:27], v[248:251], v[64:79]
    s_waitcnt lgkmcnt(4)
    ds_read_b64_tr_b16 v[24:25], v9 offset:20480
    ds_read_b64_tr_b16 v[26:27], v9 offset:20992
    v_mfma_f32_32x32x16_bf16 v[64:79], v[28:31], v[252:255], v[64:79]
    s_waitcnt lgkmcnt(4)
    ds_read_b64_tr_b16 v[28:29], v9 offset:22528
    ds_read_b64_tr_b16 v[30:31], v9 offset:23040
    v_mfma_f32_32x32x16_bf16 v[80:95], v[16:19], v[224:227], v[80:95]
    s_waitcnt lgkmcnt(4)
    ds_read_b64_tr_b16 v[16:17], v9 offset:24576
    ds_read_b64_tr_b16 v[18:19], v9 offset:25088
    v_mfma_f32_32x32x16_bf16 v[80:95], v[20:23], v[228:231], v[80:95]
    s_waitcnt lgkmcnt(4)
    ds_read_b64_tr_b16 v[20:21], v9 offset:26624
    ds_read_b64_tr_b16 v[22:23], v9 offset:27136
    v_cvt_pk_bf16_f32 v64, v64, v65
    v_cvt_pk_bf16_f32 v65, v66, v67
    v_mfma_f32_32x32x16_bf16 v[80:95], v[24:27], v[232:235], v[80:95]
    s_waitcnt lgkmcnt(4)
    ds_read_b64_tr_b16 v[24:25], v9 offset:28672
    ds_read_b64_tr_b16 v[26:27], v9 offset:29184
    v_cvt_pk_bf16_f32 v66, v68, v69
    v_cvt_pk_bf16_f32 v67, v70, v71
    v_mfma_f32_32x32x16_bf16 v[80:95], v[28:31], v[236:239], v[80:95]
    s_waitcnt lgkmcnt(4)
    ds_read_b64_tr_b16 v[28:29], v9 offset:30720
    ds_read_b64_tr_b16 v[30:31], v9 offset:31232
    v_pk_max_i16 v64, v64, 0
    v_pk_max_i16 v65, v65, 0
    v_mfma_f32_32x32x16_bf16 v[80:95], v[16:19], v[240:243], v[80:95]
    s_waitcnt lgkmcnt(4)
    v_pk_max_i16 v66, v66, 0
    v_pk_max_i16 v67, v67, 0
    v_mfma_f32_32x32x16_bf16 v[80:95], v[20:23], v[244:247], v[80:95]
    s_waitcnt lgkmcnt(2)
    v_cvt_pk_bf16_f32 v68, v72, v73
    v_cvt_pk_bf16_f32 v69, v74, v75
    buffer_store_dwordx4 v[64:67], v1, s[24:27], s77 offen offset:0 sc1
    v_mfma_f32_32x32x16_bf16 v[80:95], v[24:27], v[248:251], v[80:95]
    s_waitcnt lgkmcnt(0)
    v_cvt_pk_bf16_f32 v70, v76, v77
    v_cvt_pk_bf16_f32 v71, v78, v79
    v_mfma_f32_32x32x16_bf16 v[80:95], v[28:31], v[252:255], v[80:95]
    v_pk_max_i16 v68, v68, 0
    v_pk_max_i16 v69, v69, 0
    v_pk_max_i16 v70, v70, 0
    v_pk_max_i16 v71, v71, 0
    buffer_store_dwordx4 v[68:71], v1, s[24:27], s77 offen offset:1024 sc1
    s_add_u32 s77, s77, 4096
    s_nop 15
    s_nop 3
    v_cvt_pk_bf16_f32 v80, v80, v81
    v_cvt_pk_bf16_f32 v81, v82, v83
    v_cvt_pk_bf16_f32 v82, v84, v85
    v_cvt_pk_bf16_f32 v83, v86, v87
    v_pk_max_i16 v80, v80, 0
    v_pk_max_i16 v81, v81, 0
    v_pk_max_i16 v82, v82, 0
    v_pk_max_i16 v83, v83, 0
    buffer_store_dwordx4 v[80:83], v1, s[24:27], s77 offen offset:0 sc1
    v_cvt_pk_bf16_f32 v84, v88, v89
    v_cvt_pk_bf16_f32 v85, v90, v91
    v_cvt_pk_bf16_f32 v86, v92, v93
    v_cvt_pk_bf16_f32 v87, v94, v95
    v_pk_max_i16 v84, v84, 0
    v_pk_max_i16 v85, v85, 0
    v_pk_max_i16 v86, v86, 0
    v_pk_max_i16 v87, v87, 0
    buffer_store_dwordx4 v[84:87], v1, s[24:27], s77 offen offset:1024 sc1
PA_END:
    s_setprio 2
    s_branch PADX_7
PAD_7:
    s_branch PAD_11
PADX_7:
A_B1:
    s_barrier
    ds_read_b128 v[32:35], v11 offset:0
    ds_read_b128 v[36:39], v11 offset:1024
    ds_read_b128 v[40:43], v11 offset:2048
    v_mov_b32 v16, v1
    v_lshrrev_b32 v1, 4, v1
    v_and_b32 v17, 31, v1
    v_lshrrev_b32 v18, 5, v1
A_GO:
    ds_read2st64_b64 v[20:23], v12 offset0:0 offset1:1
    ds_read_b64 v[24:25], v13 offset:0
    ds_read_b128 v[28:31], v14 offset:0
    v_mov_b32 v92, 0
    v_mov_b32 v93, 0
    v_mov_b32 v94, 0
    v_mov_b32 v95, 0
    s_mov_b32 s40, 0
    s_mov_b32 s41, 21504
    s_mov_b32 s42, 21504
    s_mov_b32 s43, -43008
    s_waitcnt lgkmcnt(2)
    v_mfma_f32_32x32x16_bf16 v[64:79], v[20:23], v[32:35], 0
    s_waitcnt lgkmcnt(1)
    v_mfma_f32_32x32x8bf16_1k v[64:79], v[24:25], v[40:41], v[64:79]
    s_nop 15
    s_nop 3
    s_waitcnt lgkmcnt(0)
    s_branch K2_BODY
K2_STAGE:
    s_barrier
K2_BODY:
    v_mfma_f32_32x32x16_bf16 v[96:111], v[132:135], v[52:55], v[96:111]
    ds_read_b128 v[44:47], v15 offset:0
    ds_read_b64 v[26:27], v13 offset:1664
    v_exp_f32 v64, v64
    v_cvt_pk_bf16_f32 v62, v92, v93
    v_exp_f32 v65, v65
    v_cvt_pk_bf16_f32 v63, v94, v95
    v_exp_f32 v66, v66
    v_exp_f32 v67, v67
    v_mfma_f32_32x32x16_bf16 v[80:95], v[20:23], v[36:39], 0
    ds_read2st64_b64 v[20:23], v12 offset0:2 offset1:3
    ds_read_b128 v[128:131], v14 offset:1664
    v_exp_f32 v68, v68
    v_cvt_pk_bf16_f32 v48, v64, v65
    v_exp_f32 v69, v69
    v_cvt_pk_bf16_f32 v49, v66, v67
    v_exp_f32 v70, v70
    v_exp_f32 v71, v71
    v_mfma_f32_32x32x8bf16_1k v[80:95], v[24:25], v[42:43], v[80:95]
    v_exp_f32 v72, v72
    v_cvt_pk_bf16_f32 v50, v68, v69
    v_exp_f32 v73, v73
    v_cvt_pk_bf16_f32 v51, v70, v71
    v_exp_f32 v74, v74
    v_exp_f32 v75, v75
    v_mfma_f32_32x32x16_bf16 v[96:111], v[28:31], v[48:51], v[96:111]
    v_exp_f32 v76, v76
    v_cvt_pk_bf16_f32 v52, v72, v73
    v_exp_f32 v77, v77
    v_cvt_pk_bf16_f32 v53, v74, v75
    v_exp_f32 v78, v78
    v_exp_f32 v79, v79
    v_mfma_f32_32x32x16_bf16 v[112:127], v[132:135], v[60:63], v[112:127]
    v_exp_f32 v80, v80
    v_cvt_pk_bf16_f32 v54, v76, v77
    v_exp_f32 v81, v81
    v_cvt_pk_bf16_f32 v55, v78, v79
    v_exp_f32 v82, v82
    s_waitcnt lgkmcnt(0)
    v_exp_f32 v83, v83
    v_mfma_f32_32x32x16_bf16 v[64:79], v[20:23], v[32:35], 0
    v_exp_f32 v84, v84
    v_cvt_pk_bf16_f32 v56, v80, v81
    v_exp_f32 v85, v85
    v_cvt_pk_bf16_f32 v57, v82, v83
    v_exp_f32 v86, v86
    v_exp_f32 v87, v87
    v_mfma_f32_32x32x8bf16_1k v[64:79], v[26:27], v[40:41], v[64:79]
    v_exp_f32 v88, v88
    v_cvt_pk_bf16_f32 v58, v84, v85
    v_exp_f32 v89, v89
    v_cvt_pk_bf16_f32 v59, v86, v87
    v_exp_f32 v90, v90
    v_exp_f32 v91, v91
    v_mfma_f32_32x32x16_bf16 v[112:127], v[28:31], v[56:59], v[112:127]
    v_exp_f32 v92, v92
    v_cvt_pk_bf16_f32 v60, v88, v89
    v_exp_f32 v93, v93
    v_cvt_pk_bf16_f32 v61, v90, v91
    v_exp_f32 v94, v94
    v_exp_f32 v95, v95
    v_mfma_f32_32x32x16_bf16 v[96:111], v[44:47], v[52:55], v[96:111]
    ds_read_b128 v[132:135], v15 offset:1664
    ds_read_b64 v[24:25], v13 offset:3328
    v_exp_f32 v64, v64
    v_cvt_pk_bf16_f32 v62, v92, v93
    v_exp_f32 v65, v65
    v_cvt_pk_bf16_f32 v63, v94, v95
    v_exp_f32 v66, v66
    v_exp_f32 v67, v67
    v_mfma_f32_32x32x16_bf16 v[80:95], v[20:23], v[36:39], 0
    ds_read2st64_b64 v[20:23], v12 offset0:4 offset1:5
    ds_read_b128 v[28:31], v14 offset:3328
    v_exp_f32 v68, v68
    v_cvt_pk_bf16_f32 v48, v64, v65
    v_exp_f32 v69, v69
    v_cvt_pk_bf16_f32 v49, v66, v67
    v_exp_f32 v70, v70
    v_exp_f32 v71, v71
    v_mfma_f32_32x32x8bf16_1k v[80:95], v[26:27], v[42:43], v[80:95]
    v_exp_f32 v72, v72
    v_cvt_pk_bf16_f32 v50, v68, v69
    v_exp_f32 v73, v73
    v_cvt_pk_bf16_f32 v51, v70, v71
    v_exp_f32 v74, v74
    v_exp_f32 v75, v75
    v_mfma_f32_32x32x16_bf16 v[96:111], v[128:131], v[48:51], v[96:111]
    v_exp_f32 v76, v76
    v_cvt_pk_bf16_f32 v52, v72, v73
    v_exp_f32 v77, v77
    v_cvt_pk_bf16_f32 v53, v74, v75
    v_exp_f32 v78, v78
    v_exp_f32 v79, v79
    v_mfma_f32_32x32x16_bf16 v[112:127], v[44:47], v[60:63], v[112:127]
    v_exp_f32 v80, v80
    v_cvt_pk_bf16_f32 v54, v76, v77
    v_exp_f32 v81, v81
    v_cvt_pk_bf16_f32 v55, v78, v79
    v_exp_f32 v82, v82
    s_waitcnt lgkmcnt(0)
    v_exp_f32 v83, v83
    v_mfma_f32_32x32x16_bf16 v[64:79], v[20:23], v[32:35], 0
    v_exp_f32 v84, v84
    v_cvt_pk_bf16_f32 v56, v80, v81
    v_exp_f32 v85, v85
    v_cvt_pk_bf16_f32 v57, v82, v83
    v_exp_f32 v86, v86
    v_exp_f32 v87, v87
    v_mfma_f32_32x32x8bf16_1k v[64:79], v[24:25], v[40:41], v[64:79]
    v_exp_f32 v88, v88
    v_cvt_pk_bf16_f32 v58, v84, v85
    v_exp_f32 v89, v89
    v_cvt_pk_bf16_f32 v59, v86, v87
    v_exp_f32 v90, v90
    v_exp_f32 v91, v91
    v_mfma_f32_32x32x16_bf16 v[112:127], v[128:131], v[56:59], v[112:127]
    v_exp_f32 v92, v92
    v_cvt_pk_bf16_f32 v60, v88, v89
    v_exp_f32 v93, v93
    v_cvt_pk_bf16_f32 v61, v90, v91
    v_exp_f32 v94, v94
    v_exp_f32 v95, v95
    v_mfma_f32_32x32x16_bf16 v[96:111], v[132:135], v[52:55], v[96:111]
    ds_read_b128 v[44:47], v15 offset:3328
    ds_read_b64 v[26:27], v13 offset:4992
    v_exp_f32 v64, v64
    v_cvt_pk_bf16_f32 v62, v92, v93
    v_exp_f32 v65, v65
    v_cvt_pk_bf16_f32 v63, v94, v95
    v_exp_f32 v66, v66
    v_exp_f32 v67, v67
    v_mfma_f32_32x32x16_bf16 v[80:95], v[20:23], v[36:39], 0
    ds_read2st64_b64 v[20:23], v12 offset0:6 offset1:7
    ds_read_b128 v[128:131], v14 offset:4992
    v_exp_f32 v68, v68
    v_cvt_pk_bf16_f32 v48, v64, v65
    v_exp_f32 v69, v69
    v_cvt_pk_bf16_f32 v49, v66, v67
    v_exp_f32 v70, v70
    v_exp_f32 v71, v71
    v_mfma_f32_32x32x8bf16_1k v[80:95], v[24:25], v[42:43], v[80:95]
    v_exp_f32 v72, v72
    v_cvt_pk_bf16_f32 v50, v68, v69
    v_exp_f32 v73, v73
    v_cvt_pk_bf16_f32 v51, v70, v71
    v_exp_f32 v74, v74
    v_exp_f32 v75, v75
    v_mfma_f32_32x32x16_bf16 v[96:111], v[28:31], v[48:51], v[96:111]
    v_exp_f32 v76, v76
    v_cvt_pk_bf16_f32 v52, v72, v73
    v_exp_f32 v77, v77
    v_cvt_pk_bf16_f32 v53, v74, v75
    v_exp_f32 v78, v78
    v_exp_f32 v79, v79
    v_mfma_f32_32x32x16_bf16 v[112:127], v[132:135], v[60:63], v[112:127]
    v_exp_f32 v80, v80
    v_cvt_pk_bf16_f32 v54, v76, v77
    v_exp_f32 v81, v81
    v_cvt_pk_bf16_f32 v55, v78, v79
    v_exp_f32 v82, v82
    s_waitcnt lgkmcnt(0)
    v_exp_f32 v83, v83
    v_mfma_f32_32x32x16_bf16 v[64:79], v[20:23], v[32:35], 0
    v_exp_f32 v84, v84
    v_cvt_pk_bf16_f32 v56, v80, v81
    v_exp_f32 v85, v85
    v_cvt_pk_bf16_f32 v57, v82, v83
    v_exp_f32 v86, v86
    v_exp_f32 v87, v87
    v_mfma_f32_32x32x8bf16_1k v[64:79], v[26:27], v[40:41], v[64:79]
    v_exp_f32 v88, v88
    v_cvt_pk_bf16_f32 v58, v84, v85
    v_exp_f32 v89, v89
    v_cvt_pk_bf16_f32 v59, v86, v87
    v_exp_f32 v90, v90
    v_exp_f32 v91, v91
    v_mfma_f32_32x32x16_bf16 v[112:127], v[28:31], v[56:59], v[112:127]
    v_exp_f32 v92, v92
    v_cvt_pk_bf16_f32 v60, v88, v89
    v_exp_f32 v93, v93
    v_cvt_pk_bf16_f32 v61, v90, v91
    v_exp_f32 v94, v94
    v_exp_f32 v95, v95
    v_mfma_f32_32x32x16_bf16 v[96:111], v[44:47], v[52:55], v[96:111]
    ds_read_b128 v[132:135], v15 offset:4992
    ds_read_b64 v[24:25], v13 offset:6656
    v_exp_f32 v64, v64
    v_cvt_pk_bf16_f32 v62, v92, v93
    v_exp_f32 v65, v65
    v_cvt_pk_bf16_f32 v63, v94, v95
    v_exp_f32 v66, v66
    v_exp_f32 v67, v67
    v_mfma_f32_32x32x16_bf16 v[80:95], v[20:23], v[36:39], 0
    ds_read2st64_b64 v[20:23], v12 offset0:8 offset1:9
    ds_read_b128 v[28:31], v14 offset:6656
    v_exp_f32 v68, v68
    v_cvt_pk_bf16_f32 v48, v64, v65
    v_exp_f32 v69, v69
    v_cvt_pk_bf16_f32 v49, v66, v67
    v_exp_f32 v70, v70
    v_exp_f32 v71, v71
    v_mfma_f32_32x32x8bf16_1k v[80:95], v[26:27], v[42:43], v[80:95]
    v_exp_f32 v72, v72
    v_cvt_pk_bf16_f32 v50, v68, v69
    v_exp_f32 v73, v73
    v_cvt_pk_bf16_f32 v51, v70, v71
    v_exp_f32 v74, v74
    v_exp_f32 v75, v75
    v_mfma_f32_32x32x16_bf16 v[96:111], v[128:131], v[48:51], v[96:111]
    v_exp_f32 v76, v76
    v_cvt_pk_bf16_f32 v52, v72, v73
    v_exp_f32 v77, v77
    v_cvt_pk_bf16_f32 v53, v74, v75
    v_exp_f32 v78, v78
    v_exp_f32 v79, v79
    v_mfma_f32_32x32x16_bf16 v[112:127], v[44:47], v[60:63], v[112:127]
    v_exp_f32 v80, v80
    v_cvt_pk_bf16_f32 v54, v76, v77
    v_exp_f32 v81, v81
    v_cvt_pk_bf16_f32 v55, v78, v79
    v_exp_f32 v82, v82
    s_waitcnt lgkmcnt(0)
    v_exp_f32 v83, v83
    v_mfma_f32_32x32x16_bf16 v[64:79], v[20:23], v[32:35], 0
    v_exp_f32 v84, v84
    v_cvt_pk_bf16_f32 v56, v80, v81
    v_exp_f32 v85, v85
    v_cvt_pk_bf16_f32 v57, v82, v83
    v_exp_f32 v86, v86
    v_exp_f32 v87, v87
    v_mfma_f32_32x32x8bf16_1k v[64:79], v[24:25], v[40:41], v[64:79]
    v_exp_f32 v88, v88
    v_cvt_pk_bf16_f32 v58, v84, v85
    v_exp_f32 v89, v89
    v_cvt_pk_bf16_f32 v59, v86, v87
    v_exp_f32 v90, v90
    v_exp_f32 v91, v91
    v_mfma_f32_32x32x16_bf16 v[112:127], v[128:131], v[56:59], v[112:127]
    v_exp_f32 v92, v92
    v_cvt_pk_bf16_f32 v60, v88, v89
    v_exp_f32 v93, v93
    v_cvt_pk_bf16_f32 v61, v90, v91
    v_exp_f32 v94, v94
    v_exp_f32 v95, v95
    s_or_b32 s47, s40, s39
    s_cbranch_scc1 K2_NOMID
    s_waitcnt vmcnt(0)
    s_barrier
K2_NOMID:
    v_mfma_f32_32x32x16_bf16 v[96:111], v[132:135], v[52:55], v[96:111]
    ds_read_b128 v[44:47], v15 offset:6656
    ds_read_b64 v[26:27], v13 offset:8320
    v_exp_f32 v64, v64
    v_cvt_pk_bf16_f32 v62, v92, v93
    v_exp_f32 v65, v65
    v_cvt_pk_bf16_f32 v63, v94, v95
    v_exp_f32 v66, v66
    v_exp_f32 v67, v67
    v_mfma_f32_32x32x16_bf16 v[80:95], v[20:23], v[36:39], 0
    ds_read2st64_b64 v[20:23], v12 offset0:10 offset1:11
    ds_read_b128 v[128:131], v14 offset:8320
    v_exp_f32 v68, v68
    v_cvt_pk_bf16_f32 v48, v64, v65
    v_exp_f32 v69, v69
    v_cvt_pk_bf16_f32 v49, v66, v67
    v_exp_f32 v70, v70
    v_exp_f32 v71, v71
    v_mfma_f32_32x32x8bf16_1k v[80:95], v[24:25], v[42:43], v[80:95]
    v_exp_f32 v72, v72
    v_cvt_pk_bf16_f32 v50, v68, v69
    v_exp_f32 v73, v73
    v_cvt_pk_bf16_f32 v51, v70, v71
    v_exp_f32 v74, v74
    v_exp_f32 v75, v75
    v_mfma_f32_32x32x16_bf16 v[96:111], v[28:31], v[48:51], v[96:111]
    v_exp_f32 v76, v76
    v_cvt_pk_bf16_f32 v52, v72, v73
    v_exp_f32 v77, v77
    v_cvt_pk_bf16_f32 v53, v74, v75
    v_exp_f32 v78, v78
    v_exp_f32 v79, v79
    v_mfma_f32_32x32x16_bf16 v[112:127], v[132:135], v[60:63], v[112:127]
    v_exp_f32 v80, v80
    v_cvt_pk_bf16_f32 v54, v76, v77
    v_exp_f32 v81, v81
    v_cvt_pk_bf16_f32 v55, v78, v79
    v_exp_f32 v82, v82
    s_waitcnt lgkmcnt(0)
    v_exp_f32 v83, v83
    v_mfma_f32_32x32x16_bf16 v[64:79], v[20:23], v[32:35], 0
    v_exp_f32 v84, v84
    v_cvt_pk_bf16_f32 v56, v80, v81
    v_exp_f32 v85, v85
    v_cvt_pk_bf16_f32 v57, v82, v83
    v_exp_f32 v86, v86
    v_exp_f32 v87, v87
    v_mfma_f32_32x32x8bf16_1k v[64:79], v[26:27], v[40:41], v[64:79]
    v_exp_f32 v88, v88
    v_cvt_pk_bf16_f32 v58, v84, v85
    v_exp_f32 v89, v89
    v_cvt_pk_bf16_f32 v59, v86, v87
    v_exp_f32 v90, v90
    v_exp_f32 v91, v91
    v_mfma_f32_32x32x16_bf16 v[112:127], v[28:31], v[56:59], v[112:127]
    v_exp_f32 v92, v92
    v_cvt_pk_bf16_f32 v60, v88, v89
    v_exp_f32 v93, v93
    v_cvt_pk_bf16_f32 v61, v90, v91
    v_exp_f32 v94, v94
    v_exp_f32 v95, v95
    v_mfma_f32_32x32x16_bf16 v[96:111], v[44:47], v[52:55], v[96:111]
    ds_read_b128 v[132:135], v15 offset:8320
    ds_read_b64 v[24:25], v13 offset:9984
    v_exp_f32 v64, v64
    v_cvt_pk_bf16_f32 v62, v92, v93
    v_exp_f32 v65, v65
    v_cvt_pk_bf16_f32 v63, v94, v95
    v_exp_f32 v66, v66
    v_exp_f32 v67, v67
    v_mfma_f32_32x32x16_bf16 v[80:95], v[20:23], v[36:39], 0
    ds_read2st64_b64 v[20:23], v12 offset0:12 offset1:13
    ds_read_b128 v[28:31], v14 offset:9984
    v_exp_f32 v68, v68
    v_cvt_pk_bf16_f32 v48, v64, v65
    v_exp_f32 v69, v69
    v_cvt_pk_bf16_f32 v49, v66, v67
    v_exp_f32 v70, v70
    v_exp_f32 v71, v71
    v_mfma_f32_32x32x8bf16_1k v[80:95], v[26:27], v[42:43], v[80:95]
    v_exp_f32 v72, v72
    v_cvt_pk_bf16_f32 v50, v68, v69
    v_exp_f32 v73, v73
    v_cvt_pk_bf16_f32 v51, v70, v71
    v_exp_f32 v74, v74
    v_exp_f32 v75, v75
    v_mfma_f32_32x32x16_bf16 v[96:111], v[128:131], v[48:51], v[96:111]
    v_exp_f32 v76, v76
    v_cvt_pk_bf16_f32 v52, v72, v73
    v_exp_f32 v77, v77
    v_cvt_pk_bf16_f32 v53, v74, v75
    v_exp_f32 v78, v78
    v_exp_f32 v79, v79
    v_mfma_f32_32x32x16_bf16 v[112:127], v[44:47], v[60:63], v[112:127]
    v_exp_f32 v80, v80
    v_cvt_pk_bf16_f32 v54, v76, v77
    v_exp_f32 v81, v81
    v_cvt_pk_bf16_f32 v55, v78, v79
    v_exp_f32 v82, v82
    s_waitcnt lgkmcnt(0)
    v_exp_f32 v83, v83
    v_mfma_f32_32x32x16_bf16 v[64:79], v[20:23], v[32:35], 0
    v_exp_f32 v84, v84
    v_cvt_pk_bf16_f32 v56, v80, v81
    v_exp_f32 v85, v85
    v_cvt_pk_bf16_f32 v57, v82, v83
    v_exp_f32 v86, v86
    v_exp_f32 v87, v87
    v_mfma_f32_32x32x8bf16_1k v[64:79], v[24:25], v[40:41], v[64:79]
    v_exp_f32 v88, v88
    v_cvt_pk_bf16_f32 v58, v84, v85
    v_exp_f32 v89, v89
    v_cvt_pk_bf16_f32 v59, v86, v87
    v_exp_f32 v90, v90
    v_exp_f32 v91, v91
    v_mfma_f32_32x32x16_bf16 v[112:127], v[128:131], v[56:59], v[112:127]
    v_exp_f32 v92, v92
    v_cvt_pk_bf16_f32 v60, v88, v89
    v_exp_f32 v93, v93
    v_cvt_pk_bf16_f32 v61, v90, v91
    v_exp_f32 v94, v94
    v_exp_f32 v95, v95
    v_mfma_f32_32x32x16_bf16 v[96:111], v[132:135], v[52:55], v[96:111]
    ds_read_b128 v[44:47], v15 offset:9984
    ds_read_b64 v[26:27], v13 offset:11648
    v_exp_f32 v64, v64
    v_cvt_pk_bf16_f32 v62, v92, v93
    v_exp_f32 v65, v65
    v_cvt_pk_bf16_f32 v63, v94, v95
    v_exp_f32 v66, v66
    v_exp_f32 v67, v67
    v_mfma_f32_32x32x16_bf16 v[80:95], v[20:23], v[36:39], 0
    ds_read2st64_b64 v[20:23], v12 offset0:14 offset1:15
    ds_read_b128 v[128:131], v14 offset:11648
    v_exp_f32 v68, v68
    v_cvt_pk_bf16_f32 v48, v64, v65
    v_exp_f32 v69, v69
    v_cvt_pk_bf16_f32 v49, v66, v67
    v_exp_f32 v70, v70
    v_exp_f32 v71, v71
    v_mfma_f32_32x32x8bf16_1k v[80:95], v[24:25], v[42:43], v[80:95]
    v_exp_f32 v72, v72
    v_cvt_pk_bf16_f32 v50, v68, v69
    v_exp_f32 v73, v73
    v_cvt_pk_bf16_f32 v51, v70, v71
    v_exp_f32 v74, v74
    v_add_u32 v13, s41, v13
    v_exp_f32 v75, v75
    v_mfma_f32_32x32x16_bf16 v[96:111], v[28:31], v[48:51], v[96:111]
    v_exp_f32 v76, v76
    v_cvt_pk_bf16_f32 v52, v72, v73
    v_exp_f32 v77, v77
    v_cvt_pk_bf16_f32 v53, v74, v75
    v_exp_f32 v78, v78
    v_add_u32 v12, s41, v12
    v_exp_f32 v79, v79
    v_mfma_f32_32x32x16_bf16 v[112:127], v[132:135], v[60:63], v[112:127]
    v_exp_f32 v80, v80
    v_cvt_pk_bf16_f32 v54, v76, v77
    v_exp_f32 v81, v81
    v_cvt_pk_bf16_f32 v55, v78, v79
    v_exp_f32 v82, v82
    s_waitcnt lgkmcnt(0)
    v_exp_f32 v83, v83
    v_mfma_f32_32x32x16_bf16 v[64:79], v[20:23], v[32:35], 0
    v_exp_f32 v84, v84
    v_cvt_pk_bf16_f32 v56, v80, v81
    v_exp_f32 v85, v85
    v_cvt_pk_bf16_f32 v57, v82, v83
    v_exp_f32 v86, v86
    v_exp_f32 v87, v87
    v_mfma_f32_32x32x8bf16_1k v[64:79], v[26:27], v[40:41], v[64:79]
    v_exp_f32 v88, v88
    v_cvt_pk_bf16_f32 v58, v84, v85
    v_exp_f32 v89, v89
    v_cvt_pk_bf16_f32 v59, v86, v87
    v_exp_f32 v90, v90
    v_add_u32 v14, s41, v14
    v_exp_f32 v91, v91
    v_mfma_f32_32x32x16_bf16 v[112:127], v[28:31], v[56:59], v[112:127]
    v_exp_f32 v92, v92
    v_cvt_pk_bf16_f32 v60, v88, v89
    v_exp_f32 v93, v93
    v_cvt_pk_bf16_f32 v61, v90, v91
    v_exp_f32 v94, v94
    v_exp_f32 v95, v95
    v_mfma_f32_32x32x16_bf16 v[96:111], v[44:47], v[52:55], v[96:111]
    ds_read_b128 v[132:135], v15 offset:11648
    ds_read_b64 v[24:25], v13 offset:0
    v_exp_f32 v64, v64
    v_cvt_pk_bf16_f32 v62, v92, v93
    v_exp_f32 v65, v65
    v_cvt_pk_bf16_f32 v63, v94, v95
    v_exp_f32 v66, v66
    v_exp_f32 v67, v67
    v_mfma_f32_32x32x16_bf16 v[80:95], v[20:23], v[36:39], 0
    ds_read2st64_b64 v[20:23], v12 offset0:0 offset1:1
    ds_read_b128 v[28:31], v14 offset:0
    v_exp_f32 v68, v68
    v_cvt_pk_bf16_f32 v48, v64, v65
    v_exp_f32 v69, v69
    v_cvt_pk_bf16_f32 v49, v66, v67
    v_exp_f32 v70, v70
    v_exp_f32 v71, v71
    v_mfma_f32_32x32x8bf16_1k v[80:95], v[26:27], v[42:43], v[80:95]
    v_exp_f32 v72, v72
    v_cvt_pk_bf16_f32 v50, v68, v69
    v_exp_f32 v73, v73
    v_cvt_pk_bf16_f32 v51, v70, v71
    v_exp_f32 v74, v74
    v_add_u32 v15, s41, v15
    v_exp_f32 v75, v75
    v_mfma_f32_32x32x16_bf16 v[96:111], v[128:131], v[48:51], v[96:111]
    v_exp_f32 v76, v76
    v_cvt_pk_bf16_f32 v52, v72, v73
    v_exp_f32 v77, v77
    v_cvt_pk_bf16_f32 v53, v74, v75
    v_exp_f32 v78, v78
    s_mov_b32 s47, s41
    s_mov_b32 s41, s42
    v_exp_f32 v79, v79
    v_mfma_f32_32x32x16_bf16 v[112:127], v[44:47], v[60:63], v[112:127]
    v_exp_f32 v80, v80
    v_cvt_pk_bf16_f32 v54, v76, v77
    v_exp_f32 v81, v81
    v_cvt_pk_bf16_f32 v55, v78, v79
    v_exp_f32 v82, v82
    s_waitcnt lgkmcnt(0)
    s_mov_b32 s42, s43
    s_mov_b32 s43, s47
    v_exp_f32 v83, v83
    v_mfma_f32_32x32x16_bf16 v[64:79], v[20:23], v[32:35], 0
    v_exp_f32 v84, v84
    v_cvt_pk_bf16_f32 v56, v80, v81
    v_exp_f32 v85, v85
    v_cvt_pk_bf16_f32 v57, v82, v83
    v_exp_f32 v86, v86
    v_exp_f32 v87, v87
    v_mfma_f32_32x32x8bf16_1k v[64:79], v[24:25], v[40:41], v[64:79]
    v_exp_f32 v88, v88
    v_cvt_pk_bf16_f32 v58, v84, v85
    v_exp_f32 v89, v89
    v_cvt_pk_bf16_f32 v59, v86, v87
    v_exp_f32 v90, v90
    s_add_u32 s40, s40, 1
    v_exp_f32 v91, v91
    v_mfma_f32_32x32x16_bf16 v[112:127], v[128:131], v[56:59], v[112:127]
    v_exp_f32 v92, v92
    v_cvt_pk_bf16_f32 v60, v88, v89
    v_exp_f32 v93, v93
    v_cvt_pk_bf16_f32 v61, v90, v91
    v_exp_f32 v94, v94
    v_exp_f32 v95, v95
    s_cmp_lt_u32 s40, 8
    s_cbranch_scc1 K2_STAGE
    v_mfma_f32_32x32x16_bf16 v[96:111], v[132:135], v[52:55], v[96:111]
    s_barrier
    v_cvt_pk_bf16_f32 v62, v92, v93
    v_cvt_pk_bf16_f32 v63, v94, v95
    s_nop 1
    v_mfma_f32_32x32x16_bf16 v[112:127], v[132:135], v[60:63], v[112:127]
    s_lshl_b32 s47, s37, 8
    s_lshl_b32 s48, s38, 6
    s_add_u32 s47, s47, s48
    v_add_u32 v2, s47, v17
    v_lshrrev_b32 v3, 4, v2
    v_mul_u32_u24 v3, 20480, v3
    v_and_b32 v2, 15, v2
    v_lshl_add_u32 v2, v2, 4, v3
    s_mul_i32 s48, s36, 20
    v_lshl_add_u32 v3, v18, 2, s48
    v_lshrrev_b32 v19, 3, v3
    v_lshl_add_u32 v2, v19, 8, v2
    v_and_b32 v3, 4, v3
    v_lshl_add_u32 v10, v3, 1, v2
    v_add_u32 v11, 40960, v10
    v_cmp_eq_u32 vcc, 0, v18
    s_mov_b64 s[52:53], vcc
    s_nop 4
    v_mov_b32 v2, v104
    v_mov_b32 v3, v104
    s_nop 1
    v_permlane32_swap_b32 v2, v3
    s_nop 1
    v_rcp_f32 v3, v3
    v_mul_f32 v4, 0x49800000, v104
    v_mul_f32 v4, 0, v4
    v_mul_f32 v96, v96, v3
    v_mul_f32 v97, v97, v3
    v_mul_f32 v98, v98, v3
    v_mul_f32 v99, v99, v3
    v_mul_f32 v100, v100, v3
    v_mul_f32 v101, v101, v3
    v_mul_f32 v102, v102, v3
    v_mul_f32 v103, v103, v3
    v_mul_f32 v104, v104, v3
    v_mul_f32 v105, v105, v3
    v_mul_f32 v106, v106, v3
    v_mul_f32 v107, v107, v3
    v_cvt_pk_bf16_f32 v48, v96, v97
    v_cvt_pk_bf16_f32 v49, v98, v99
    v_cvt_pk_bf16_f32 v50, v100, v101
    v_cvt_pk_bf16_f32 v51, v102, v103
    v_cvt_pk_bf16_f32 v52, v104, v105
    v_cvt_pk_bf16_f32 v53, v106, v107
    buffer_store_dwordx2 v[48:49], v10, s[20:23], 0 offen sc1
    buffer_store_dwordx2 v[50:51], v10, s[20:23], 0 offen offset:256 sc1
    s_mov_b64 exec, s[52:53]
    buffer_store_dwordx2 v[52:53], v10, s[20:23], 0 offen offset:512 sc1
    s_mov_b64 exec, -1
    v_mov_b32 v2, v120
    v_mov_b32 v3, v120
    s_nop 1
    v_permlane32_swap_b32 v2, v3
    s_nop 1
    v_rcp_f32 v3, v3
    v_mul_f32 v5, 0x49800000, v120
    v_mul_f32 v5, 0, v5
    v_mul_f32 v112, v112, v3
    v_mul_f32 v113, v113, v3
    v_mul_f32 v114, v114, v3
    v_mul_f32 v115, v115, v3
    v_mul_f32 v116, v116, v3
    v_mul_f32 v117, v117, v3
    v_mul_f32 v118, v118, v3
    v_mul_f32 v119, v119, v3
    v_mul_f32 v120, v120, v3
    v_mul_f32 v121, v121, v3
    v_mul_f32 v122, v122, v3
    v_mul_f32 v123, v123, v3
    v_cvt_pk_bf16_f32 v56, v112, v113
    v_cvt_pk_bf16_f32 v57, v114, v115
    v_cvt_pk_bf16_f32 v58, v116, v117
    v_cvt_pk_bf16_f32 v59, v118, v119
    v_cvt_pk_bf16_f32 v60, v120, v121
    v_cvt_pk_bf16_f32 v61, v122, v123
    buffer_store_dwordx2 v[56:57], v11, s[20:23], 0 offen sc1
    buffer_store_dwordx2 v[58:59], v11, s[20:23], 0 offen offset:256 sc1
    s_mov_b64 exec, s[52:53]
    buffer_store_dwordx2 v[60:61], v11, s[20:23], 0 offen offset:512 sc1
    s_mov_b64 exec, -1
    s_cmp_lg_u32 s39, 0
    s_cbranch_scc1 K2_VOTE
    v_fma_f32 v4, v96, 0, v4
    v_fma_f32 v4, v97, 0, v4
    v_fma_f32 v4, v98, 0, v4
    v_fma_f32 v4, v99, 0, v4
    v_fma_f32 v4, v100, 0, v4
    v_fma_f32 v4, v101, 0, v4
    v_fma_f32 v4, v102, 0, v4
    v_fma_f32 v4, v103, 0, v4
    v_fma_f32 v4, v104, 0, v4
    v_fma_f32 v4, v105, 0, v4
    v_fma_f32 v4, v106, 0, v4
    v_fma_f32 v4, v107, 0, v4
    v_fma_f32 v5, v112, 0, v5
    v_fma_f32 v5, v113, 0, v5
    v_fma_f32 v5, v114, 0, v5
    v_fma_f32 v5, v115, 0, v5
    v_fma_f32 v5, v116, 0, v5
    v_fma_f32 v5, v117, 0, v5
    v_fma_f32 v5, v118, 0, v5
    v_fma_f32 v5, v119, 0, v5
    v_fma_f32 v5, v120, 0, v5
    v_fma_f32 v5, v121, 0, v5
    v_fma_f32 v5, v122, 0, v5
    v_fma_f32 v5, v123, 0, v5
    v_add_f32 v4, v4, v5
    v_cmp_u_f32 vcc, v4, v4
    s_nop 4
    s_cbranch_vccz K2_VOTE
    v_mov_b32 v2, 1
    v_mov_b32 v3, 159744
    ds_write_b32 v3, v2
K2_VOTE:
    s_waitcnt lgkmcnt(0)
    s_barrier
    s_cmp_lg_u32 s39, 0
    s_cbranch_scc1 K2_GO
    v_mov_b32 v3, 159744
    ds_read_b32 v2, v3
    s_waitcnt lgkmcnt(0)
    v_readfirstlane_b32 s47, v2
    s_cmp_eq_u32 s47, 0
    s_cbranch_scc0 K2_EXACT
K2_GO:
    s_setprio 0
    s_lshr_b32 s60, s2, 6
    s_lshl_b32 s60, s60, 2
    s_bfe_u32 s61, s2, 0x20001
    s_add_u32 s60, s60, s61
    s_bfe_u32 s61, s2, 0x10005
    s_lshl_b32 s61, s61, 4
    s_add_u32 s62, s60, s61
    s_and_b32 s60, s2, 1
    s_lshl_b32 s60, s60, 2
    s_bfe_u32 s61, s2, 0x20003
    s_add_u32 s63, s60, s61
    v_lshrrev_b32 v22, 4, v1
    v_and_b32 v23, 15, v1
    s_lshl_b32 s64, s62, 2
    s_add_u32 s64, s64, s38
    s_lshl_b32 s3, s64, 6
    v_lshl_add_u32 v255, v23, 2, s3
    s_mul_i32 s64, s64, 20480
    s_mul_i32 s3, s63, 160
    s_add_u32 s3, s3, s64
    v_mul_u32_u24 v2, 1280, v23
    v_add_u32 v2, s3, v2
    v_lshl_add_u32 v253, v22, 3, v2
    v_and_b32 v3, 1, v22
    v_lshl_add_u32 v2, v3, 5, v2
    v_lshrrev_b32 v3, 1, v22
    v_lshl_add_u32 v252, v3, 4, v2
    s_mov_b32 s3, 44032
    v_lshlrev_b32 v2, 3, v22
    v_lshrrev_b32 v3, 2, v23
    v_add_u32 v2, v2, v3
    v_mul_u32_u24 v2, 160, v2
    v_and_b32 v3, 3, v23
    v_lshlrev_b32 v3, 3, v3
    v_add3_u32 v2, v2, v3, s3
    v_and_b32 v3, 1, v22
    v_mul_u32_u24 v3, 640, v3
    v_add_u32 v245, v2, v3
    v_sub_u32 v2, v2, v3
    v_add_u32 v246, 640, v2
    v_add_u32 v247, 61440, v245
    v_add_u32 v248, 61440, v246
    s_mul_i32 s3, s38, 2560
    s_add_u32 s3, s3, 146432
    v_lshl_add_u32 v249, v1, 3, s3
    s_mul_i32 s3, s38, 10240
    s_add_u32 s3, s3, 5120
    s_branch PADX_8
PAD_8:
    s_branch PAD_12
PADX_8:
    v_lshl_add_u32 v254, v1, 4, s3
    s_load_dwordx2 s[4:5], s[0:1], 56
    s_add_u32 s32, s8, 25165824
    s_addc_u32 s33, s9, 0
    s_and_b32 s33, s33, 0xffff
    s_mov_b32 s34, 8192
    s_mov_b32 s35, 0x00020000
    buffer_load_dword v18, v255, s[32:35], 0 offen sc1
    s_add_u32 s24, s8, 41943040
    s_addc_u32 s25, s9, 0
    s_and_b32 s25, s25, 0xffff
    s_mov_b32 s26, 65536
    s_mov_b32 s27, 0x00020000
    s_lshr_b32 s60, s2, 6
    s_lshl_b32 s60, s60, 2
    s_bfe_u32 s61, s2, 0x20001
    s_add_u32 s60, s60, s61
    s_bfe_u32 s61, s2, 0x10005
    s_lshl_b32 s61, s61, 4
    s_add_u32 s62, s60, s61
    s_and_b32 s60, s2, 1
    s_lshl_b32 s60, s60, 2
    s_bfe_u32 s61, s2, 0x20003
    s_add_u32 s63, s60, s61
    s_lshl_b32 s66, s62, 2
    s_add_u32 s66, s66, s38
    s_mul_i32 s66, s66, 20480
    s_lshl_b32 s67, s62, 3
    s_add_u32 s67, s67, s63
    s_lshl_b32 s67, s67, 8
    s_waitcnt lgkmcnt(0)
    s_mov_b32 s16, s4
    s_and_b32 s17, s5, 0xffff
    s_mov_b32 s18, 2621440
    s_mov_b32 s19, 0x00020000
    v_mov_b32 v4, 159744
    v_mov_b32 v20, 0
    s_lshl_b32 s3, s37, 2
    s_add_u32 s3, s3, s38
    s_lshl_b32 s3, s3, 11
    v_lshl_add_u32 v21, v1, 8, s3
    s_lshl_b32 s3, 1, s36
    v_mov_b32 v5, s3
    ds_read_b64_tr_b16 v[84:85], v245 offset:20480
    ds_read_b64_tr_b16 v[86:87], v246 offset:20480
    ds_read_b64_tr_b16 v[88:89], v245 offset:20512
    ds_read_b64_tr_b16 v[90:91], v246 offset:20512
    ds_read_b64_tr_b16 v[92:93], v245 offset:20544
    ds_read_b64_tr_b16 v[94:95], v246 offset:20544
    ds_read_b64_tr_b16 v[96:97], v245 offset:20576
    ds_read_b64_tr_b16 v[98:99], v246 offset:20576
    ds_read_b64_tr_b16 v[100:101], v245 offset:20608
    ds_read_b64_tr_b16 v[102:103], v246 offset:20608
    s_waitcnt vmcnt(1)
    s_mov_b64 exec, 0xff
    buffer_atomic_or v5, v21, s[24:27], 0 offen
    s_mov_b64 exec, -1
    s_barrier
    ds_read_b64_tr_b16 v[104:105], v245 offset:25600
    ds_read_b64_tr_b16 v[106:107], v246 offset:25600
    ds_read_b64_tr_b16 v[108:109], v245 offset:25632
    ds_read_b64_tr_b16 v[110:111], v246 offset:25632
    ds_read_b64_tr_b16 v[112:113], v245 offset:25664
    ds_read_b64_tr_b16 v[114:115], v246 offset:25664
    ds_read_b64_tr_b16 v[116:117], v245 offset:25696
    ds_read_b64_tr_b16 v[118:119], v246 offset:25696
    ds_read_b64_tr_b16 v[120:121], v245 offset:25728
    ds_read_b64_tr_b16 v[122:123], v246 offset:25728
    ds_read_b64_tr_b16 v[124:125], v245 offset:40960
    ds_read_b64_tr_b16 v[126:127], v246 offset:40960
    ds_read_b64_tr_b16 v[128:129], v245 offset:40992
    ds_read_b64_tr_b16 v[130:131], v246 offset:40992
    ds_read_b64_tr_b16 v[132:133], v245 offset:41024
    ds_read_b64_tr_b16 v[134:135], v246 offset:41024
    ds_read_b64_tr_b16 v[136:137], v245 offset:41056
    ds_read_b64_tr_b16 v[138:139], v246 offset:41056
    ds_read_b64_tr_b16 v[140:141], v245 offset:41088
    ds_read_b64_tr_b16 v[142:143], v246 offset:41088
    ds_read_b64_tr_b16 v[144:145], v245 offset:46080
    ds_read_b64_tr_b16 v[146:147], v246 offset:46080
    ds_read_b64_tr_b16 v[148:149], v245 offset:46112
    ds_read_b64_tr_b16 v[150:151], v246 offset:46112
    ds_read_b64_tr_b16 v[152:153], v245 offset:46144
    ds_read_b64_tr_b16 v[154:155], v246 offset:46144
    ds_read_b64_tr_b16 v[156:157], v245 offset:46176
    ds_read_b64_tr_b16 v[158:159], v246 offset:46176
    ds_read_b64_tr_b16 v[160:161], v245 offset:46208
    ds_read_b64_tr_b16 v[162:163], v246 offset:46208
    ds_read_b64_tr_b16 v[164:165], v247 offset:0
    ds_read_b64_tr_b16 v[166:167], v248 offset:0
    ds_read_b64_tr_b16 v[168:169], v247 offset:32
    ds_read_b64_tr_b16 v[170:171], v248 offset:32
    ds_read_b64_tr_b16 v[172:173], v247 offset:64
    ds_read_b64_tr_b16 v[174:175], v248 offset:64
    ds_read_b64_tr_b16 v[176:177], v247 offset:96
    ds_read_b64_tr_b16 v[178:179], v248 offset:96
    ds_read_b64_tr_b16 v[180:181], v247 offset:128
    ds_read_b64_tr_b16 v[182:183], v248 offset:128
    ds_read_b64_tr_b16 v[184:185], v247 offset:5120
    ds_read_b64_tr_b16 v[186:187], v248 offset:5120
    ds_read_b64_tr_b16 v[188:189], v247 offset:5152
    ds_read_b64_tr_b16 v[190:191], v248 offset:5152
    ds_read_b64_tr_b16 v[192:193], v247 offset:5184
    ds_read_b64_tr_b16 v[194:195], v248 offset:5184
    ds_read_b64_tr_b16 v[196:197], v247 offset:5216
    ds_read_b64_tr_b16 v[198:199], v248 offset:5216
    ds_read_b64_tr_b16 v[200:201], v247 offset:5248
    ds_read_b64_tr_b16 v[202:203], v248 offset:5248
    ds_read_b64_tr_b16 v[204:205], v247 offset:20480
    ds_read_b64_tr_b16 v[206:207], v248 offset:20480
    ds_read_b64_tr_b16 v[208:209], v247 offset:20512
    ds_read_b64_tr_b16 v[210:211], v248 offset:20512
    ds_read_b64_tr_b16 v[212:213], v247 offset:20544
    ds_read_b64_tr_b16 v[214:215], v248 offset:20544
    ds_read_b64_tr_b16 v[216:217], v247 offset:20576
    ds_read_b64_tr_b16 v[218:219], v248 offset:20576
    ds_read_b64_tr_b16 v[220:221], v247 offset:20608
    ds_read_b64_tr_b16 v[222:223], v248 offset:20608
    ds_read_b64_tr_b16 v[224:225], v247 offset:25600
    ds_read_b64_tr_b16 v[226:227], v248 offset:25600
    ds_read_b64_tr_b16 v[228:229], v247 offset:25632
    ds_read_b64_tr_b16 v[230:231], v248 offset:25632
    ds_read_b64_tr_b16 v[232:233], v247 offset:25664
    ds_read_b64_tr_b16 v[234:235], v248 offset:25664
    ds_read_b64_tr_b16 v[236:237], v247 offset:25696
    ds_read_b64_tr_b16 v[238:239], v248 offset:25696
    ds_read_b64_tr_b16 v[240:241], v247 offset:25728
    ds_read_b64_tr_b16 v[242:243], v248 offset:25728
K2_TAIL:
    s_add_u32 s75, s66, 0
    s_add_u32 s76, s66, 4096
    s_add_u32 s77, s66, 8192
    s_add_u32 s78, s66, 12288
    s_add_u32 s79, s66, 16384
    s_cmp_lg_u32 s38, 0
    s_cbranch_scc1 T_GO
    s_mov_b32 s69, 0
    s_mov_b64 exec, 1
T_L:
    buffer_atomic_or v20, off, s[24:27], s67 sc0
    s_sleep 1
    s_waitcnt vmcnt(8)
    v_readfirstlane_b32 s3, v20
    s_add_u32 s69, s69, 1
    s_cmp_gt_u32 s69, 0x40000
    s_cselect_b32 s3, -1, s3
    s_cmp_lg_u32 s3, -1
    s_cbranch_scc1 T_L
    s_mov_b64 exec, -1
T_GO:
    s_barrier
    buffer_load_dwordx4 v[24:27], v16, s[20:23], s75 offen offset:0 sc1
    buffer_load_dwordx4 v[28:31], v16, s[20:23], s75 offen offset:1024 sc1
    buffer_load_dwordx4 v[32:35], v16, s[20:23], s76 offen offset:0 sc1
    buffer_load_dwordx4 v[36:39], v16, s[20:23], s76 offen offset:1024 sc1
    buffer_load_dwordx4 v[40:43], v16, s[20:23], s77 offen offset:0 sc1
    s_waitcnt vmcnt(4) lgkmcnt(0)
    v_mfma_f32_16x16x32_bf16 v[64:67], v[84:87], v[24:27], 0
    buffer_load_dwordx4 v[44:47], v16, s[20:23], s77 offen offset:1024 sc1
    v_mfma_f32_16x16x32_bf16 v[68:71], v[88:91], v[24:27], 0
    v_mfma_f32_16x16x32_bf16 v[72:75], v[92:95], v[24:27], 0
    v_mfma_f32_16x16x32_bf16 v[76:79], v[96:99], v[24:27], 0
    v_mfma_f32_16x16x32_bf16 v[80:83], v[100:103], v[24:27], 0
    ds_read_b64_tr_b16 v[84:85], v245 offset:0
    ds_read_b64_tr_b16 v[86:87], v246 offset:0
    ds_read_b64_tr_b16 v[88:89], v245 offset:32
    ds_read_b64_tr_b16 v[90:91], v246 offset:32
    ds_read_b64_tr_b16 v[92:93], v245 offset:64
    ds_read_b64_tr_b16 v[94:95], v246 offset:64
    ds_read_b64_tr_b16 v[96:97], v245 offset:96
    ds_read_b64_tr_b16 v[98:99], v246 offset:96
    ds_read_b64_tr_b16 v[100:101], v245 offset:128
    ds_read_b64_tr_b16 v[102:103], v246 offset:128
    s_waitcnt vmcnt(4)
    v_mfma_f32_16x16x32_bf16 v[64:67], v[104:107], v[28:31], v[64:67]
    buffer_load_dwordx4 v[48:51], v16, s[20:23], s78 offen offset:0 sc1
    v_mfma_f32_16x16x32_bf16 v[68:71], v[108:111], v[28:31], v[68:71]
    v_mfma_f32_16x16x32_bf16 v[72:75], v[112:115], v[28:31], v[72:75]
    v_mfma_f32_16x16x32_bf16 v[76:79], v[116:119], v[28:31], v[76:79]
    v_mfma_f32_16x16x32_bf16 v[80:83], v[120:123], v[28:31], v[80:83]
    ds_read_b64_tr_b16 v[104:105], v245 offset:5120
    ds_read_b64_tr_b16 v[106:107], v246 offset:5120
    ds_read_b64_tr_b16 v[108:109], v245 offset:5152
    ds_read_b64_tr_b16 v[110:111], v246 offset:5152
    ds_read_b64_tr_b16 v[112:113], v245 offset:5184
    ds_read_b64_tr_b16 v[114:115], v246 offset:5184
    ds_read_b64_tr_b16 v[116:117], v245 offset:5216
    ds_read_b64_tr_b16 v[118:119], v246 offset:5216
    ds_read_b64_tr_b16 v[120:121], v245 offset:5248
    ds_read_b64_tr_b16 v[122:123], v246 offset:5248
    s_waitcnt vmcnt(4)
    v_mfma_f32_16x16x32_bf16 v[64:67], v[124:127], v[32:35], v[64:67]
    buffer_load_dwordx4 v[52:55], v16, s[20:23], s78 offen offset:1024 sc1
    v_mfma_f32_16x16x32_bf16 v[68:71], v[128:131], v[32:35], v[68:71]
    v_mfma_f32_16x16x32_bf16 v[72:75], v[132:135], v[32:35], v[72:75]
    v_mfma_f32_16x16x32_bf16 v[76:79], v[136:139], v[32:35], v[76:79]
    v_mfma_f32_16x16x32_bf16 v[80:83], v[140:143], v[32:35], v[80:83]
    s_waitcnt vmcnt(4)
    v_mfma_f32_16x16x32_bf16 v[64:67], v[144:147], v[36:39], v[64:67]
    buffer_load_dwordx4 v[56:59], v16, s[20:23], s79 offen offset:0 sc1
    v_mfma_f32_16x16x32_bf16 v[68:71], v[148:151], v[36:39], v[68:71]
    v_mfma_f32_16x16x32_bf16 v[72:75], v[152:155], v[36:39], v[72:75]
    v_mfma_f32_16x16x32_bf16 v[76:79], v[156:159], v[36:39], v[76:79]
    v_mfma_f32_16x16x32_bf16 v[80:83], v[160:163], v[36:39], v[80:83]
    s_waitcnt vmcnt(4)
    v_mfma_f32_16x16x32_bf16 v[64:67], v[164:167], v[40:43], v[64:67]
    buffer_load_dwordx4 v[60:63], v16, s[20:23], s79 offen offset:1024 sc1
    v_mfma_f32_16x16x32_bf16 v[68:71], v[168:171], v[40:43], v[68:71]
    v_mfma_f32_16x16x32_bf16 v[72:75], v[172:175], v[40:43], v[72:75]
    v_mfma_f32_16x16x32_bf16 v[76:79], v[176:179], v[40:43], v[76:79]
    v_mfma_f32_16x16x32_bf16 v[80:83], v[180:183], v[40:43], v[80:83]
    s_waitcnt vmcnt(4)
    v_mfma_f32_16x16x32_bf16 v[64:67], v[184:187], v[44:47], v[64:67]
    v_mfma_f32_16x16x32_bf16 v[68:71], v[188:191], v[44:47], v[68:71]
    v_mfma_f32_16x16x32_bf16 v[72:75], v[192:195], v[44:47], v[72:75]
    v_mfma_f32_16x16x32_bf16 v[76:79], v[196:199], v[44:47], v[76:79]
    v_mfma_f32_16x16x32_bf16 v[80:83], v[200:203], v[44:47], v[80:83]
    s_waitcnt vmcnt(3)
    v_mfma_f32_16x16x32_bf16 v[64:67], v[204:207], v[48:51], v[64:67]
    v_mfma_f32_16x16x32_bf16 v[68:71], v[208:211], v[48:51], v[68:71]
    v_mfma_f32_16x16x32_bf16 v[72:75], v[212:215], v[48:51], v[72:75]
    v_mfma_f32_16x16x32_bf16 v[76:79], v[216:219], v[48:51], v[76:79]
    v_mfma_f32_16x16x32_bf16 v[80:83], v[220:223], v[48:51], v[80:83]
    s_waitcnt vmcnt(2)
    v_mfma_f32_16x16x32_bf16 v[64:67], v[224:227], v[52:55], v[64:67]
    v_mfma_f32_16x16x32_bf16 v[68:71], v[228:231], v[52:55], v[68:71]
    v_mfma_f32_16x16x32_bf16 v[72:75], v[232:235], v[52:55], v[72:75]
    v_mfma_f32_16x16x32_bf16 v[76:79], v[236:239], v[52:55], v[76:79]
    v_mfma_f32_16x16x32_bf16 v[80:83], v[240:243], v[52:55], v[80:83]
    s_waitcnt vmcnt(1) lgkmcnt(0)
    v_mfma_f32_16x16x32_bf16 v[64:67], v[84:87], v[56:59], v[64:67]
    v_mfma_f32_16x16x32_bf16 v[68:71], v[88:91], v[56:59], v[68:71]
    v_mfma_f32_16x16x32_bf16 v[72:75], v[92:95], v[56:59], v[72:75]
    v_mfma_f32_16x16x32_bf16 v[76:79], v[96:99], v[56:59], v[76:79]
    v_mfma_f32_16x16x32_bf16 v[80:83], v[100:103], v[56:59], v[80:83]
    s_waitcnt vmcnt(0)
    v_mfma_f32_16x16x32_bf16 v[64:67], v[104:107], v[60:63], v[64:67]
    v_mfma_f32_16x16x32_bf16 v[68:71], v[108:111], v[60:63], v[68:71]
    v_mfma_f32_16x16x32_bf16 v[72:75], v[112:115], v[60:63], v[72:75]
    v_mfma_f32_16x16x32_bf16 v[76:79], v[116:119], v[60:63], v[76:79]
    v_mfma_f32_16x16x32_bf16 v[80:83], v[120:123], v[60:63], v[80:83]
    s_nop 9
    ds_write_b128 v254, v[64:67] offset:0
    ds_write_b128 v254, v[68:71] offset:1024
    ds_write_b128 v254, v[72:75] offset:2048
    ds_write_b128 v254, v[76:79] offset:3072
    ds_write_b128 v254, v[80:83] offset:4096
    s_waitcnt lgkmcnt(0)
    s_barrier
    s_endpgm
T_X1:
    s_add_u32 s75, s66, 0
    s_add_u32 s76, s66, 4096
    s_add_u32 s77, s66, 8192
    s_add_u32 s78, s66, 12288
    s_add_u32 s79, s66, 16384
    v_mov_b32 v19, v18
    s_barrier
    buffer_load_dwordx4 v[24:27], v16, s[20:23], s75 offen offset:0 sc1
    ds_read_b64_tr_b16 v[104:105], v245 offset:25600
    ds_read_b64_tr_b16 v[106:107], v246 offset:25600
    ds_read_b64_tr_b16 v[108:109], v245 offset:25632
    ds_read_b64_tr_b16 v[110:111], v246 offset:25632
    ds_read_b64_tr_b16 v[112:113], v245 offset:25664
    ds_read_b64_tr_b16 v[114:115], v246 offset:25664
    ds_read_b64_tr_b16 v[116:117], v245 offset:25696
    ds_read_b64_tr_b16 v[118:119], v246 offset:25696
    ds_read_b64_tr_b16 v[120:121], v245 offset:25728
    ds_read_b64_tr_b16 v[122:123], v246 offset:25728
    ds_read_b64_tr_b16 v[124:125], v245 offset:40960
    ds_read_b64_tr_b16 v[126:127], v246 offset:40960
    ds_read_b64_tr_b16 v[128:129], v245 offset:40992
    ds_read_b64_tr_b16 v[130:131], v246 offset:40992
    buffer_load_dwordx4 v[28:31], v16, s[20:23], s75 offen offset:1024 sc1
    ds_read_b64_tr_b16 v[132:133], v245 offset:41024
    ds_read_b64_tr_b16 v[134:135], v246 offset:41024
    ds_read_b64_tr_b16 v[136:137], v245 offset:41056
    ds_read_b64_tr_b16 v[138:139], v246 offset:41056
    ds_read_b64_tr_b16 v[140:141], v245 offset:41088
    ds_read_b64_tr_b16 v[142:143], v246 offset:41088
    ds_read_b64_tr_b16 v[144:145], v245 offset:46080
    ds_read_b64_tr_b16 v[146:147], v246 offset:46080
    ds_read_b64_tr_b16 v[148:149], v245 offset:46112
    ds_read_b64_tr_b16 v[150:151], v246 offset:46112
    ds_read_b64_tr_b16 v[152:153], v245 offset:46144
    ds_read_b64_tr_b16 v[154:155], v246 offset:46144
    ds_read_b64_tr_b16 v[156:157], v245 offset:46176
    ds_read_b64_tr_b16 v[158:159], v246 offset:46176
    buffer_load_dwordx4 v[32:35], v16, s[20:23], s76 offen offset:0 sc1
    ds_read_b64_tr_b16 v[160:161], v245 offset:46208
    ds_read_b64_tr_b16 v[162:163], v246 offset:46208
    ds_read_b64_tr_b16 v[164:165], v247 offset:0
    ds_read_b64_tr_b16 v[166:167], v248 offset:0
    ds_read_b64_tr_b16 v[168:169], v247 offset:32
    ds_read_b64_tr_b16 v[170:171], v248 offset:32
    ds_read_b64_tr_b16 v[172:173], v247 offset:64
    ds_read_b64_tr_b16 v[174:175], v248 offset:64
    ds_read_b64_tr_b16 v[176:177], v247 offset:96
    ds_read_b64_tr_b16 v[178:179], v248 offset:96
    ds_read_b64_tr_b16 v[180:181], v247 offset:128
    ds_read_b64_tr_b16 v[182:183], v248 offset:128
    ds_read_b64_tr_b16 v[184:185], v247 offset:5120
    ds_read_b64_tr_b16 v[186:187], v248 offset:5120
    buffer_load_dwordx4 v[36:39], v16, s[20:23], s76 offen offset:1024 sc1
    ds_read_b64_tr_b16 v[188:189], v247 offset:5152
    ds_read_b64_tr_b16 v[190:191], v248 offset:5152
    ds_read_b64_tr_b16 v[192:193], v247 offset:5184
    ds_read_b64_tr_b16 v[194:195], v248 offset:5184
    ds_read_b64_tr_b16 v[196:197], v247 offset:5216
    ds_read_b64_tr_b16 v[198:199], v248 offset:5216
    ds_read_b64_tr_b16 v[200:201], v247 offset:5248
    ds_read_b64_tr_b16 v[202:203], v248 offset:5248
    ds_read_b64_tr_b16 v[204:205], v247 offset:20480
    ds_read_b64_tr_b16 v[206:207], v248 offset:20480
    ds_read_b64_tr_b16 v[208:209], v247 offset:20512
    ds_read_b64_tr_b16 v[210:211], v248 offset:20512
    ds_read_b64_tr_b16 v[212:213], v247 offset:20544
    ds_read_b64_tr_b16 v[214:215], v248 offset:20544
    buffer_load_dwordx4 v[40:43], v16, s[20:23], s77 offen offset:0 sc1
    ds_read_b64_tr_b16 v[216:217], v247 offset:20576
    ds_read_b64_tr_b16 v[218:219], v248 offset:20576
    ds_read_b64_tr_b16 v[220:221], v247 offset:20608
    ds_read_b64_tr_b16 v[222:223], v248 offset:20608
    ds_read_b64_tr_b16 v[224:225], v247 offset:25600
    ds_read_b64_tr_b16 v[226:227], v248 offset:25600
    ds_read_b64_tr_b16 v[228:229], v247 offset:25632
    ds_read_b64_tr_b16 v[230:231], v248 offset:25632
    ds_read_b64_tr_b16 v[232:233], v247 offset:25664
    ds_read_b64_tr_b16 v[234:235], v248 offset:25664
    ds_read_b64_tr_b16 v[236:237], v247 offset:25696
    ds_read_b64_tr_b16 v[238:239], v248 offset:25696
    ds_read_b64_tr_b16 v[240:241], v247 offset:25728
    ds_read_b64_tr_b16 v[242:243], v248 offset:25728
    s_waitcnt vmcnt(4) lgkmcnt(0)
    v_mfma_f32_16x16x32_bf16 v[64:67], v[84:87], v[24:27], 0
    buffer_load_dwordx4 v[44:47], v16, s[20:23], s77 offen offset:1024 sc1
    v_mfma_f32_16x16x32_bf16 v[68:71], v[88:91], v[24:27], 0
    v_mfma_f32_16x16x32_bf16 v[72:75], v[92:95], v[24:27], 0
    v_mfma_f32_16x16x32_bf16 v[76:79], v[96:99], v[24:27], 0
    v_mfma_f32_16x16x32_bf16 v[80:83], v[100:103], v[24:27], 0
    ds_read_b64_tr_b16 v[84:85], v245 offset:0
    ds_read_b64_tr_b16 v[86:87], v246 offset:0
    ds_read_b64_tr_b16 v[88:89], v245 offset:32
    ds_read_b64_tr_b16 v[90:91], v246 offset:32
    ds_read_b64_tr_b16 v[92:93], v245 offset:64
    ds_read_b64_tr_b16 v[94:95], v246 offset:64
    ds_read_b64_tr_b16 v[96:97], v245 offset:96
    ds_read_b64_tr_b16 v[98:99], v246 offset:96
    ds_read_b64_tr_b16 v[100:101], v245 offset:128
    ds_read_b64_tr_b16 v[102:103], v246 offset:128
    s_waitcnt vmcnt(4)
    v_mfma_f32_16x16x32_bf16 v[64:67], v[104:107], v[28:31], v[64:67]
    buffer_load_dwordx4 v[48:51], v16, s[20:23], s78 offen offset:0 sc1
    v_mfma_f32_16x16x32_bf16 v[68:71], v[108:111], v[28:31], v[68:71]
    v_mfma_f32_16x16x32_bf16 v[72:75], v[112:115], v[28:31], v[72:75]
    v_mfma_f32_16x16x32_bf16 v[76:79], v[116:119], v[28:31], v[76:79]
    v_mfma_f32_16x16x32_bf16 v[80:83], v[120:123], v[28:31], v[80:83]
    ds_read_b64_tr_b16 v[104:105], v245 offset:5120
    ds_read_b64_tr_b16 v[106:107], v246 offset:5120
    ds_read_b64_tr_b16 v[108:109], v245 offset:5152
    ds_read_b64_tr_b16 v[110:111], v246 offset:5152
    ds_read_b64_tr_b16 v[112:113], v245 offset:5184
    ds_read_b64_tr_b16 v[114:115], v246 offset:5184
    ds_read_b64_tr_b16 v[116:117], v245 offset:5216
    ds_read_b64_tr_b16 v[118:119], v246 offset:5216
    ds_read_b64_tr_b16 v[120:121], v245 offset:5248
    ds_read_b64_tr_b16 v[122:123], v246 offset:5248
    s_waitcnt vmcnt(4)
    v_mfma_f32_16x16x32_bf16 v[64:67], v[124:127], v[32:35], v[64:67]
    buffer_load_dwordx4 v[52:55], v16, s[20:23], s78 offen offset:1024 sc1
    v_mfma_f32_16x16x32_bf16 v[68:71], v[128:131], v[32:35], v[68:71]
    v_mfma_f32_16x16x32_bf16 v[72:75], v[132:135], v[32:35], v[72:75]
    v_mfma_f32_16x16x32_bf16 v[76:79], v[136:139], v[32:35], v[76:79]
    v_mfma_f32_16x16x32_bf16 v[80:83], v[140:143], v[32:35], v[80:83]
    s_waitcnt vmcnt(4)
    v_mfma_f32_16x16x32_bf16 v[64:67], v[144:147], v[36:39], v[64:67]
    buffer_load_dwordx4 v[56:59], v16, s[20:23], s79 offen offset:0 sc1
    v_mfma_f32_16x16x32_bf16 v[68:71], v[148:151], v[36:39], v[68:71]
    v_mfma_f32_16x16x32_bf16 v[72:75], v[152:155], v[36:39], v[72:75]
    v_mfma_f32_16x16x32_bf16 v[76:79], v[156:159], v[36:39], v[76:79]
    v_mfma_f32_16x16x32_bf16 v[80:83], v[160:163], v[36:39], v[80:83]
    v_lshlrev_b32 v124, 16, v6
    v_and_b32 v125, 0xffff0000, v6
    v_lshlrev_b32 v126, 16, v7
    v_and_b32 v127, 0xffff0000, v7
    v_lshlrev_b32 v128, 16, v8
    v_and_b32 v129, 0xffff0000, v8
    v_lshlrev_b32 v130, 16, v9
    v_and_b32 v131, 0xffff0000, v9
    v_lshlrev_b32 v132, 16, v10
    v_and_b32 v133, 0xffff0000, v10
    v_lshlrev_b32 v134, 16, v11
    v_and_b32 v135, 0xffff0000, v11
    v_lshlrev_b32 v136, 16, v12
    v_and_b32 v137, 0xffff0000, v12
    v_lshlrev_b32 v138, 16, v13
    v_and_b32 v139, 0xffff0000, v13
    v_lshlrev_b32 v140, 16, v14
    v_and_b32 v141, 0xffff0000, v14
    v_lshlrev_b32 v142, 16, v15
    v_and_b32 v143, 0xffff0000, v15
    s_waitcnt vmcnt(4)
    v_mfma_f32_16x16x32_bf16 v[64:67], v[164:167], v[40:43], v[64:67]
    buffer_load_dwordx4 v[60:63], v16, s[20:23], s79 offen offset:1024 sc1
    v_mfma_f32_16x16x32_bf16 v[68:71], v[168:171], v[40:43], v[68:71]
    v_mfma_f32_16x16x32_bf16 v[72:75], v[172:175], v[40:43], v[72:75]
    v_mfma_f32_16x16x32_bf16 v[76:79], v[176:179], v[40:43], v[76:79]
    v_mfma_f32_16x16x32_bf16 v[80:83], v[180:183], v[40:43], v[80:83]
    s_waitcnt vmcnt(4)
    v_mfma_f32_16x16x32_bf16 v[64:67], v[184:187], v[44:47], v[64:67]
    v_mfma_f32_16x16x32_bf16 v[68:71], v[188:191], v[44:47], v[68:71]
    v_mfma_f32_16x16x32_bf16 v[72:75], v[192:195], v[44:47], v[72:75]
    v_mfma_f32_16x16x32_bf16 v[76:79], v[196:199], v[44:47], v[76:79]
    v_mfma_f32_16x16x32_bf16 v[80:83], v[200:203], v[44:47], v[80:83]
    s_waitcnt vmcnt(3)
    v_mfma_f32_16x16x32_bf16 v[64:67], v[204:207], v[48:51], v[64:67]
    v_mfma_f32_16x16x32_bf16 v[68:71], v[208:211], v[48:51], v[68:71]
    v_mfma_f32_16x16x32_bf16 v[72:75], v[212:215], v[48:51], v[72:75]
    v_mfma_f32_16x16x32_bf16 v[76:79], v[216:219], v[48:51], v[76:79]
    v_mfma_f32_16x16x32_bf16 v[80:83], v[220:223], v[48:51], v[80:83]
    s_waitcnt vmcnt(2)
    v_mfma_f32_16x16x32_bf16 v[64:67], v[224:227], v[52:55], v[64:67]
    v_mfma_f32_16x16x32_bf16 v[68:71], v[228:231], v[52:55], v[68:71]
    v_mfma_f32_16x16x32_bf16 v[72:75], v[232:235], v[52:55], v[72:75]
    v_mfma_f32_16x16x32_bf16 v[76:79], v[236:239], v[52:55], v[76:79]
    v_mfma_f32_16x16x32_bf16 v[80:83], v[240:243], v[52:55], v[80:83]
    s_barrier
    ds_read_b128 v[144:147], v254 offset:0
    ds_read_b128 v[148:151], v254 offset:1024
    ds_read_b128 v[152:155], v254 offset:2048
    ds_read_b128 v[156:159], v254 offset:3072
    ds_read_b128 v[160:163], v254 offset:4096
    s_waitcnt vmcnt(1) lgkmcnt(0)
    v_mfma_f32_16x16x32_bf16 v[64:67], v[84:87], v[56:59], v[64:67]
    v_mfma_f32_16x16x32_bf16 v[68:71], v[88:91], v[56:59], v[68:71]
    v_mfma_f32_16x16x32_bf16 v[72:75], v[92:95], v[56:59], v[72:75]
    v_mfma_f32_16x16x32_bf16 v[76:79], v[96:99], v[56:59], v[76:79]
    v_mfma_f32_16x16x32_bf16 v[80:83], v[100:103], v[56:59], v[80:83]
    s_waitcnt vmcnt(0)
    v_mfma_f32_16x16x32_bf16 v[64:67], v[104:107], v[60:63], v[64:67]
    v_mfma_f32_16x16x32_bf16 v[68:71], v[108:111], v[60:63], v[68:71]
    v_mfma_f32_16x16x32_bf16 v[72:75], v[112:115], v[60:63], v[72:75]
    v_mfma_f32_16x16x32_bf16 v[76:79], v[116:119], v[60:63], v[76:79]
    v_mfma_f32_16x16x32_bf16 v[80:83], v[120:123], v[60:63], v[80:83]
    s_waitcnt lgkmcnt(0)
    s_nop 1
    v_pk_add_f32 v[64:65], v[64:65], v[144:145]
    v_pk_add_f32 v[66:67], v[66:67], v[146:147]
    v_pk_add_f32 v[68:69], v[68:69], v[148:149]
    v_pk_add_f32 v[70:71], v[70:71], v[150:151]
    v_cvt_pk_bf16_f32 v2, v64, v65
    v_cvt_pk_bf16_f32 v3, v66, v67
    v_cvt_pk_bf16_f32 v4, v68, v69
    v_cvt_pk_bf16_f32 v5, v70, v71
    v_lshlrev_b32 v64, 16, v2
    v_and_b32 v65, 0xffff0000, v2
    v_lshlrev_b32 v66, 16, v3
    v_and_b32 v67, 0xffff0000, v3
    v_lshlrev_b32 v68, 16, v4
    v_and_b32 v69, 0xffff0000, v4
    v_lshlrev_b32 v70, 16, v5
    v_and_b32 v71, 0xffff0000, v5
    v_pk_mul_f32 v[64:65], v[64:65], v[18:19]
    v_pk_mul_f32 v[66:67], v[66:67], v[18:19]
    v_pk_mul_f32 v[68:69], v[68:69], v[18:19]
    v_pk_mul_f32 v[70:71], v[70:71], v[18:19]
    v_cvt_pk_bf16_f32 v2, v64, v65
    v_cvt_pk_bf16_f32 v3, v66, v67
    v_cvt_pk_bf16_f32 v4, v68, v69
    v_cvt_pk_bf16_f32 v5, v70, v71
    v_lshlrev_b32 v64, 16, v2
    v_and_b32 v65, 0xffff0000, v2
    v_lshlrev_b32 v66, 16, v3
    v_and_b32 v67, 0xffff0000, v3
    v_lshlrev_b32 v68, 16, v4
    v_and_b32 v69, 0xffff0000, v4
    v_lshlrev_b32 v70, 16, v5
    v_and_b32 v71, 0xffff0000, v5
    v_pk_add_f32 v[64:65], v[64:65], v[124:125]
    v_pk_add_f32 v[66:67], v[66:67], v[126:127]
    v_pk_add_f32 v[68:69], v[68:69], v[128:129]
    v_pk_add_f32 v[70:71], v[70:71], v[130:131]
    v_cvt_pk_bf16_f32 v176, v64, v65
    v_cvt_pk_bf16_f32 v177, v66, v67
    v_cvt_pk_bf16_f32 v178, v68, v69
    v_cvt_pk_bf16_f32 v179, v70, v71
    s_nop 1
    v_permlane16_swap_b32 v176, v178
    v_permlane16_swap_b32 v177, v179
    buffer_store_dwordx4 v[176:179], v252, s[16:19], 0 offen offset:0
    v_pk_add_f32 v[72:73], v[72:73], v[152:153]
    v_pk_add_f32 v[74:75], v[74:75], v[154:155]
    v_pk_add_f32 v[76:77], v[76:77], v[156:157]
    v_pk_add_f32 v[78:79], v[78:79], v[158:159]
    v_cvt_pk_bf16_f32 v2, v72, v73
    v_cvt_pk_bf16_f32 v3, v74, v75
    v_cvt_pk_bf16_f32 v4, v76, v77
    v_cvt_pk_bf16_f32 v5, v78, v79
    v_lshlrev_b32 v72, 16, v2
    v_and_b32 v73, 0xffff0000, v2
    v_lshlrev_b32 v74, 16, v3
    v_and_b32 v75, 0xffff0000, v3
    v_lshlrev_b32 v76, 16, v4
    v_and_b32 v77, 0xffff0000, v4
    v_lshlrev_b32 v78, 16, v5
    v_and_b32 v79, 0xffff0000, v5
    v_pk_mul_f32 v[72:73], v[72:73], v[18:19]
    v_pk_mul_f32 v[74:75], v[74:75], v[18:19]
    v_pk_mul_f32 v[76:77], v[76:77], v[18:19]
    v_pk_mul_f32 v[78:79], v[78:79], v[18:19]
    v_cvt_pk_bf16_f32 v2, v72, v73
    v_cvt_pk_bf16_f32 v3, v74, v75
    v_cvt_pk_bf16_f32 v4, v76, v77
    v_cvt_pk_bf16_f32 v5, v78, v79
    v_lshlrev_b32 v72, 16, v2
    v_and_b32 v73, 0xffff0000, v2
    v_lshlrev_b32 v74, 16, v3
    v_and_b32 v75, 0xffff0000, v3
    v_lshlrev_b32 v76, 16, v4
    v_and_b32 v77, 0xffff0000, v4
    v_lshlrev_b32 v78, 16, v5
    v_and_b32 v79, 0xffff0000, v5
    v_pk_add_f32 v[72:73], v[72:73], v[132:133]
    v_pk_add_f32 v[74:75], v[74:75], v[134:135]
    v_pk_add_f32 v[76:77], v[76:77], v[136:137]
    v_pk_add_f32 v[78:79], v[78:79], v[138:139]
    v_cvt_pk_bf16_f32 v180, v72, v73
    v_cvt_pk_bf16_f32 v181, v74, v75
    v_cvt_pk_bf16_f32 v182, v76, v77
    v_cvt_pk_bf16_f32 v183, v78, v79
    s_nop 1
    v_permlane16_swap_b32 v180, v182
    v_permlane16_swap_b32 v181, v183
    buffer_store_dwordx4 v[180:183], v252, s[16:19], 0 offen offset:64
    v_pk_add_f32 v[80:81], v[80:81], v[160:161]
    v_pk_add_f32 v[82:83], v[82:83], v[162:163]
    v_cvt_pk_bf16_f32 v2, v80, v81
    v_cvt_pk_bf16_f32 v3, v82, v83
    v_lshlrev_b32 v80, 16, v2
    v_and_b32 v81, 0xffff0000, v2
    v_lshlrev_b32 v82, 16, v3
    v_and_b32 v83, 0xffff0000, v3
    v_pk_mul_f32 v[80:81], v[80:81], v[18:19]
    v_pk_mul_f32 v[82:83], v[82:83], v[18:19]
    v_cvt_pk_bf16_f32 v2, v80, v81
    v_cvt_pk_bf16_f32 v3, v82, v83
    v_lshlrev_b32 v80, 16, v2
    v_and_b32 v81, 0xffff0000, v2
    v_lshlrev_b32 v82, 16, v3
    v_and_b32 v83, 0xffff0000, v3
    v_pk_add_f32 v[80:81], v[80:81], v[140:141]
    v_pk_add_f32 v[82:83], v[82:83], v[142:143]
    v_cvt_pk_bf16_f32 v184, v80, v81
    v_cvt_pk_bf16_f32 v185, v82, v83
    buffer_store_dwordx2 v[184:185], v253, s[16:19], 0 offen offset:128
K_END:
    s_endpgm
K2_EXACT:
    s_barrier
    v_subrev_u32 v12, 43008, v12
    v_subrev_u32 v13, 43008, v13
    v_subrev_u32 v14, 43008, v14
    v_subrev_u32 v15, 43008, v15
    v_cmp_eq_u32 vcc, 0, v18
    s_nop 1
    v_cndmask_b32 v40, 0, v40, vcc
    v_cndmask_b32 v41, 0, v41, vcc
    v_cndmask_b32 v42, 0, v42, vcc
    v_cndmask_b32 v43, 0, v43, vcc
    v_mov_b32 v8, 4286578688
    v_mov_b32 v9, v8
    v_mov_b32 v4, v12
    v_mov_b32 v5, v13
    s_mov_b32 s40, 0
K2_MSTAGE:
    s_barrier
    ds_read2st64_b64 v[20:23], v4 offset0:0 offset1:1
    s_branch PADX_9
PAD_9:
    s_branch PAD_13
PADX_9:
    ds_read_b64 v[24:25], v5 offset:0
    s_waitcnt lgkmcnt(0)
    v_mfma_f32_32x32x16_bf16 v[64:79], v[20:23], v[32:35], 0
    v_mfma_f32_32x32x16_bf16 v[80:95], v[20:23], v[36:39], 0
    v_mfma_f32_32x32x8bf16_1k v[64:79], v[24:25], v[40:41], v[64:79]
    v_mfma_f32_32x32x8bf16_1k v[80:95], v[24:25], v[42:43], v[80:95]
    s_nop 15
    s_nop 3
    v_max3_f32 v8, v8, v64, v65
    v_max3_f32 v8, v8, v66, v67
    v_max3_f32 v8, v8, v68, v69
    v_max3_f32 v8, v8, v70, v71
    v_max3_f32 v8, v8, v72, v73
    v_max3_f32 v8, v8, v74, v75
    v_max3_f32 v8, v8, v76, v77
    v_max3_f32 v8, v8, v78, v79
    v_max3_f32 v9, v9, v80, v81
    v_max3_f32 v9, v9, v82, v83
    v_max3_f32 v9, v9, v84, v85
    v_max3_f32 v9, v9, v86, v87
    v_max3_f32 v9, v9, v88, v89
    v_max3_f32 v9, v9, v90, v91
    v_max3_f32 v9, v9, v92, v93
    v_max3_f32 v9, v9, v94, v95
    ds_read2st64_b64 v[20:23], v4 offset0:2 offset1:3
    ds_read_b64 v[26:27], v5 offset:1664
    s_waitcnt lgkmcnt(0)
    v_mfma_f32_32x32x16_bf16 v[64:79], v[20:23], v[32:35], 0
    v_mfma_f32_32x32x16_bf16 v[80:95], v[20:23], v[36:39], 0
    v_mfma_f32_32x32x8bf16_1k v[64:79], v[26:27], v[40:41], v[64:79]
    v_mfma_f32_32x32x8bf16_1k v[80:95], v[26:27], v[42:43], v[80:95]
    s_nop 15
    s_nop 3
    v_max3_f32 v8, v8, v64, v65
    v_max3_f32 v8, v8, v66, v67
    v_max3_f32 v8, v8, v68, v69
    v_max3_f32 v8, v8, v70, v71
    v_max3_f32 v8, v8, v72, v73
    v_max3_f32 v8, v8, v74, v75
    v_max3_f32 v8, v8, v76, v77
    v_max3_f32 v8, v8, v78, v79
    v_max3_f32 v9, v9, v80, v81
    v_max3_f32 v9, v9, v82, v83
    v_max3_f32 v9, v9, v84, v85
    v_max3_f32 v9, v9, v86, v87
    v_max3_f32 v9, v9, v88, v89
    v_max3_f32 v9, v9, v90, v91
    v_max3_f32 v9, v9, v92, v93
    v_max3_f32 v9, v9, v94, v95
    ds_read2st64_b64 v[20:23], v4 offset0:4 offset1:5
    ds_read_b64 v[24:25], v5 offset:3328
    s_waitcnt lgkmcnt(0)
    v_mfma_f32_32x32x16_bf16 v[64:79], v[20:23], v[32:35], 0
    v_mfma_f32_32x32x16_bf16 v[80:95], v[20:23], v[36:39], 0
    v_mfma_f32_32x32x8bf16_1k v[64:79], v[24:25], v[40:41], v[64:79]
    v_mfma_f32_32x32x8bf16_1k v[80:95], v[24:25], v[42:43], v[80:95]
    s_nop 15
    s_nop 3
    v_max3_f32 v8, v8, v64, v65
    v_max3_f32 v8, v8, v66, v67
    v_max3_f32 v8, v8, v68, v69
    v_max3_f32 v8, v8, v70, v71
    v_max3_f32 v8, v8, v72, v73
    v_max3_f32 v8, v8, v74, v75
    v_max3_f32 v8, v8, v76, v77
    v_max3_f32 v8, v8, v78, v79
    v_max3_f32 v9, v9, v80, v81
    v_max3_f32 v9, v9, v82, v83
    v_max3_f32 v9, v9, v84, v85
    v_max3_f32 v9, v9, v86, v87
    v_max3_f32 v9, v9, v88, v89
    v_max3_f32 v9, v9, v90, v91
    v_max3_f32 v9, v9, v92, v93
    v_max3_f32 v9, v9, v94, v95
    ds_read2st64_b64 v[20:23], v4 offset0:6 offset1:7
    ds_read_b64 v[26:27], v5 offset:4992
    s_waitcnt lgkmcnt(0)
    v_mfma_f32_32x32x16_bf16 v[64:79], v[20:23], v[32:35], 0
    v_mfma_f32_32x32x16_bf16 v[80:95], v[20:23], v[36:39], 0
    v_mfma_f32_32x32x8bf16_1k v[64:79], v[26:27], v[40:41], v[64:79]
    v_mfma_f32_32x32x8bf16_1k v[80:95], v[26:27], v[42:43], v[80:95]
    s_nop 15
    s_nop 3
    v_max3_f32 v8, v8, v64, v65
    v_max3_f32 v8, v8, v66, v67
    v_max3_f32 v8, v8, v68, v69
    v_max3_f32 v8, v8, v70, v71
    v_max3_f32 v8, v8, v72, v73
    v_max3_f32 v8, v8, v74, v75
    v_max3_f32 v8, v8, v76, v77
    v_max3_f32 v8, v8, v78, v79
    v_max3_f32 v9, v9, v80, v81
    v_max3_f32 v9, v9, v82, v83
    v_max3_f32 v9, v9, v84, v85
    v_max3_f32 v9, v9, v86, v87
    v_max3_f32 v9, v9, v88, v89
    v_max3_f32 v9, v9, v90, v91
    v_max3_f32 v9, v9, v92, v93
    v_max3_f32 v9, v9, v94, v95
    ds_read2st64_b64 v[20:23], v4 offset0:8 offset1:9
    ds_read_b64 v[24:25], v5 offset:6656
    s_waitcnt lgkmcnt(0)
    v_mfma_f32_32x32x16_bf16 v[64:79], v[20:23], v[32:35], 0
    v_mfma_f32_32x32x16_bf16 v[80:95], v[20:23], v[36:39], 0
    v_mfma_f32_32x32x8bf16_1k v[64:79], v[24:25], v[40:41], v[64:79]
    v_mfma_f32_32x32x8bf16_1k v[80:95], v[24:25], v[42:43], v[80:95]
    s_nop 15
    s_nop 3
    v_max3_f32 v8, v8, v64, v65
    v_max3_f32 v8, v8, v66, v67
    v_max3_f32 v8, v8, v68, v69
    v_max3_f32 v8, v8, v70, v71
    v_max3_f32 v8, v8, v72, v73
    v_max3_f32 v8, v8, v74, v75
    v_max3_f32 v8, v8, v76, v77
    v_max3_f32 v8, v8, v78, v79
    v_max3_f32 v9, v9, v80, v81
    v_max3_f32 v9, v9, v82, v83
    v_max3_f32 v9, v9, v84, v85
    v_max3_f32 v9, v9, v86, v87
    v_max3_f32 v9, v9, v88, v89
    v_max3_f32 v9, v9, v90, v91
    v_max3_f32 v9, v9, v92, v93
    v_max3_f32 v9, v9, v94, v95
    ds_read2st64_b64 v[20:23], v4 offset0:10 offset1:11
    ds_read_b64 v[26:27], v5 offset:8320
    s_waitcnt lgkmcnt(0)
    v_mfma_f32_32x32x16_bf16 v[64:79], v[20:23], v[32:35], 0
    v_mfma_f32_32x32x16_bf16 v[80:95], v[20:23], v[36:39], 0
    v_mfma_f32_32x32x8bf16_1k v[64:79], v[26:27], v[40:41], v[64:79]
    v_mfma_f32_32x32x8bf16_1k v[80:95], v[26:27], v[42:43], v[80:95]
    s_nop 15
    s_nop 3
    v_max3_f32 v8, v8, v64, v65
    v_max3_f32 v8, v8, v66, v67
    v_max3_f32 v8, v8, v68, v69
    v_max3_f32 v8, v8, v70, v71
    v_max3_f32 v8, v8, v72, v73
    v_max3_f32 v8, v8, v74, v75
    v_max3_f32 v8, v8, v76, v77
    v_max3_f32 v8, v8, v78, v79
    v_max3_f32 v9, v9, v80, v81
    v_max3_f32 v9, v9, v82, v83
    v_max3_f32 v9, v9, v84, v85
    v_max3_f32 v9, v9, v86, v87
    v_max3_f32 v9, v9, v88, v89
    v_max3_f32 v9, v9, v90, v91
    v_max3_f32 v9, v9, v92, v93
    v_max3_f32 v9, v9, v94, v95
    ds_read2st64_b64 v[20:23], v4 offset0:12 offset1:13
    ds_read_b64 v[24:25], v5 offset:9984
    s_waitcnt lgkmcnt(0)
    v_mfma_f32_32x32x16_bf16 v[64:79], v[20:23], v[32:35], 0
    v_mfma_f32_32x32x16_bf16 v[80:95], v[20:23], v[36:39], 0
    v_mfma_f32_32x32x8bf16_1k v[64:79], v[24:25], v[40:41], v[64:79]
    v_mfma_f32_32x32x8bf16_1k v[80:95], v[24:25], v[42:43], v[80:95]
    s_nop 15
    s_nop 3
    v_max3_f32 v8, v8, v64, v65
    v_max3_f32 v8, v8, v66, v67
    v_max3_f32 v8, v8, v68, v69
    v_max3_f32 v8, v8, v70, v71
    v_max3_f32 v8, v8, v72, v73
    v_max3_f32 v8, v8, v74, v75
    v_max3_f32 v8, v8, v76, v77
    v_max3_f32 v8, v8, v78, v79
    v_max3_f32 v9, v9, v80, v81
    v_max3_f32 v9, v9, v82, v83
    v_max3_f32 v9, v9, v84, v85
    v_max3_f32 v9, v9, v86, v87
    v_max3_f32 v9, v9, v88, v89
    v_max3_f32 v9, v9, v90, v91
    v_max3_f32 v9, v9, v92, v93
    v_max3_f32 v9, v9, v94, v95
    ds_read2st64_b64 v[20:23], v4 offset0:14 offset1:15
    ds_read_b64 v[26:27], v5 offset:11648
    s_waitcnt lgkmcnt(0)
    v_mfma_f32_32x32x16_bf16 v[64:79], v[20:23], v[32:35], 0
    v_mfma_f32_32x32x16_bf16 v[80:95], v[20:23], v[36:39], 0
    v_mfma_f32_32x32x8bf16_1k v[64:79], v[26:27], v[40:41], v[64:79]
    v_mfma_f32_32x32x8bf16_1k v[80:95], v[26:27], v[42:43], v[80:95]
    s_nop 15
    s_nop 3
    v_max3_f32 v8, v8, v64, v65
    v_max3_f32 v8, v8, v66, v67
    v_max3_f32 v8, v8, v68, v69
    v_max3_f32 v8, v8, v70, v71
    v_max3_f32 v8, v8, v72, v73
    v_max3_f32 v8, v8, v74, v75
    v_max3_f32 v8, v8, v76, v77
    v_max3_f32 v8, v8, v78, v79
    v_max3_f32 v9, v9, v80, v81
    v_max3_f32 v9, v9, v82, v83
    v_max3_f32 v9, v9, v84, v85
    v_max3_f32 v9, v9, v86, v87
    v_max3_f32 v9, v9, v88, v89
    v_max3_f32 v9, v9, v90, v91
    v_max3_f32 v9, v9, v92, v93
    v_max3_f32 v9, v9, v94, v95
    s_add_u32 s40, s40, 1
    s_mov_b32 s47, 21504
    s_cmp_eq_u32 s40, 3
    s_cselect_b32 s47, -43008, s47
    s_cmp_eq_u32 s40, 6
    s_cselect_b32 s47, -43008, s47
    v_add_u32 v4, s47, v4
    v_add_u32 v5, s47, v5
    s_cmp_lt_u32 s40, 8
    s_cbranch_scc1 K2_MSTAGE
    v_mov_b32 v3, v8
    v_mov_b32 v5, v9
    s_nop 1
    v_permlane32_swap_b32 v8, v3
    v_permlane32_swap_b32 v9, v5
    s_nop 1
    v_max_f32 v8, v8, v3
    v_max_f32 v9, v9, v5
    v_and_b32 v3, 0xffff0000, v8
    v_sub_f32 v2, v8, v3
    v_and_b32 v19, 0xffff0000, v2
    v_sub_f32 v2, v2, v19
    v_lshrrev_b32 v3, 16, v3
    v_or_b32 v3, v3, v19
    v_xor_b32 v3, 0x80008000, v3
    v_lshrrev_b32 v2, 16, v2
    v_xor_b32 v2, 0x8000, v2
    v_and_b32 v5, 0xffff0000, v9
    v_sub_f32 v4, v9, v5
    v_and_b32 v6, 0xffff0000, v4
    v_sub_f32 v4, v4, v6
    v_lshrrev_b32 v5, 16, v5
    v_or_b32 v5, v5, v6
    v_xor_b32 v5, 0x80008000, v5
    v_lshrrev_b32 v4, 16, v4
    v_xor_b32 v4, 0x8000, v4
    v_cmp_eq_u32 vcc, 0, v18
    s_nop 1
    v_cndmask_b32 v40, v3, v40, vcc
    v_cndmask_b32 v41, v2, v41, vcc
    v_cndmask_b32 v42, v5, v42, vcc
    v_cndmask_b32 v43, v4, v43, vcc
    s_mov_b32 s39, 1
    s_barrier
    v_mov_b32 v52, 0
    v_mov_b32 v53, 0
    v_mov_b32 v54, 0
    v_mov_b32 v55, 0
    v_mov_b32 v60, 0
    v_mov_b32 v61, 0
    v_mov_b32 v62, 0
    v_mov_b32 v63, 0
    v_mov_b32 v96, 0
    v_mov_b32 v97, 0
    v_mov_b32 v98, 0
    v_mov_b32 v99, 0
    v_mov_b32 v100, 0
    v_mov_b32 v101, 0
    v_mov_b32 v102, 0
    v_mov_b32 v103, 0
    v_mov_b32 v104, 0
    v_mov_b32 v105, 0
    v_mov_b32 v106, 0
    v_mov_b32 v107, 0
    v_mov_b32 v108, 0
    v_mov_b32 v109, 0
    v_mov_b32 v110, 0
    v_mov_b32 v111, 0
    v_mov_b32 v112, 0
    v_mov_b32 v113, 0
    v_mov_b32 v114, 0
    v_mov_b32 v115, 0
    v_mov_b32 v116, 0
    v_mov_b32 v117, 0
    v_mov_b32 v118, 0
    v_mov_b32 v119, 0
    v_mov_b32 v120, 0
    v_mov_b32 v121, 0
    v_mov_b32 v122, 0
    v_mov_b32 v123, 0
    v_mov_b32 v124, 0
    v_mov_b32 v125, 0
    v_mov_b32 v126, 0
    v_mov_b32 v127, 0
    v_mov_b32 v132, 0
    v_mov_b32 v133, 0
    v_mov_b32 v134, 0
    v_mov_b32 v135, 0
    s_barrier
    s_branch A_GO
PA_LSKIP:
    v_cvt_pk_bf16_f32 v34, v36, v37
    v_cvt_pk_bf16_f32 v35, v38, v39
    v_pk_max_i16 v32, v32, 0
    v_pk_max_i16 v33, v33, 0
    v_pk_max_i16 v34, v34, 0
    v_pk_max_i16 v35, v35, 0
    buffer_store_dwordx4 v[32:35], v1, s[28:31], s76 offen offset:0 sc1
    v_cvt_pk_bf16_f32 v36, v40, v41
    v_cvt_pk_bf16_f32 v37, v42, v43
    v_cvt_pk_bf16_f32 v38, v44, v45
    v_cvt_pk_bf16_f32 v39, v46, v47
    v_pk_max_i16 v36, v36, 0
    v_pk_max_i16 v37, v37, 0
    v_pk_max_i16 v38, v38, 0
    v_pk_max_i16 v39, v39, 0
    buffer_store_dwordx4 v[36:39], v1, s[28:31], s76 offen offset:1024 sc1
    s_add_u32 s76, s76, 4096
    s_nop 15
    s_nop 3
    v_cvt_pk_bf16_f32 v48, v48, v49
    v_cvt_pk_bf16_f32 v49, v50, v51
    v_cvt_pk_bf16_f32 v50, v52, v53
    v_cvt_pk_bf16_f32 v51, v54, v55
    v_pk_max_i16 v48, v48, 0
    v_pk_max_i16 v49, v49, 0
    v_pk_max_i16 v50, v50, 0
    v_pk_max_i16 v51, v51, 0
    buffer_store_dwordx4 v[48:51], v1, s[28:31], s76 offen offset:0 sc1
    v_cvt_pk_bf16_f32 v52, v56, v57
    v_cvt_pk_bf16_f32 v53, v58, v59
    v_cvt_pk_bf16_f32 v54, v60, v61
    v_cvt_pk_bf16_f32 v55, v62, v63
    v_pk_max_i16 v52, v52, 0
    v_pk_max_i16 v53, v53, 0
    v_pk_max_i16 v54, v54, 0
    v_pk_max_i16 v55, v55, 0
    buffer_store_dwordx4 v[52:55], v1, s[28:31], s76 offen offset:1024 sc1
    s_and_b32 s3, s2, 7
    s_lshl_b32 s3, s3, 2
    s_bfe_u32 s36, s2, 0x20003
    s_add_u32 s36, s3, s36
    s_bfe_u32 s3, s2, 0x10005
    s_lshl_b32 s3, s3, 2
    s_lshr_b32 s37, s2, 6
    s_add_u32 s37, s37, s3
    s_add_u32 s20, s8, 20971520
    s_addc_u32 s21, s9, 0
    s_and_b32 s21, s21, 0xffff
    s_mov_b32 s22, 2621440
    s_mov_b32 s23, 0x00020000
    s_mov_b32 s39, 0
    s_mul_i32 s3, s38, 3072
    s_add_u32 s3, s3, 147456
    v_add_u32 v11, s3, v1
    v_bfe_u32 v4, v1, 4, 5
    v_lshrrev_b32 v5, 9, v1
    v_lshlrev_b32 v2, 3, v4
    v_lshl_add_u32 v12, v5, 8, v2
    v_add_u32 v2, 9472, v2
    v_mov_b32 v3, 9728
    v_cmp_eq_u32 vcc, 0, v5
    v_mul_u32_u24 v0, 320, v5
    v_cndmask_b32 v13, v3, v2, vcc
    v_lshl_add_u32 v2, v4, 4, v0
    v_cmp_gt_u32 vcc, 20, v4
    v_add_u32 v14, 8192, v2
    v_add_u32 v15, 8832, v2
    v_min_u32 v3, 21, v4
    v_lshlrev_b32 v3, 4, v3
    v_add_u32 v3, 9424, v3
    v_cndmask_b32 v14, v3, v14, vcc
    v_cndmask_b32 v15, v3, v15, vcc
    v_mov_b32 v96, 0
    v_mov_b32 v97, 0
    v_mov_b32 v98, 0
    v_mov_b32 v99, 0
    v_mov_b32 v100, 0
    v_mov_b32 v101, 0
    v_mov_b32 v102, 0
    v_mov_b32 v103, 0
    v_mov_b32 v104, 0
    v_mov_b32 v105, 0
    v_mov_b32 v106, 0
    v_mov_b32 v107, 0
    v_mov_b32 v108, 0
    v_mov_b32 v109, 0
    v_mov_b32 v110, 0
    v_mov_b32 v111, 0
    v_mov_b32 v112, 0
    v_mov_b32 v113, 0
    v_mov_b32 v114, 0
    v_mov_b32 v115, 0
    v_mov_b32 v116, 0
    v_mov_b32 v117, 0
    v_mov_b32 v118, 0
    v_mov_b32 v119, 0
    v_mov_b32 v120, 0
    v_mov_b32 v121, 0
    v_mov_b32 v122, 0
    v_mov_b32 v123, 0
    v_mov_b32 v124, 0
    v_mov_b32 v125, 0
    v_mov_b32 v126, 0
    v_mov_b32 v127, 0
    v_mov_b32 v132, 0
    v_mov_b32 v133, 0
    v_mov_b32 v134, 0
    v_mov_b32 v135, 0
    v_mov_b32 v52, 0
    v_mov_b32 v53, 0
    v_mov_b32 v54, 0
    v_mov_b32 v55, 0
    v_mov_b32 v60, 0
    v_mov_b32 v61, 0
    v_mov_b32 v62, 0
    v_mov_b32 v63, 0
    s_branch PA_END
K_SPARE:
    s_waitcnt vmcnt(0)
    s_load_dwordx2 s[44:45], s[0:1], 48
    v_cmp_eq_u32 vcc, 63, v1
    s_mov_b64 s[50:51], vcc
    v_lshlrev_b32 v16, 3, v1
    v_lshlrev_b32 v17, 2, v1
    s_lshl_b32 s3, s24, 3
    s_add_u32 s3, s3, s38
    s_mul_i32 s49, s3, 20480
    s_lshl_b32 s48, s3, 6
    s_lshl_b32 s3, s24, 9
    v_add_u32 v18, s3, v0
    s_waitcnt lgkmcnt(0)
    s_mov_b32 s12, s4
    s_and_b32 s13, s5, 0xffff
    s_mov_b32 s14, 2621440
    s_mov_b32 s15, 0x00020000
    s_mov_b32 s16, s44
    s_and_b32 s17, s45, 0xffff
    s_mov_b32 s18, 1280
    s_mov_b32 s19, 0x00020000
    s_add_u32 s28, s8, 25165824
    s_addc_u32 s29, s9, 0
    s_and_b32 s29, s29, 0xffff
    s_mov_b32 s30, 8192
    s_mov_b32 s31, 0x00020000
    s_add_u32 s52, s8, 41943040
    s_addc_u32 s53, s9, 0
    s_and_b32 s53, s53, 0xffff
    s_mov_b32 s54, 139264
    s_mov_b32 s55, 0x00020000
    s_mov_b32 s80, s80
    s_and_b32 s81, s81, 0xffff
    s_mov_b32 s82, 256
    s_mov_b32 s83, 0x00020000
    buffer_load_dwordx2 v[24:25], v16, s[16:19], 0 offen offset:0
    buffer_load_dwordx2 v[26:27], v16, s[16:19], 0 offen offset:512
    buffer_load_dword v28, v17, s[16:19], 0 offen offset:1024
    buffer_load_dwordx2 v[136:137], v16, s[12:15], s49 offen offset:0
    buffer_load_dwordx2 v[138:139], v16, s[12:15], s49 offen offset:512
    buffer_load_dword v140, v17, s[12:15], s49 offen offset:1024
    buffer_load_dwordx2 v[142:143], v16, s[12:15], s49 offen offset:1280
    buffer_load_dwordx2 v[144:145], v16, s[12:15], s49 offen offset:1792
    buffer_load_dword v146, v17, s[12:15], s49 offen offset:2304
    s_add_u32 s49, s49, 2560
    buffer_load_dwordx2 v[148:149], v16, s[12:15], s49 offen offset:0
    buffer_load_dwordx2 v[150:151], v16, s[12:15], s49 offen offset:512
    buffer_load_dword v152, v17, s[12:15], s49 offen offset:1024
    buffer_load_dwordx2 v[154:155], v16, s[12:15], s49 offen offset:1280
    buffer_load_dwordx2 v[156:157], v16, s[12:15], s49 offen offset:1792
    buffer_load_dword v158, v17, s[12:15], s49 offen offset:2304
    s_add_u32 s49, s49, 2560
    buffer_load_dwordx2 v[160:161], v16, s[12:15], s49 offen offset:0
    buffer_load_dwordx2 v[162:163], v16, s[12:15], s49 offen offset:512
    buffer_load_dword v164, v17, s[12:15], s49 offen offset:1024
    buffer_load_dwordx2 v[166:167], v16, s[12:15], s49 offen offset:1280
    buffer_load_dwordx2 v[168:169], v16, s[12:15], s49 offen offset:1792
    buffer_load_dword v170, v17, s[12:15], s49 offen offset:2304
    s_add_u32 s49, s49, 2560
    buffer_load_dwordx2 v[172:173], v16, s[12:15], s49 offen offset:0
    buffer_load_dwordx2 v[174:175], v16, s[12:15], s49 offen offset:512
    buffer_load_dword v176, v17, s[12:15], s49 offen offset:1024
    buffer_load_dwordx2 v[178:179], v16, s[12:15], s49 offen offset:1280
    buffer_load_dwordx2 v[180:181], v16, s[12:15], s49 offen offset:1792
    buffer_load_dword v182, v17, s[12:15], s49 offen offset:2304
    s_add_u32 s49, s49, 2560
    buffer_load_dwordx2 v[184:185], v16, s[12:15], s49 offen offset:0
    buffer_load_dwordx2 v[186:187], v16, s[12:15], s49 offen offset:512
    buffer_load_dword v188, v17, s[12:15], s49 offen offset:1024
    buffer_load_dwordx2 v[190:191], v16, s[12:15], s49 offen offset:1280
    buffer_load_dwordx2 v[192:193], v16, s[12:15], s49 offen offset:1792
    buffer_load_dword v194, v17, s[12:15], s49 offen offset:2304
    s_add_u32 s49, s49, 2560
    buffer_load_dwordx2 v[196:197], v16, s[12:15], s49 offen offset:0
    buffer_load_dwordx2 v[198:199], v16, s[12:15], s49 offen offset:512
    buffer_load_dword v200, v17, s[12:15], s49 offen offset:1024
    buffer_load_dwordx2 v[202:203], v16, s[12:15], s49 offen offset:1280
    buffer_load_dwordx2 v[204:205], v16, s[12:15], s49 offen offset:1792
    buffer_load_dword v206, v17, s[12:15], s49 offen offset:2304
    s_add_u32 s49, s49, 2560
    buffer_load_dwordx2 v[208:209], v16, s[12:15], s49 offen offset:0
    buffer_load_dwordx2 v[210:211], v16, s[12:15], s49 offen offset:512
    buffer_load_dword v212, v17, s[12:15], s49 offen offset:1024
    buffer_load_dwordx2 v[214:215], v16, s[12:15], s49 offen offset:1280
    buffer_load_dwordx2 v[216:217], v16, s[12:15], s49 offen offset:1792
    buffer_load_dword v218, v17, s[12:15], s49 offen offset:2304
    s_add_u32 s49, s49, 2560
    buffer_load_dwordx2 v[220:221], v16, s[12:15], s49 offen offset:0
    buffer_load_dwordx2 v[222:223], v16, s[12:15], s49 offen offset:512
    buffer_load_dword v224, v17, s[12:15], s49 offen offset:1024
    buffer_load_dwordx2 v[226:227], v16, s[12:15], s49 offen offset:1280
    buffer_load_dwordx2 v[228:229], v16, s[12:15], s49 offen offset:1792
    buffer_load_dword v230, v17, s[12:15], s49 offen offset:2304
    s_add_u32 s49, s49, 2560
    s_waitcnt vmcnt(42)
    v_lshlrev_b32 v32, 16, v24
    v_and_b32 v33, 0xffff0000, v24
    v_lshlrev_b32 v34, 16, v25
    v_and_b32 v35, 0xffff0000, v25
    v_lshlrev_b32 v36, 16, v26
    v_and_b32 v37, 0xffff0000, v26
    v_lshlrev_b32 v38, 16, v27
    v_and_b32 v39, 0xffff0000, v27
    v_lshlrev_b32 v40, 16, v28
    v_and_b32 v41, 0xffff0000, v28
    v_mov_b32 v44, 0
    v_mov_b32 v45, 0
    v_lshlrev_b32 v46, 16, v136
    v_and_b32 v47, 0xffff0000, v136
    v_mul_f32 v46, v46, v32
    v_mul_f32 v47, v47, v33
    v_cvt_pk_bf16_f32 v46, v46, v47
    v_and_b32 v47, 0xffff0000, v46
    v_lshlrev_b32 v46, 16, v46
    v_add_f32 v44, v44, v47
    v_add_f32 v44, v44, v46
    v_lshlrev_b32 v46, 16, v137
    v_and_b32 v47, 0xffff0000, v137
    v_mul_f32 v46, v46, v34
    v_mul_f32 v47, v47, v35
    v_cvt_pk_bf16_f32 v46, v46, v47
    v_and_b32 v47, 0xffff0000, v46
    v_lshlrev_b32 v46, 16, v46
    v_add_f32 v44, v44, v47
    v_add_f32 v44, v44, v46
    v_lshlrev_b32 v46, 16, v138
    v_and_b32 v47, 0xffff0000, v138
    v_mul_f32 v46, v46, v36
    v_mul_f32 v47, v47, v37
    v_cvt_pk_bf16_f32 v46, v46, v47
    v_and_b32 v47, 0xffff0000, v46
    v_lshlrev_b32 v46, 16, v46
    v_add_f32 v44, v44, v47
    v_add_f32 v44, v44, v46
    v_lshlrev_b32 v46, 16, v139
    v_and_b32 v47, 0xffff0000, v139
    v_mul_f32 v46, v46, v38
    v_mul_f32 v47, v47, v39
    v_cvt_pk_bf16_f32 v46, v46, v47
    v_and_b32 v47, 0xffff0000, v46
    v_lshlrev_b32 v46, 16, v46
    v_add_f32 v44, v44, v47
    v_add_f32 v44, v44, v46
    v_lshlrev_b32 v46, 16, v140
    v_and_b32 v47, 0xffff0000, v140
    v_mul_f32 v46, v46, v40
    v_mul_f32 v47, v47, v41
    v_cvt_pk_bf16_f32 v46, v46, v47
    v_and_b32 v47, 0xffff0000, v46
    v_lshlrev_b32 v46, 16, v46
    v_add_f32 v44, v44, v47
    v_add_f32 v44, v44, v46
    v_lshlrev_b32 v46, 16, v142
    v_and_b32 v47, 0xffff0000, v142
    v_mul_f32 v46, v46, v32
    v_mul_f32 v47, v47, v33
    v_cvt_pk_bf16_f32 v46, v46, v47
    v_and_b32 v47, 0xffff0000, v46
    v_lshlrev_b32 v46, 16, v46
    v_add_f32 v45, v45, v47
    v_add_f32 v45, v45, v46
    v_lshlrev_b32 v46, 16, v143
    v_and_b32 v47, 0xffff0000, v143
    v_mul_f32 v46, v46, v34
    v_mul_f32 v47, v47, v35
    v_cvt_pk_bf16_f32 v46, v46, v47
    v_and_b32 v47, 0xffff0000, v46
    v_lshlrev_b32 v46, 16, v46
    v_add_f32 v45, v45, v47
    v_add_f32 v45, v45, v46
    v_lshlrev_b32 v46, 16, v144
    v_and_b32 v47, 0xffff0000, v144
    v_mul_f32 v46, v46, v36
    v_mul_f32 v47, v47, v37
    v_cvt_pk_bf16_f32 v46, v46, v47
    v_and_b32 v47, 0xffff0000, v46
    v_lshlrev_b32 v46, 16, v46
    v_add_f32 v45, v45, v47
    v_add_f32 v45, v45, v46
    v_lshlrev_b32 v46, 16, v145
    v_and_b32 v47, 0xffff0000, v145
    v_mul_f32 v46, v46, v38
    v_mul_f32 v47, v47, v39
    v_cvt_pk_bf16_f32 v46, v46, v47
    v_and_b32 v47, 0xffff0000, v46
    v_lshlrev_b32 v46, 16, v46
    v_add_f32 v45, v45, v47
    v_add_f32 v45, v45, v46
    v_lshlrev_b32 v46, 16, v146
    v_and_b32 v47, 0xffff0000, v146
    v_mul_f32 v46, v46, v40
    v_mul_f32 v47, v47, v41
    v_cvt_pk_bf16_f32 v46, v46, v47
    v_and_b32 v47, 0xffff0000, v46
    v_lshlrev_b32 v46, 16, v46
    v_add_f32 v45, v45, v47
    v_add_f32 v45, v45, v46
    s_nop 2
    v_add_f32_dpp v44, v44, v44 row_shr:1 row_mask:0xf bank_mask:0xf
    v_add_f32_dpp v45, v45, v45 row_shr:1 row_mask:0xf bank_mask:0xf
    s_nop 0
    v_add_f32_dpp v44, v44, v44 row_shr:2 row_mask:0xf bank_mask:0xf
    v_add_f32_dpp v45, v45, v45 row_shr:2 row_mask:0xf bank_mask:0xf
    s_nop 0
    v_add_f32_dpp v44, v44, v44 row_shr:4 row_mask:0xf bank_mask:0xf
    v_add_f32_dpp v45, v45, v45 row_shr:4 row_mask:0xf bank_mask:0xf
    s_nop 0
    v_add_f32_dpp v44, v44, v44 row_shr:8 row_mask:0xf bank_mask:0xf
    v_add_f32_dpp v45, v45, v45 row_shr:8 row_mask:0xf bank_mask:0xf
    s_nop 0
    v_add_f32_dpp v44, v44, v44 row_bcast:15 row_mask:0xa bank_mask:0xf
    v_add_f32_dpp v45, v45, v45 row_bcast:15 row_mask:0xa bank_mask:0xf
    s_nop 0
    v_add_f32_dpp v44, v44, v44 row_bcast:31 row_mask:0xc bank_mask:0xf
    v_add_f32_dpp v45, v45, v45 row_bcast:31 row_mask:0xc bank_mask:0xf
    s_nop 1
    v_cvt_pk_bf16_f32 v44, v44, v45
    v_and_b32 v45, 0xffff0000, v44
    v_lshlrev_b32 v44, 16, v44
    v_mul_f32 v44, 3216550459, v44
    v_mul_f32 v45, 3216550459, v45
    v_exp_f32 v44, v44
    v_exp_f32 v45, v45
    s_nop 0
    v_add_f32 v44, 1.0, v44
    v_add_f32 v45, 1.0, v45
    v_rcp_f32 v44, v44
    v_rcp_f32 v45, v45
    s_nop 0
    v_cvt_pk_bf16_f32 v44, v44, v45
    v_and_b32 v45, 0xffff0000, v44
    v_lshlrev_b32 v44, 16, v44
    v_mov_b32 v46, 0
    s_mov_b64 exec, s[50:51]
    buffer_store_dwordx2 v[44:45], v46, s[28:31], s48 offen offset:0 sc1
    s_mov_b64 exec, -1
    s_waitcnt vmcnt(37)
    v_mov_b32 v44, 0
    v_mov_b32 v45, 0
    v_lshlrev_b32 v46, 16, v148
    v_and_b32 v47, 0xffff0000, v148
    v_mul_f32 v46, v46, v32
    v_mul_f32 v47, v47, v33
    v_cvt_pk_bf16_f32 v46, v46, v47
    s_branch PADX_10
PAD_10:
    s_branch PAD_14
PADX_10:
    v_and_b32 v47, 0xffff0000, v46
    v_lshlrev_b32 v46, 16, v46
    v_add_f32 v44, v44, v47
    v_add_f32 v44, v44, v46
    v_lshlrev_b32 v46, 16, v149
    v_and_b32 v47, 0xffff0000, v149
    v_mul_f32 v46, v46, v34
    v_mul_f32 v47, v47, v35
    v_cvt_pk_bf16_f32 v46, v46, v47
    v_and_b32 v47, 0xffff0000, v46
    v_lshlrev_b32 v46, 16, v46
    v_add_f32 v44, v44, v47
    v_add_f32 v44, v44, v46
    v_lshlrev_b32 v46, 16, v150
    v_and_b32 v47, 0xffff0000, v150
    v_mul_f32 v46, v46, v36
    v_mul_f32 v47, v47, v37
    v_cvt_pk_bf16_f32 v46, v46, v47
    v_and_b32 v47, 0xffff0000, v46
    v_lshlrev_b32 v46, 16, v46
    v_add_f32 v44, v44, v47
    v_add_f32 v44, v44, v46
    v_lshlrev_b32 v46, 16, v151
    v_and_b32 v47, 0xffff0000, v151
    v_mul_f32 v46, v46, v38
    v_mul_f32 v47, v47, v39
    v_cvt_pk_bf16_f32 v46, v46, v47
    v_and_b32 v47, 0xffff0000, v46
    v_lshlrev_b32 v46, 16, v46
    v_add_f32 v44, v44, v47
    v_add_f32 v44, v44, v46
    v_lshlrev_b32 v46, 16, v152
    v_and_b32 v47, 0xffff0000, v152
    v_mul_f32 v46, v46, v40
    v_mul_f32 v47, v47, v41
    v_cvt_pk_bf16_f32 v46, v46, v47
    v_and_b32 v47, 0xffff0000, v46
    v_lshlrev_b32 v46, 16, v46
    v_add_f32 v44, v44, v47
    v_add_f32 v44, v44, v46
    v_lshlrev_b32 v46, 16, v154
    v_and_b32 v47, 0xffff0000, v154
    v_mul_f32 v46, v46, v32
    v_mul_f32 v47, v47, v33
    v_cvt_pk_bf16_f32 v46, v46, v47
    v_and_b32 v47, 0xffff0000, v46
    v_lshlrev_b32 v46, 16, v46
    v_add_f32 v45, v45, v47
    v_add_f32 v45, v45, v46
    v_lshlrev_b32 v46, 16, v155
    v_and_b32 v47, 0xffff0000, v155
    v_mul_f32 v46, v46, v34
    v_mul_f32 v47, v47, v35
    v_cvt_pk_bf16_f32 v46, v46, v47
    v_and_b32 v47, 0xffff0000, v46
    v_lshlrev_b32 v46, 16, v46
    v_add_f32 v45, v45, v47
    v_add_f32 v45, v45, v46
    v_lshlrev_b32 v46, 16, v156
    v_and_b32 v47, 0xffff0000, v156
    v_mul_f32 v46, v46, v36
    v_mul_f32 v47, v47, v37
    v_cvt_pk_bf16_f32 v46, v46, v47
    v_and_b32 v47, 0xffff0000, v46
    v_lshlrev_b32 v46, 16, v46
    v_add_f32 v45, v45, v47
    v_add_f32 v45, v45, v46
    v_lshlrev_b32 v46, 16, v157
    v_and_b32 v47, 0xffff0000, v157
    v_mul_f32 v46, v46, v38
    v_mul_f32 v47, v47, v39
    v_cvt_pk_bf16_f32 v46, v46, v47
    v_and_b32 v47, 0xffff0000, v46
    v_lshlrev_b32 v46, 16, v46
    v_add_f32 v45, v45, v47
    v_add_f32 v45, v45, v46
    v_lshlrev_b32 v46, 16, v158
    v_and_b32 v47, 0xffff0000, v158
    v_mul_f32 v46, v46, v40
    v_mul_f32 v47, v47, v41
    v_cvt_pk_bf16_f32 v46, v46, v47
    v_and_b32 v47, 0xffff0000, v46
    v_lshlrev_b32 v46, 16, v46
    v_add_f32 v45, v45, v47
    v_add_f32 v45, v45, v46
    s_nop 2
    v_add_f32_dpp v44, v44, v44 row_shr:1 row_mask:0xf bank_mask:0xf
    v_add_f32_dpp v45, v45, v45 row_shr:1 row_mask:0xf bank_mask:0xf
    s_nop 0
    v_add_f32_dpp v44, v44, v44 row_shr:2 row_mask:0xf bank_mask:0xf
    v_add_f32_dpp v45, v45, v45 row_shr:2 row_mask:0xf bank_mask:0xf
    s_nop 0
    v_add_f32_dpp v44, v44, v44 row_shr:4 row_mask:0xf bank_mask:0xf
    v_add_f32_dpp v45, v45, v45 row_shr:4 row_mask:0xf bank_mask:0xf
    s_nop 0
    v_add_f32_dpp v44, v44, v44 row_shr:8 row_mask:0xf bank_mask:0xf
    v_add_f32_dpp v45, v45, v45 row_shr:8 row_mask:0xf bank_mask:0xf
    s_nop 0
    v_add_f32_dpp v44, v44, v44 row_bcast:15 row_mask:0xa bank_mask:0xf
    v_add_f32_dpp v45, v45, v45 row_bcast:15 row_mask:0xa bank_mask:0xf
    s_nop 0
    v_add_f32_dpp v44, v44, v44 row_bcast:31 row_mask:0xc bank_mask:0xf
    v_add_f32_dpp v45, v45, v45 row_bcast:31 row_mask:0xc bank_mask:0xf
    s_nop 1
    v_cvt_pk_bf16_f32 v44, v44, v45
    v_and_b32 v45, 0xffff0000, v44
    v_lshlrev_b32 v44, 16, v44
    v_mul_f32 v44, 3216550459, v44
    v_mul_f32 v45, 3216550459, v45
    v_exp_f32 v44, v44
    v_exp_f32 v45, v45
    s_nop 0
    v_add_f32 v44, 1.0, v44
    v_add_f32 v45, 1.0, v45
    v_rcp_f32 v44, v44
    v_rcp_f32 v45, v45
    s_nop 0
    v_cvt_pk_bf16_f32 v44, v44, v45
    v_and_b32 v45, 0xffff0000, v44
    v_lshlrev_b32 v44, 16, v44
    v_mov_b32 v46, 0
    s_mov_b64 exec, s[50:51]
    buffer_store_dwordx2 v[44:45], v46, s[28:31], s48 offen offset:8 sc1
    s_mov_b64 exec, -1
    s_waitcnt vmcnt(32)
    v_mov_b32 v44, 0
    v_mov_b32 v45, 0
    v_lshlrev_b32 v46, 16, v160
    v_and_b32 v47, 0xffff0000, v160
    v_mul_f32 v46, v46, v32
    v_mul_f32 v47, v47, v33
    v_cvt_pk_bf16_f32 v46, v46, v47
    v_and_b32 v47, 0xffff0000, v46
    v_lshlrev_b32 v46, 16, v46
    v_add_f32 v44, v44, v47
    v_add_f32 v44, v44, v46
    v_lshlrev_b32 v46, 16, v161
    v_and_b32 v47, 0xffff0000, v161
    v_mul_f32 v46, v46, v34
    v_mul_f32 v47, v47, v35
    v_cvt_pk_bf16_f32 v46, v46, v47
    v_and_b32 v47, 0xffff0000, v46
    v_lshlrev_b32 v46, 16, v46
    v_add_f32 v44, v44, v47
    v_add_f32 v44, v44, v46
    v_lshlrev_b32 v46, 16, v162
    v_and_b32 v47, 0xffff0000, v162
    v_mul_f32 v46, v46, v36
    v_mul_f32 v47, v47, v37
    v_cvt_pk_bf16_f32 v46, v46, v47
    v_and_b32 v47, 0xffff0000, v46
    v_lshlrev_b32 v46, 16, v46
    v_add_f32 v44, v44, v47
    v_add_f32 v44, v44, v46
    v_lshlrev_b32 v46, 16, v163
    v_and_b32 v47, 0xffff0000, v163
    v_mul_f32 v46, v46, v38
    v_mul_f32 v47, v47, v39
    v_cvt_pk_bf16_f32 v46, v46, v47
    v_and_b32 v47, 0xffff0000, v46
    v_lshlrev_b32 v46, 16, v46
    v_add_f32 v44, v44, v47
    v_add_f32 v44, v44, v46
    v_lshlrev_b32 v46, 16, v164
    v_and_b32 v47, 0xffff0000, v164
    v_mul_f32 v46, v46, v40
    v_mul_f32 v47, v47, v41
    v_cvt_pk_bf16_f32 v46, v46, v47
    v_and_b32 v47, 0xffff0000, v46
    v_lshlrev_b32 v46, 16, v46
    v_add_f32 v44, v44, v47
    v_add_f32 v44, v44, v46
    v_lshlrev_b32 v46, 16, v166
    v_and_b32 v47, 0xffff0000, v166
    v_mul_f32 v46, v46, v32
    v_mul_f32 v47, v47, v33
    v_cvt_pk_bf16_f32 v46, v46, v47
    v_and_b32 v47, 0xffff0000, v46
    v_lshlrev_b32 v46, 16, v46
    v_add_f32 v45, v45, v47
    v_add_f32 v45, v45, v46
    v_lshlrev_b32 v46, 16, v167
    v_and_b32 v47, 0xffff0000, v167
    v_mul_f32 v46, v46, v34
    v_mul_f32 v47, v47, v35
    v_cvt_pk_bf16_f32 v46, v46, v47
    v_and_b32 v47, 0xffff0000, v46
    v_lshlrev_b32 v46, 16, v46
    v_add_f32 v45, v45, v47
    v_add_f32 v45, v45, v46
    v_lshlrev_b32 v46, 16, v168
    v_and_b32 v47, 0xffff0000, v168
    v_mul_f32 v46, v46, v36
    v_mul_f32 v47, v47, v37
    v_cvt_pk_bf16_f32 v46, v46, v47
    v_and_b32 v47, 0xffff0000, v46
    v_lshlrev_b32 v46, 16, v46
    v_add_f32 v45, v45, v47
    v_add_f32 v45, v45, v46
    v_lshlrev_b32 v46, 16, v169
    v_and_b32 v47, 0xffff0000, v169
    v_mul_f32 v46, v46, v38
    v_mul_f32 v47, v47, v39
    v_cvt_pk_bf16_f32 v46, v46, v47
    v_and_b32 v47, 0xffff0000, v46
    v_lshlrev_b32 v46, 16, v46
    v_add_f32 v45, v45, v47
    v_add_f32 v45, v45, v46
    v_lshlrev_b32 v46, 16, v170
    v_and_b32 v47, 0xffff0000, v170
    v_mul_f32 v46, v46, v40
    v_mul_f32 v47, v47, v41
    v_cvt_pk_bf16_f32 v46, v46, v47
    v_and_b32 v47, 0xffff0000, v46
    v_lshlrev_b32 v46, 16, v46
    v_add_f32 v45, v45, v47
    v_add_f32 v45, v45, v46
    s_nop 2
    v_add_f32_dpp v44, v44, v44 row_shr:1 row_mask:0xf bank_mask:0xf
    v_add_f32_dpp v45, v45, v45 row_shr:1 row_mask:0xf bank_mask:0xf
    s_nop 0
    v_add_f32_dpp v44, v44, v44 row_shr:2 row_mask:0xf bank_mask:0xf
    v_add_f32_dpp v45, v45, v45 row_shr:2 row_mask:0xf bank_mask:0xf
    s_nop 0
    v_add_f32_dpp v44, v44, v44 row_shr:4 row_mask:0xf bank_mask:0xf
    v_add_f32_dpp v45, v45, v45 row_shr:4 row_mask:0xf bank_mask:0xf
    s_nop 0
    v_add_f32_dpp v44, v44, v44 row_shr:8 row_mask:0xf bank_mask:0xf
    v_add_f32_dpp v45, v45, v45 row_shr:8 row_mask:0xf bank_mask:0xf
    s_nop 0
    v_add_f32_dpp v44, v44, v44 row_bcast:15 row_mask:0xa bank_mask:0xf
    v_add_f32_dpp v45, v45, v45 row_bcast:15 row_mask:0xa bank_mask:0xf
    s_nop 0
    v_add_f32_dpp v44, v44, v44 row_bcast:31 row_mask:0xc bank_mask:0xf
    v_add_f32_dpp v45, v45, v45 row_bcast:31 row_mask:0xc bank_mask:0xf
    s_nop 1
    v_cvt_pk_bf16_f32 v44, v44, v45
    v_and_b32 v45, 0xffff0000, v44
    v_lshlrev_b32 v44, 16, v44
    v_mul_f32 v44, 3216550459, v44
    v_mul_f32 v45, 3216550459, v45
    v_exp_f32 v44, v44
    v_exp_f32 v45, v45
    s_nop 0
    v_add_f32 v44, 1.0, v44
    v_add_f32 v45, 1.0, v45
    v_rcp_f32 v44, v44
    v_rcp_f32 v45, v45
    s_nop 0
    v_cvt_pk_bf16_f32 v44, v44, v45
    v_and_b32 v45, 0xffff0000, v44
    v_lshlrev_b32 v44, 16, v44
    v_mov_b32 v46, 0
    s_mov_b64 exec, s[50:51]
    buffer_store_dwordx2 v[44:45], v46, s[28:31], s48 offen offset:16 sc1
    s_mov_b64 exec, -1
    s_waitcnt vmcnt(27)
    v_mov_b32 v44, 0
    v_mov_b32 v45, 0
    v_lshlrev_b32 v46, 16, v172
    v_and_b32 v47, 0xffff0000, v172
    v_mul_f32 v46, v46, v32
    v_mul_f32 v47, v47, v33
    v_cvt_pk_bf16_f32 v46, v46, v47
    v_and_b32 v47, 0xffff0000, v46
    v_lshlrev_b32 v46, 16, v46
    v_add_f32 v44, v44, v47
    v_add_f32 v44, v44, v46
    v_lshlrev_b32 v46, 16, v173
    v_and_b32 v47, 0xffff0000, v173
    v_mul_f32 v46, v46, v34
    v_mul_f32 v47, v47, v35
    v_cvt_pk_bf16_f32 v46, v46, v47
    v_and_b32 v47, 0xffff0000, v46
    v_lshlrev_b32 v46, 16, v46
    v_add_f32 v44, v44, v47
    v_add_f32 v44, v44, v46
    v_lshlrev_b32 v46, 16, v174
    v_and_b32 v47, 0xffff0000, v174
    v_mul_f32 v46, v46, v36
    v_mul_f32 v47, v47, v37
    v_cvt_pk_bf16_f32 v46, v46, v47
    v_and_b32 v47, 0xffff0000, v46
    v_lshlrev_b32 v46, 16, v46
    v_add_f32 v44, v44, v47
    v_add_f32 v44, v44, v46
    v_lshlrev_b32 v46, 16, v175
    v_and_b32 v47, 0xffff0000, v175
    v_mul_f32 v46, v46, v38
    v_mul_f32 v47, v47, v39
    v_cvt_pk_bf16_f32 v46, v46, v47
    v_and_b32 v47, 0xffff0000, v46
    v_lshlrev_b32 v46, 16, v46
    v_add_f32 v44, v44, v47
    v_add_f32 v44, v44, v46
    v_lshlrev_b32 v46, 16, v176
    v_and_b32 v47, 0xffff0000, v176
    v_mul_f32 v46, v46, v40
    v_mul_f32 v47, v47, v41
    v_cvt_pk_bf16_f32 v46, v46, v47
    v_and_b32 v47, 0xffff0000, v46
    v_lshlrev_b32 v46, 16, v46
    v_add_f32 v44, v44, v47
    v_add_f32 v44, v44, v46
    v_lshlrev_b32 v46, 16, v178
    v_and_b32 v47, 0xffff0000, v178
    v_mul_f32 v46, v46, v32
    v_mul_f32 v47, v47, v33
    v_cvt_pk_bf16_f32 v46, v46, v47
    v_and_b32 v47, 0xffff0000, v46
    v_lshlrev_b32 v46, 16, v46
    v_add_f32 v45, v45, v47
    v_add_f32 v45, v45, v46
    v_lshlrev_b32 v46, 16, v179
    v_and_b32 v47, 0xffff0000, v179
    v_mul_f32 v46, v46, v34
    v_mul_f32 v47, v47, v35
    v_cvt_pk_bf16_f32 v46, v46, v47
    v_and_b32 v47, 0xffff0000, v46
    v_lshlrev_b32 v46, 16, v46
    v_add_f32 v45, v45, v47
    v_add_f32 v45, v45, v46
    v_lshlrev_b32 v46, 16, v180
    v_and_b32 v47, 0xffff0000, v180
    v_mul_f32 v46, v46, v36
    v_mul_f32 v47, v47, v37
    v_cvt_pk_bf16_f32 v46, v46, v47
    v_and_b32 v47, 0xffff0000, v46
    v_lshlrev_b32 v46, 16, v46
    v_add_f32 v45, v45, v47
    v_add_f32 v45, v45, v46
    v_lshlrev_b32 v46, 16, v181
    v_and_b32 v47, 0xffff0000, v181
    v_mul_f32 v46, v46, v38
    v_mul_f32 v47, v47, v39
    v_cvt_pk_bf16_f32 v46, v46, v47
    v_and_b32 v47, 0xffff0000, v46
    v_lshlrev_b32 v46, 16, v46
    v_add_f32 v45, v45, v47
    v_add_f32 v45, v45, v46
    v_lshlrev_b32 v46, 16, v182
    v_and_b32 v47, 0xffff0000, v182
    v_mul_f32 v46, v46, v40
    v_mul_f32 v47, v47, v41
    v_cvt_pk_bf16_f32 v46, v46, v47
    v_and_b32 v47, 0xffff0000, v46
    v_lshlrev_b32 v46, 16, v46
    v_add_f32 v45, v45, v47
    v_add_f32 v45, v45, v46
    s_nop 2
    v_add_f32_dpp v44, v44, v44 row_shr:1 row_mask:0xf bank_mask:0xf
    v_add_f32_dpp v45, v45, v45 row_shr:1 row_mask:0xf bank_mask:0xf
    s_nop 0
    v_add_f32_dpp v44, v44, v44 row_shr:2 row_mask:0xf bank_mask:0xf
    v_add_f32_dpp v45, v45, v45 row_shr:2 row_mask:0xf bank_mask:0xf
    s_nop 0
    v_add_f32_dpp v44, v44, v44 row_shr:4 row_mask:0xf bank_mask:0xf
    v_add_f32_dpp v45, v45, v45 row_shr:4 row_mask:0xf bank_mask:0xf
    s_nop 0
    v_add_f32_dpp v44, v44, v44 row_shr:8 row_mask:0xf bank_mask:0xf
    v_add_f32_dpp v45, v45, v45 row_shr:8 row_mask:0xf bank_mask:0xf
    s_nop 0
    v_add_f32_dpp v44, v44, v44 row_bcast:15 row_mask:0xa bank_mask:0xf
    v_add_f32_dpp v45, v45, v45 row_bcast:15 row_mask:0xa bank_mask:0xf
    s_nop 0
    v_add_f32_dpp v44, v44, v44 row_bcast:31 row_mask:0xc bank_mask:0xf
    v_add_f32_dpp v45, v45, v45 row_bcast:31 row_mask:0xc bank_mask:0xf
    s_nop 1
    v_cvt_pk_bf16_f32 v44, v44, v45
    v_and_b32 v45, 0xffff0000, v44
    v_lshlrev_b32 v44, 16, v44
    v_mul_f32 v44, 3216550459, v44
    v_mul_f32 v45, 3216550459, v45
    v_exp_f32 v44, v44
    v_exp_f32 v45, v45
    s_nop 0
    v_add_f32 v44, 1.0, v44
    v_add_f32 v45, 1.0, v45
    v_rcp_f32 v44, v44
    v_rcp_f32 v45, v45
    s_nop 0
    v_cvt_pk_bf16_f32 v44, v44, v45
    v_and_b32 v45, 0xffff0000, v44
    v_lshlrev_b32 v44, 16, v44
    v_mov_b32 v46, 0
    s_mov_b64 exec, s[50:51]
    buffer_store_dwordx2 v[44:45], v46, s[28:31], s48 offen offset:24 sc1
    s_mov_b64 exec, -1
    s_waitcnt vmcnt(22)
    v_mov_b32 v44, 0
    v_mov_b32 v45, 0
    v_lshlrev_b32 v46, 16, v184
    v_and_b32 v47, 0xffff0000, v184
    v_mul_f32 v46, v46, v32
    v_mul_f32 v47, v47, v33
    v_cvt_pk_bf16_f32 v46, v46, v47
    v_and_b32 v47, 0xffff0000, v46
    v_lshlrev_b32 v46, 16, v46
    v_add_f32 v44, v44, v47
    v_add_f32 v44, v44, v46
    v_lshlrev_b32 v46, 16, v185
    v_and_b32 v47, 0xffff0000, v185
    v_mul_f32 v46, v46, v34
    v_mul_f32 v47, v47, v35
    v_cvt_pk_bf16_f32 v46, v46, v47
    v_and_b32 v47, 0xffff0000, v46
    v_lshlrev_b32 v46, 16, v46
    v_add_f32 v44, v44, v47
    v_add_f32 v44, v44, v46
    v_lshlrev_b32 v46, 16, v186
    v_and_b32 v47, 0xffff0000, v186
    v_mul_f32 v46, v46, v36
    v_mul_f32 v47, v47, v37
    v_cvt_pk_bf16_f32 v46, v46, v47
    v_and_b32 v47, 0xffff0000, v46
    v_lshlrev_b32 v46, 16, v46
    v_add_f32 v44, v44, v47
    v_add_f32 v44, v44, v46
    v_lshlrev_b32 v46, 16, v187
    v_and_b32 v47, 0xffff0000, v187
    v_mul_f32 v46, v46, v38
    v_mul_f32 v47, v47, v39
    v_cvt_pk_bf16_f32 v46, v46, v47
    v_and_b32 v47, 0xffff0000, v46
    v_lshlrev_b32 v46, 16, v46
    v_add_f32 v44, v44, v47
    v_add_f32 v44, v44, v46
    v_lshlrev_b32 v46, 16, v188
    v_and_b32 v47, 0xffff0000, v188
    v_mul_f32 v46, v46, v40
    v_mul_f32 v47, v47, v41
    v_cvt_pk_bf16_f32 v46, v46, v47
    v_and_b32 v47, 0xffff0000, v46
    v_lshlrev_b32 v46, 16, v46
    v_add_f32 v44, v44, v47
    v_add_f32 v44, v44, v46
    v_lshlrev_b32 v46, 16, v190
    v_and_b32 v47, 0xffff0000, v190
    v_mul_f32 v46, v46, v32
    v_mul_f32 v47, v47, v33
    v_cvt_pk_bf16_f32 v46, v46, v47
    v_and_b32 v47, 0xffff0000, v46
    v_lshlrev_b32 v46, 16, v46
    v_add_f32 v45, v45, v47
    v_add_f32 v45, v45, v46
    v_lshlrev_b32 v46, 16, v191
    v_and_b32 v47, 0xffff0000, v191
    v_mul_f32 v46, v46, v34
    v_mul_f32 v47, v47, v35
    v_cvt_pk_bf16_f32 v46, v46, v47
    v_and_b32 v47, 0xffff0000, v46
    v_lshlrev_b32 v46, 16, v46
    v_add_f32 v45, v45, v47
    v_add_f32 v45, v45, v46
    v_lshlrev_b32 v46, 16, v192
    v_and_b32 v47, 0xffff0000, v192
    v_mul_f32 v46, v46, v36
    v_mul_f32 v47, v47, v37
    v_cvt_pk_bf16_f32 v46, v46, v47
    v_and_b32 v47, 0xffff0000, v46
    v_lshlrev_b32 v46, 16, v46
    v_add_f32 v45, v45, v47
    v_add_f32 v45, v45, v46
    v_lshlrev_b32 v46, 16, v193
    v_and_b32 v47, 0xffff0000, v193
    v_mul_f32 v46, v46, v38
    v_mul_f32 v47, v47, v39
    v_cvt_pk_bf16_f32 v46, v46, v47
    v_and_b32 v47, 0xffff0000, v46
    v_lshlrev_b32 v46, 16, v46
    v_add_f32 v45, v45, v47
    v_add_f32 v45, v45, v46
    v_lshlrev_b32 v46, 16, v194
    v_and_b32 v47, 0xffff0000, v194
    v_mul_f32 v46, v46, v40
    v_mul_f32 v47, v47, v41
    v_cvt_pk_bf16_f32 v46, v46, v47
    v_and_b32 v47, 0xffff0000, v46
    v_lshlrev_b32 v46, 16, v46
    v_add_f32 v45, v45, v47
    v_add_f32 v45, v45, v46
    s_nop 2
    v_add_f32_dpp v44, v44, v44 row_shr:1 row_mask:0xf bank_mask:0xf
    v_add_f32_dpp v45, v45, v45 row_shr:1 row_mask:0xf bank_mask:0xf
    s_nop 0
    v_add_f32_dpp v44, v44, v44 row_shr:2 row_mask:0xf bank_mask:0xf
    v_add_f32_dpp v45, v45, v45 row_shr:2 row_mask:0xf bank_mask:0xf
    s_nop 0
    v_add_f32_dpp v44, v44, v44 row_shr:4 row_mask:0xf bank_mask:0xf
    v_add_f32_dpp v45, v45, v45 row_shr:4 row_mask:0xf bank_mask:0xf
    s_nop 0
    v_add_f32_dpp v44, v44, v44 row_shr:8 row_mask:0xf bank_mask:0xf
    v_add_f32_dpp v45, v45, v45 row_shr:8 row_mask:0xf bank_mask:0xf
    s_nop 0
    v_add_f32_dpp v44, v44, v44 row_bcast:15 row_mask:0xa bank_mask:0xf
    v_add_f32_dpp v45, v45, v45 row_bcast:15 row_mask:0xa bank_mask:0xf
    s_nop 0
    v_add_f32_dpp v44, v44, v44 row_bcast:31 row_mask:0xc bank_mask:0xf
    v_add_f32_dpp v45, v45, v45 row_bcast:31 row_mask:0xc bank_mask:0xf
    s_nop 1
    v_cvt_pk_bf16_f32 v44, v44, v45
    v_and_b32 v45, 0xffff0000, v44
    v_lshlrev_b32 v44, 16, v44
    v_mul_f32 v44, 3216550459, v44
    v_mul_f32 v45, 3216550459, v45
    v_exp_f32 v44, v44
    v_exp_f32 v45, v45
    s_nop 0
    v_add_f32 v44, 1.0, v44
    v_add_f32 v45, 1.0, v45
    v_rcp_f32 v44, v44
    v_rcp_f32 v45, v45
    s_nop 0
    v_cvt_pk_bf16_f32 v44, v44, v45
    v_and_b32 v45, 0xffff0000, v44
    v_lshlrev_b32 v44, 16, v44
    v_mov_b32 v46, 0
    s_mov_b64 exec, s[50:51]
    buffer_store_dwordx2 v[44:45], v46, s[28:31], s48 offen offset:32 sc1
    s_mov_b64 exec, -1
    s_waitcnt vmcnt(17)
    v_mov_b32 v44, 0
    v_mov_b32 v45, 0
    v_lshlrev_b32 v46, 16, v196
    v_and_b32 v47, 0xffff0000, v196
    v_mul_f32 v46, v46, v32
    v_mul_f32 v47, v47, v33
    v_cvt_pk_bf16_f32 v46, v46, v47
    v_and_b32 v47, 0xffff0000, v46
    v_lshlrev_b32 v46, 16, v46
    v_add_f32 v44, v44, v47
    v_add_f32 v44, v44, v46
    v_lshlrev_b32 v46, 16, v197
    v_and_b32 v47, 0xffff0000, v197
    v_mul_f32 v46, v46, v34
    v_mul_f32 v47, v47, v35
    v_cvt_pk_bf16_f32 v46, v46, v47
    v_and_b32 v47, 0xffff0000, v46
    v_lshlrev_b32 v46, 16, v46
    v_add_f32 v44, v44, v47
    v_add_f32 v44, v44, v46
    v_lshlrev_b32 v46, 16, v198
    v_and_b32 v47, 0xffff0000, v198
    v_mul_f32 v46, v46, v36
    v_mul_f32 v47, v47, v37
    v_cvt_pk_bf16_f32 v46, v46, v47
    v_and_b32 v47, 0xffff0000, v46
    v_lshlrev_b32 v46, 16, v46
    v_add_f32 v44, v44, v47
    v_add_f32 v44, v44, v46
    v_lshlrev_b32 v46, 16, v199
    v_and_b32 v47, 0xffff0000, v199
    v_mul_f32 v46, v46, v38
    v_mul_f32 v47, v47, v39
    v_cvt_pk_bf16_f32 v46, v46, v47
    v_and_b32 v47, 0xffff0000, v46
    v_lshlrev_b32 v46, 16, v46
    v_add_f32 v44, v44, v47
    v_add_f32 v44, v44, v46
    v_lshlrev_b32 v46, 16, v200
    v_and_b32 v47, 0xffff0000, v200
    v_mul_f32 v46, v46, v40
    v_mul_f32 v47, v47, v41
    v_cvt_pk_bf16_f32 v46, v46, v47
    v_and_b32 v47, 0xffff0000, v46
    v_lshlrev_b32 v46, 16, v46
    v_add_f32 v44, v44, v47
    v_add_f32 v44, v44, v46
    v_lshlrev_b32 v46, 16, v202
    v_and_b32 v47, 0xffff0000, v202
    v_mul_f32 v46, v46, v32
    v_mul_f32 v47, v47, v33
    v_cvt_pk_bf16_f32 v46, v46, v47
    v_and_b32 v47, 0xffff0000, v46
    v_lshlrev_b32 v46, 16, v46
    v_add_f32 v45, v45, v47
    v_add_f32 v45, v45, v46
    v_lshlrev_b32 v46, 16, v203
    v_and_b32 v47, 0xffff0000, v203
    v_mul_f32 v46, v46, v34
    v_mul_f32 v47, v47, v35
    v_cvt_pk_bf16_f32 v46, v46, v47
    v_and_b32 v47, 0xffff0000, v46
    v_lshlrev_b32 v46, 16, v46
    v_add_f32 v45, v45, v47
    v_add_f32 v45, v45, v46
    v_lshlrev_b32 v46, 16, v204
    v_and_b32 v47, 0xffff0000, v204
    v_mul_f32 v46, v46, v36
    v_mul_f32 v47, v47, v37
    v_cvt_pk_bf16_f32 v46, v46, v47
    v_and_b32 v47, 0xffff0000, v46
    v_lshlrev_b32 v46, 16, v46
    v_add_f32 v45, v45, v47
    v_add_f32 v45, v45, v46
    v_lshlrev_b32 v46, 16, v205
    v_and_b32 v47, 0xffff0000, v205
    v_mul_f32 v46, v46, v38
    v_mul_f32 v47, v47, v39
    v_cvt_pk_bf16_f32 v46, v46, v47
    v_and_b32 v47, 0xffff0000, v46
    v_lshlrev_b32 v46, 16, v46
    v_add_f32 v45, v45, v47
    v_add_f32 v45, v45, v46
    v_lshlrev_b32 v46, 16, v206
    v_and_b32 v47, 0xffff0000, v206
    v_mul_f32 v46, v46, v40
    v_mul_f32 v47, v47, v41
    v_cvt_pk_bf16_f32 v46, v46, v47
    v_and_b32 v47, 0xffff0000, v46
    v_lshlrev_b32 v46, 16, v46
    v_add_f32 v45, v45, v47
    v_add_f32 v45, v45, v46
    s_nop 2
    v_add_f32_dpp v44, v44, v44 row_shr:1 row_mask:0xf bank_mask:0xf
    v_add_f32_dpp v45, v45, v45 row_shr:1 row_mask:0xf bank_mask:0xf
    s_nop 0
    v_add_f32_dpp v44, v44, v44 row_shr:2 row_mask:0xf bank_mask:0xf
    v_add_f32_dpp v45, v45, v45 row_shr:2 row_mask:0xf bank_mask:0xf
    s_nop 0
    v_add_f32_dpp v44, v44, v44 row_shr:4 row_mask:0xf bank_mask:0xf
    v_add_f32_dpp v45, v45, v45 row_shr:4 row_mask:0xf bank_mask:0xf
    s_nop 0
    v_add_f32_dpp v44, v44, v44 row_shr:8 row_mask:0xf bank_mask:0xf
    v_add_f32_dpp v45, v45, v45 row_shr:8 row_mask:0xf bank_mask:0xf
    s_nop 0
    v_add_f32_dpp v44, v44, v44 row_bcast:15 row_mask:0xa bank_mask:0xf
    v_add_f32_dpp v45, v45, v45 row_bcast:15 row_mask:0xa bank_mask:0xf
    s_nop 0
    v_add_f32_dpp v44, v44, v44 row_bcast:31 row_mask:0xc bank_mask:0xf
    v_add_f32_dpp v45, v45, v45 row_bcast:31 row_mask:0xc bank_mask:0xf
    s_nop 1
    v_cvt_pk_bf16_f32 v44, v44, v45
    v_and_b32 v45, 0xffff0000, v44
    v_lshlrev_b32 v44, 16, v44
    v_mul_f32 v44, 3216550459, v44
    v_mul_f32 v45, 3216550459, v45
    v_exp_f32 v44, v44
    v_exp_f32 v45, v45
    s_nop 0
    v_add_f32 v44, 1.0, v44
    v_add_f32 v45, 1.0, v45
    v_rcp_f32 v44, v44
    v_rcp_f32 v45, v45
    s_nop 0
    v_cvt_pk_bf16_f32 v44, v44, v45
    v_and_b32 v45, 0xffff0000, v44
    v_lshlrev_b32 v44, 16, v44
    v_mov_b32 v46, 0
    s_mov_b64 exec, s[50:51]
    buffer_store_dwordx2 v[44:45], v46, s[28:31], s48 offen offset:40 sc1
    s_mov_b64 exec, -1
    s_waitcnt vmcnt(12)
    v_mov_b32 v44, 0
    v_mov_b32 v45, 0
    v_lshlrev_b32 v46, 16, v208
    v_and_b32 v47, 0xffff0000, v208
    v_mul_f32 v46, v46, v32
    v_mul_f32 v47, v47, v33
    v_cvt_pk_bf16_f32 v46, v46, v47
    v_and_b32 v47, 0xffff0000, v46
    v_lshlrev_b32 v46, 16, v46
    v_add_f32 v44, v44, v47
    v_add_f32 v44, v44, v46
    v_lshlrev_b32 v46, 16, v209
    v_and_b32 v47, 0xffff0000, v209
    v_mul_f32 v46, v46, v34
    v_mul_f32 v47, v47, v35
    v_cvt_pk_bf16_f32 v46, v46, v47
    v_and_b32 v47, 0xffff0000, v46
    v_lshlrev_b32 v46, 16, v46
    v_add_f32 v44, v44, v47
    v_add_f32 v44, v44, v46
    v_lshlrev_b32 v46, 16, v210
    v_and_b32 v47, 0xffff0000, v210
    v_mul_f32 v46, v46, v36
    v_mul_f32 v47, v47, v37
    v_cvt_pk_bf16_f32 v46, v46, v47
    v_and_b32 v47, 0xffff0000, v46
    v_lshlrev_b32 v46, 16, v46
    v_add_f32 v44, v44, v47
    v_add_f32 v44, v44, v46
    v_lshlrev_b32 v46, 16, v211
    v_and_b32 v47, 0xffff0000, v211
    v_mul_f32 v46, v46, v38
    v_mul_f32 v47, v47, v39
    v_cvt_pk_bf16_f32 v46, v46, v47
    v_and_b32 v47, 0xffff0000, v46
    v_lshlrev_b32 v46, 16, v46
    v_add_f32 v44, v44, v47
    v_add_f32 v44, v44, v46
    v_lshlrev_b32 v46, 16, v212
    v_and_b32 v47, 0xffff0000, v212
    v_mul_f32 v46, v46, v40
    v_mul_f32 v47, v47, v41
    v_cvt_pk_bf16_f32 v46, v46, v47
    v_and_b32 v47, 0xffff0000, v46
    v_lshlrev_b32 v46, 16, v46
    v_add_f32 v44, v44, v47
    v_add_f32 v44, v44, v46
    v_lshlrev_b32 v46, 16, v214
    v_and_b32 v47, 0xffff0000, v214
    v_mul_f32 v46, v46, v32
    v_mul_f32 v47, v47, v33
    v_cvt_pk_bf16_f32 v46, v46, v47
    v_and_b32 v47, 0xffff0000, v46
    v_lshlrev_b32 v46, 16, v46
    v_add_f32 v45, v45, v47
    v_add_f32 v45, v45, v46
    v_lshlrev_b32 v46, 16, v215
    v_and_b32 v47, 0xffff0000, v215
    v_mul_f32 v46, v46, v34
    v_mul_f32 v47, v47, v35
    v_cvt_pk_bf16_f32 v46, v46, v47
    v_and_b32 v47, 0xffff0000, v46
    v_lshlrev_b32 v46, 16, v46
    v_add_f32 v45, v45, v47
    v_add_f32 v45, v45, v46
    v_lshlrev_b32 v46, 16, v216
    v_and_b32 v47, 0xffff0000, v216
    v_mul_f32 v46, v46, v36
    v_mul_f32 v47, v47, v37
    v_cvt_pk_bf16_f32 v46, v46, v47
    v_and_b32 v47, 0xffff0000, v46
    v_lshlrev_b32 v46, 16, v46
    v_add_f32 v45, v45, v47
    v_add_f32 v45, v45, v46
    v_lshlrev_b32 v46, 16, v217
    v_and_b32 v47, 0xffff0000, v217
    v_mul_f32 v46, v46, v38
    v_mul_f32 v47, v47, v39
    v_cvt_pk_bf16_f32 v46, v46, v47
    v_and_b32 v47, 0xffff0000, v46
    v_lshlrev_b32 v46, 16, v46
    v_add_f32 v45, v45, v47
    v_add_f32 v45, v45, v46
    v_lshlrev_b32 v46, 16, v218
    v_and_b32 v47, 0xffff0000, v218
    v_mul_f32 v46, v46, v40
    v_mul_f32 v47, v47, v41
    v_cvt_pk_bf16_f32 v46, v46, v47
    v_and_b32 v47, 0xffff0000, v46
    v_lshlrev_b32 v46, 16, v46
    v_add_f32 v45, v45, v47
    v_add_f32 v45, v45, v46
    s_nop 2
    v_add_f32_dpp v44, v44, v44 row_shr:1 row_mask:0xf bank_mask:0xf
    v_add_f32_dpp v45, v45, v45 row_shr:1 row_mask:0xf bank_mask:0xf
    s_branch PADX_11
PAD_11:
    s_branch PAD_END
PADX_11:
    s_nop 0
    v_add_f32_dpp v44, v44, v44 row_shr:2 row_mask:0xf bank_mask:0xf
    v_add_f32_dpp v45, v45, v45 row_shr:2 row_mask:0xf bank_mask:0xf
    s_nop 0
    v_add_f32_dpp v44, v44, v44 row_shr:4 row_mask:0xf bank_mask:0xf
    v_add_f32_dpp v45, v45, v45 row_shr:4 row_mask:0xf bank_mask:0xf
    s_nop 0
    v_add_f32_dpp v44, v44, v44 row_shr:8 row_mask:0xf bank_mask:0xf
    v_add_f32_dpp v45, v45, v45 row_shr:8 row_mask:0xf bank_mask:0xf
    s_nop 0
    v_add_f32_dpp v44, v44, v44 row_bcast:15 row_mask:0xa bank_mask:0xf
    v_add_f32_dpp v45, v45, v45 row_bcast:15 row_mask:0xa bank_mask:0xf
    s_nop 0
    v_add_f32_dpp v44, v44, v44 row_bcast:31 row_mask:0xc bank_mask:0xf
    v_add_f32_dpp v45, v45, v45 row_bcast:31 row_mask:0xc bank_mask:0xf
    s_nop 1
    v_cvt_pk_bf16_f32 v44, v44, v45
    v_and_b32 v45, 0xffff0000, v44
    v_lshlrev_b32 v44, 16, v44
    v_mul_f32 v44, 3216550459, v44
    v_mul_f32 v45, 3216550459, v45
    v_exp_f32 v44, v44
    v_exp_f32 v45, v45
    s_nop 0
    v_add_f32 v44, 1.0, v44
    v_add_f32 v45, 1.0, v45
    v_rcp_f32 v44, v44
    v_rcp_f32 v45, v45
    s_nop 0
    v_cvt_pk_bf16_f32 v44, v44, v45
    v_and_b32 v45, 0xffff0000, v44
    v_lshlrev_b32 v44, 16, v44
    v_mov_b32 v46, 0
    s_mov_b64 exec, s[50:51]
    buffer_store_dwordx2 v[44:45], v46, s[28:31], s48 offen offset:48 sc1
    s_mov_b64 exec, -1
    s_waitcnt vmcnt(7)
    v_mov_b32 v44, 0
    v_mov_b32 v45, 0
    v_lshlrev_b32 v46, 16, v220
    v_and_b32 v47, 0xffff0000, v220
    v_mul_f32 v46, v46, v32
    v_mul_f32 v47, v47, v33
    v_cvt_pk_bf16_f32 v46, v46, v47
    v_and_b32 v47, 0xffff0000, v46
    v_lshlrev_b32 v46, 16, v46
    v_add_f32 v44, v44, v47
    v_add_f32 v44, v44, v46
    v_lshlrev_b32 v46, 16, v221
    v_and_b32 v47, 0xffff0000, v221
    v_mul_f32 v46, v46, v34
    v_mul_f32 v47, v47, v35
    v_cvt_pk_bf16_f32 v46, v46, v47
    v_and_b32 v47, 0xffff0000, v46
    v_lshlrev_b32 v46, 16, v46
    v_add_f32 v44, v44, v47
    v_add_f32 v44, v44, v46
    v_lshlrev_b32 v46, 16, v222
    v_and_b32 v47, 0xffff0000, v222
    v_mul_f32 v46, v46, v36
    v_mul_f32 v47, v47, v37
    v_cvt_pk_bf16_f32 v46, v46, v47
    v_and_b32 v47, 0xffff0000, v46
    v_lshlrev_b32 v46, 16, v46
    v_add_f32 v44, v44, v47
    v_add_f32 v44, v44, v46
    v_lshlrev_b32 v46, 16, v223
    v_and_b32 v47, 0xffff0000, v223
    v_mul_f32 v46, v46, v38
    v_mul_f32 v47, v47, v39
    v_cvt_pk_bf16_f32 v46, v46, v47
    v_and_b32 v47, 0xffff0000, v46
    v_lshlrev_b32 v46, 16, v46
    v_add_f32 v44, v44, v47
    v_add_f32 v44, v44, v46
    v_lshlrev_b32 v46, 16, v224
    v_and_b32 v47, 0xffff0000, v224
    v_mul_f32 v46, v46, v40
    v_mul_f32 v47, v47, v41
    v_cvt_pk_bf16_f32 v46, v46, v47
    v_and_b32 v47, 0xffff0000, v46
    v_lshlrev_b32 v46, 16, v46
    v_add_f32 v44, v44, v47
    v_add_f32 v44, v44, v46
    v_lshlrev_b32 v46, 16, v226
    v_and_b32 v47, 0xffff0000, v226
    v_mul_f32 v46, v46, v32
    v_mul_f32 v47, v47, v33
    v_cvt_pk_bf16_f32 v46, v46, v47
    v_and_b32 v47, 0xffff0000, v46
    v_lshlrev_b32 v46, 16, v46
    v_add_f32 v45, v45, v47
    v_add_f32 v45, v45, v46
    v_lshlrev_b32 v46, 16, v227
    v_and_b32 v47, 0xffff0000, v227
    v_mul_f32 v46, v46, v34
    v_mul_f32 v47, v47, v35
    v_cvt_pk_bf16_f32 v46, v46, v47
    v_and_b32 v47, 0xffff0000, v46
    v_lshlrev_b32 v46, 16, v46
    v_add_f32 v45, v45, v47
    v_add_f32 v45, v45, v46
    v_lshlrev_b32 v46, 16, v228
    v_and_b32 v47, 0xffff0000, v228
    v_mul_f32 v46, v46, v36
    v_mul_f32 v47, v47, v37
    v_cvt_pk_bf16_f32 v46, v46, v47
    v_and_b32 v47, 0xffff0000, v46
    v_lshlrev_b32 v46, 16, v46
    v_add_f32 v45, v45, v47
    v_add_f32 v45, v45, v46
    v_lshlrev_b32 v46, 16, v229
    v_and_b32 v47, 0xffff0000, v229
    v_mul_f32 v46, v46, v38
    v_mul_f32 v47, v47, v39
    v_cvt_pk_bf16_f32 v46, v46, v47
    v_and_b32 v47, 0xffff0000, v46
    v_lshlrev_b32 v46, 16, v46
    v_add_f32 v45, v45, v47
    v_add_f32 v45, v45, v46
    v_lshlrev_b32 v46, 16, v230
    v_and_b32 v47, 0xffff0000, v230
    v_mul_f32 v46, v46, v40
    v_mul_f32 v47, v47, v41
    v_cvt_pk_bf16_f32 v46, v46, v47
    v_and_b32 v47, 0xffff0000, v46
    v_lshlrev_b32 v46, 16, v46
    v_add_f32 v45, v45, v47
    v_add_f32 v45, v45, v46
    s_nop 2
    v_add_f32_dpp v44, v44, v44 row_shr:1 row_mask:0xf bank_mask:0xf
    v_add_f32_dpp v45, v45, v45 row_shr:1 row_mask:0xf bank_mask:0xf
    s_nop 0
    v_add_f32_dpp v44, v44, v44 row_shr:2 row_mask:0xf bank_mask:0xf
    v_add_f32_dpp v45, v45, v45 row_shr:2 row_mask:0xf bank_mask:0xf
    s_nop 0
    v_add_f32_dpp v44, v44, v44 row_shr:4 row_mask:0xf bank_mask:0xf
    v_add_f32_dpp v45, v45, v45 row_shr:4 row_mask:0xf bank_mask:0xf
    s_nop 0
    v_add_f32_dpp v44, v44, v44 row_shr:8 row_mask:0xf bank_mask:0xf
    v_add_f32_dpp v45, v45, v45 row_shr:8 row_mask:0xf bank_mask:0xf
    s_nop 0
    v_add_f32_dpp v44, v44, v44 row_bcast:15 row_mask:0xa bank_mask:0xf
    v_add_f32_dpp v45, v45, v45 row_bcast:15 row_mask:0xa bank_mask:0xf
    s_nop 0
    v_add_f32_dpp v44, v44, v44 row_bcast:31 row_mask:0xc bank_mask:0xf
    v_add_f32_dpp v45, v45, v45 row_bcast:31 row_mask:0xc bank_mask:0xf
    s_nop 1
    v_cvt_pk_bf16_f32 v44, v44, v45
    v_and_b32 v45, 0xffff0000, v44
    v_lshlrev_b32 v44, 16, v44
    v_mul_f32 v44, 3216550459, v44
    v_mul_f32 v45, 3216550459, v45
    v_exp_f32 v44, v44
    v_exp_f32 v45, v45
    s_nop 0
    v_add_f32 v44, 1.0, v44
    v_add_f32 v45, 1.0, v45
    v_rcp_f32 v44, v44
    v_rcp_f32 v45, v45
    s_nop 0
    v_cvt_pk_bf16_f32 v44, v44, v45
    v_and_b32 v45, 0xffff0000, v44
    v_lshlrev_b32 v44, 16, v44
    v_mov_b32 v46, 0
    s_mov_b64 exec, s[50:51]
    buffer_store_dwordx2 v[44:45], v46, s[28:31], s48 offen offset:56 sc1
    s_mov_b64 exec, -1
    s_lshl_b32 s3, s24, 1
    s_add_u32 s3, s3, 256
    v_add_u32 v24, s3, v1
    v_mov_b32 v26, 0
    v_lshlrev_b32 v24, 8, v24
    v_mov_b32 v25, 1
    s_cmp_lg_u32 s38, 0
    s_cbranch_scc1 K_SP0
    s_mov_b32 s46, 0
K_FP:
    buffer_load_dword v19, v26, s[80:83], 0 offen sc1
    s_add_u32 s46, s46, 1
    s_waitcnt vmcnt(0)
    v_readfirstlane_b32 s3, v19
    s_cmp_lg_u32 s3, 0
    s_cbranch_scc1 K_FP_OK
    s_sleep 8
    s_cmp_lt_u32 s46, 0x20000
    s_cbranch_scc1 K_FP
K_FP_OK:
K_SP0:
    s_waitcnt vmcnt(0)
    s_barrier
    s_cmp_ge_u32 s38, 4
    s_cbranch_scc1 K_SP2
    s_cmp_lg_u32 s38, 0
    s_cbranch_scc1 K_SP1
    s_mov_b64 exec, 3
    buffer_atomic_add v25, v24, s[52:55], 0 offen
    s_mov_b64 exec, -1
K_SP1:
    v_lshlrev_b32 v1, 4, v1
    s_and_b32 s3, s2, 7
    s_lshl_b32 s3, s3, 2
    s_bfe_u32 s36, s2, 0x20003
    s_add_u32 s36, s3, s36
    s_bfe_u32 s3, s2, 0x10005
    s_lshl_b32 s3, s3, 2
    s_lshr_b32 s37, s2, 6
    s_add_u32 s37, s37, s3
    s_add_u32 s20, s8, 20971520
    s_addc_u32 s21, s9, 0
    s_and_b32 s21, s21, 0xffff
    s_mov_b32 s22, 2621440
    s_mov_b32 s23, 0x00020000
    s_mov_b32 s39, 0
    s_mul_i32 s3, s38, 3072
    s_add_u32 s3, s3, 147456
    v_add_u32 v11, s3, v1
    v_bfe_u32 v4, v1, 4, 5
    v_lshrrev_b32 v5, 9, v1
    v_lshlrev_b32 v2, 3, v4
    v_lshl_add_u32 v12, v5, 8, v2
    v_add_u32 v2, 9472, v2
    v_mov_b32 v3, 9728
    v_cmp_eq_u32 vcc, 0, v5
    v_mul_u32_u24 v0, 320, v5
    v_cndmask_b32 v13, v3, v2, vcc
    v_lshl_add_u32 v2, v4, 4, v0
    v_cmp_gt_u32 vcc, 20, v4
    v_add_u32 v14, 8192, v2
    v_add_u32 v15, 8832, v2
    v_min_u32 v3, 21, v4
    v_lshlrev_b32 v3, 4, v3
    v_add_u32 v3, 9424, v3
    v_cndmask_b32 v14, v3, v14, vcc
    v_cndmask_b32 v15, v3, v15, vcc
    v_mov_b32 v96, 0
    v_mov_b32 v97, 0
    v_mov_b32 v98, 0
    v_mov_b32 v99, 0
    v_mov_b32 v100, 0
    v_mov_b32 v101, 0
    v_mov_b32 v102, 0
    v_mov_b32 v103, 0
    v_mov_b32 v104, 0
    v_mov_b32 v105, 0
    v_mov_b32 v106, 0
    v_mov_b32 v107, 0
    v_mov_b32 v108, 0
    v_mov_b32 v109, 0
    v_mov_b32 v110, 0
    v_mov_b32 v111, 0
    v_mov_b32 v112, 0
    v_mov_b32 v113, 0
    v_mov_b32 v114, 0
    v_mov_b32 v115, 0
    v_mov_b32 v116, 0
    v_mov_b32 v117, 0
    v_mov_b32 v118, 0
    v_mov_b32 v119, 0
    v_mov_b32 v120, 0
    v_mov_b32 v121, 0
    v_mov_b32 v122, 0
    v_mov_b32 v123, 0
    v_mov_b32 v124, 0
    v_mov_b32 v125, 0
    v_mov_b32 v126, 0
    v_mov_b32 v127, 0
    v_mov_b32 v132, 0
    v_mov_b32 v133, 0
    v_mov_b32 v134, 0
    v_mov_b32 v135, 0
    v_mov_b32 v52, 0
    v_mov_b32 v53, 0
    v_mov_b32 v54, 0
    v_mov_b32 v55, 0
    v_mov_b32 v60, 0
    v_mov_b32 v61, 0
    v_mov_b32 v62, 0
    v_mov_b32 v63, 0
    s_setprio 2
    s_branch A_B1
K_SP2:
    s_sub_u32 s38, s38, 4
    s_mov_b32 s39, 0
    s_mov_b32 s85, 0
    s_lshr_b32 s7, s2, 6
    s_lshl_b32 s7, s7, 2
    s_bfe_u32 s20, s2, 0x20001
    s_add_u32 s7, s7, s20
    s_bfe_u32 s20, s2, 0x10005
    s_lshl_b32 s20, s20, 4
    s_add_u32 s4, s7, s20
    s_and_b32 s7, s2, 1
    s_lshl_b32 s7, s7, 2
    s_bfe_u32 s20, s2, 0x20003
    s_add_u32 s5, s7, s20
    v_lshrrev_b32 v22, 4, v1
    v_and_b32 v23, 15, v1
    s_lshl_b32 s6, s4, 2
    s_add_u32 s6, s6, s38
    s_lshl_b32 s3, s6, 6
    v_lshl_add_u32 v255, v23, 2, s3
    s_mul_i32 s6, s6, 20480
    s_mul_i32 s3, s5, 160
    s_add_u32 s3, s3, s6
    v_mul_u32_u24 v2, 1280, v23
    v_add_u32 v2, s3, v2
    v_lshl_add_u32 v253, v22, 3, v2
    v_and_b32 v3, 1, v22
    v_lshl_add_u32 v2, v3, 5, v2
    v_lshrrev_b32 v3, 1, v22
    v_lshl_add_u32 v252, v3, 4, v2
    s_mov_b32 s3, 54272
    v_lshlrev_b32 v2, 3, v22
    v_lshrrev_b32 v3, 2, v23
    v_add_u32 v2, v2, v3
    v_mul_u32_u24 v2, 160, v2
    v_and_b32 v3, 3, v23
    v_lshlrev_b32 v3, 3, v3
    v_add3_u32 v2, v2, v3, s3
    v_and_b32 v3, 1, v22
    v_mul_u32_u24 v3, 640, v3
    v_add_u32 v245, v2, v3
    v_sub_u32 v2, v2, v3
    v_add_u32 v246, 640, v2
    v_add_u32 v247, 61440, v245
    v_add_u32 v248, 61440, v246
    s_mul_i32 s3, s38, 2560
    s_add_u32 s3, s3, 146432
    v_lshl_add_u32 v249, v1, 3, s3
    s_mul_i32 s3, s38, 10240
    s_add_u32 s3, s3, 5120
    v_lshl_add_u32 v254, v1, 4, s3
H_POST:
    s_and_b32 s3, s2, 7
    s_lshl_b32 s3, s3, 2
    s_bfe_u32 s36, s2, 0x20003
    s_add_u32 s36, s3, s36
    s_bfe_u32 s3, s2, 0x10005
    s_lshl_b32 s3, s3, 2
    s_lshr_b32 s37, s2, 6
    s_add_u32 s37, s37, s3
    s_mul_i32 s58, s38, 5376
    s_mul_i32 s49, s36, 172032
    s_add_u32 s59, s49, s58
    s_mov_b32 s44, s59
    s_add_u32 s28, s8, 41943040
    s_addc_u32 s29, s9, 0
    s_and_b32 s29, s29, 0xffff
    s_mov_b32 s30, 139264
    s_mov_b32 s31, 0x00020000
    s_lshl_b32 s3, s36, 11
    s_add_u32 s3, s3, 73728
    v_lshl_add_u32 v145, v1, 8, s3
    s_bitcmp1_b32 0x02081040, s36
    s_cselect_b32 s62, 8, 4
    v_mov_b32 v146, s62
    v_writelane_b32 v146, 16, 8
    s_lshl_b32 s62, s62, 15
    s_mov_b32 s63, s37
    s_lshr_b32 s60, s2, 6
    s_lshl_b32 s60, s60, 2
    s_bfe_u32 s61, s2, 0x20001
    s_add_u32 s60, s60, s61
    s_bfe_u32 s61, s2, 0x10005
    s_lshl_b32 s61, s61, 4
    s_add_u32 s50, s60, s61
    s_and_b32 s60, s2, 1
    s_lshl_b32 s60, s60, 2
    s_bfe_u32 s61, s2, 0x20003
    s_add_u32 s51, s60, s61
    s_lshl_b32 s3, s50, 8
    s_add_u32 s3, s3, 65536
    v_writelane_b32 v145, s3, 8
    v_mov_b32 v147, 0
    v_lshlrev_b32 v16, 4, v1
    v_add_u32 v13, 4096, v16
    s_add_u32 s12, s8, 4194304
    s_addc_u32 s13, s9, 0
    s_and_b32 s13, s13, 0xffff
    s_mov_b32 s14, 5505024
    s_mov_b32 s15, 0x00020000
    s_add_u32 s64, s8, 0
    s_addc_u32 s65, s9, 0
    s_and_b32 s65, s65, 0xffff
    s_mov_b32 s66, 2621440
    s_mov_b32 s67, 0x00020000
    v_and_b32 v17, 31, v1
    v_lshrrev_b32 v18, 5, v1
    s_lshl_b32 s3, s37, 3
    s_lshl_b32 s48, s38, 1
    s_add_u32 s3, s3, s48
    s_mul_i32 s3, s3, 1280
    s_mul_i32 s48, s36, 81920
    s_add_u32 s48, s48, s3
    v_lshlrev_b32 v4, 3, v17
    v_lshl_add_u32 v5, v18, 8, v4
    v_add_u32 v2, 9472, v4
    v_mov_b32 v3, 9728
    v_cmp_eq_u32 vcc, 0, v18
    s_nop 1
    v_cndmask_b32 v6, v3, v2, vcc
    s_mov_b32 s52, s42
    s_and_b32 s53, s43, 0xffff
    s_mov_b32 s54, 819200
    s_mov_b32 s55, 0x00020000
    s_mov_b32 s16, s40
    s_and_b32 s17, s41, 0xffff
    s_mov_b32 s18, 2211840
    s_mov_b32 s19, 0x00020000
    s_add_u32 s24, s8, 12582912
    s_addc_u32 s25, s9, 0
    s_and_b32 s25, s25, 0xffff
    s_mov_b32 s26, 7077888
    s_mov_b32 s27, 0x00020000
    s_cmp_eq_u32 s38, 0
    s_cselect_b32 s34, 3, 0
    s_and_b32 s34, s34, s39
    s_mov_b32 s35, 0
    s_mul_i32 s40, s51, 160
    s_mul_i32 s41, s38, 20480
    s_add_u32 s41, s41, 64512
    s_mul_i32 s42, s38, 14
    s_cmp_eq_u32 s38, 3
    s_cselect_b32 s42, 41, s42
    s_mul_i32 s45, s50, 54
    s_add_u32 s45, s45, s42
    s_lshl_b32 s45, s45, 12
    s_mul_i32 s46, s42, 40960
    s_mul_i32 s3, s38, 3072
    s_add_u32 s3, s3, 147456
    v_add_u32 v7, s3, v16
    v_add_u32 v2, 0, v1
    v_mul_u32_u24 v3, 6554, v2
    v_lshrrev_b32 v3, 16, v3
    v_mul_u32_u24 v15, 10, v3
    v_sub_u32 v2, v2, v15
    v_lshrrev_b32 v15, 1, v3
    v_xor_b32 v15, v15, v3
    v_bfe_u32 v15, v15, 2, 1
    v_mul_u32_u24 v15, 12, v15
    v_xor_b32 v3, v3, v15
    v_mul_u32_u24 v3, 1280, v3
    v_lshl_add_u32 v2, v2, 4, v3
    v_add_u32 v152, s40, v2
    v_add_u32 v2, 64, v1
    v_mul_u32_u24 v3, 6554, v2
    v_lshrrev_b32 v3, 16, v3
    v_mul_u32_u24 v15, 10, v3
    v_sub_u32 v2, v2, v15
    v_lshrrev_b32 v15, 1, v3
    v_xor_b32 v15, v15, v3
    v_bfe_u32 v15, v15, 2, 1
    v_mul_u32_u24 v15, 12, v15
    v_xor_b32 v3, v3, v15
    v_mul_u32_u24 v3, 1280, v3
    v_lshl_add_u32 v2, v2, 4, v3
    v_subrev_u32 v2, 1024, v2
    v_add_u32 v153, s40, v2
    v_add_u32 v2, 128, v1
    v_mul_u32_u24 v3, 6554, v2
    v_lshrrev_b32 v3, 16, v3
    v_mul_u32_u24 v15, 10, v3
    v_sub_u32 v2, v2, v15
    v_lshrrev_b32 v15, 1, v3
    v_xor_b32 v15, v15, v3
    v_bfe_u32 v15, v15, 2, 1
    v_mul_u32_u24 v15, 12, v15
    v_xor_b32 v3, v3, v15
    v_mul_u32_u24 v3, 1280, v3
    v_lshl_add_u32 v2, v2, 4, v3
    v_subrev_u32 v2, 2048, v2
    v_add_u32 v154, s40, v2
    v_add_u32 v2, 192, v1
    v_mul_u32_u24 v3, 6554, v2
    v_lshrrev_b32 v3, 16, v3
    v_mul_u32_u24 v15, 10, v3
    v_sub_u32 v2, v2, v15
    v_lshrrev_b32 v15, 1, v3
    v_xor_b32 v15, v15, v3
    v_bfe_u32 v15, v15, 2, 1
    v_mul_u32_u24 v15, 12, v15
    v_xor_b32 v3, v3, v15
    v_mul_u32_u24 v3, 1280, v3
    v_lshl_add_u32 v2, v2, 4, v3
    v_subrev_u32 v2, 3072, v2
    v_add_u32 v155, s40, v2
    v_add_u32 v2, 256, v1
    v_mul_u32_u24 v3, 6554, v2
    v_lshrrev_b32 v3, 16, v3
    v_mul_u32_u24 v15, 10, v3
    v_sub_u32 v2, v2, v15
    v_lshrrev_b32 v15, 1, v3
    v_xor_b32 v15, v15, v3
    v_bfe_u32 v15, v15, 2, 1
    v_mul_u32_u24 v15, 12, v15
    v_xor_b32 v3, v3, v15
    v_mul_u32_u24 v3, 1280, v3
    v_lshl_add_u32 v2, v2, 4, v3
    v_add_u32 v156, s40, v2
    v_lshrrev_b32 v10, 4, v1
    v_and_b32 v11, 15, v1
    v_lshlrev_b32 v2, 4, v11
    v_lshl_add_u32 v2, v10, 9, v2
    s_and_b32 s60, s38, 1
    s_lshl_b32 s60, s60, 8
    s_lshr_b32 s61, s38, 1
    s_lshl_b32 s61, s61, 11
    s_or_b32 s60, s60, s61
    s_xor_b32 s61, s60, 0
    s_add_u32 s61, s61, s41
    v_add_u32 v141, s61, v2
    s_xor_b32 s61, s60, 256
    s_add_u32 s61, s61, s41
    v_add_u32 v142, s61, v2
    s_xor_b32 s61, s60, 2048
    s_add_u32 s61, s61, s41
    v_add_u32 v143, s61, v2
    s_xor_b32 s61, s60, 2304
    s_add_u32 s61, s61, s41
    v_add_u32 v144, s61, v2
    v_lshlrev_b32 v2, 3, v10
    v_lshrrev_b32 v3, 2, v11
    v_add_u32 v2, v2, v3
    v_mul_u32_u24 v2, 160, v2
    v_and_b32 v3, 3, v11
    v_lshlrev_b32 v3, 3, v3
    v_add_u32 v2, 4096, v2
    v_add3_u32 v157, v2, v3, s41
    v_add_u32 v2, 0, v1
    v_mul_u32_u24 v3, 6554, v2
    v_lshrrev_b32 v3, 16, v3
    v_mul_u32_u24 v15, 10, v3
    v_sub_u32 v2, v2, v15
    v_lshrrev_b32 v15, 1, v3
    v_and_b32 v15, 4, v15
    v_xor_b32 v3, v3, v15
    v_lshlrev_b32 v2, 4, v2
    v_mul_u32_u24 v3, 1280, v3
    v_add3_u32 v240, v2, v3, s40
    v_add_u32 v2, 64, v1
    v_mul_u32_u24 v3, 6554, v2
    v_lshrrev_b32 v3, 16, v3
    v_mul_u32_u24 v15, 10, v3
    v_sub_u32 v2, v2, v15
    v_lshrrev_b32 v15, 1, v3
    v_and_b32 v15, 4, v15
    v_xor_b32 v3, v3, v15
    v_lshlrev_b32 v2, 4, v2
    v_mul_u32_u24 v3, 1280, v3
    v_add3_u32 v241, v2, v3, s40
    v_add_u32 v2, 128, v1
    v_mul_u32_u24 v3, 6554, v2
    v_lshrrev_b32 v3, 16, v3
    v_mul_u32_u24 v15, 10, v3
    v_sub_u32 v2, v2, v15
    v_lshrrev_b32 v15, 1, v3
    v_and_b32 v15, 4, v15
    v_xor_b32 v3, v3, v15
    v_lshlrev_b32 v2, 4, v2
    v_mul_u32_u24 v3, 1280, v3
    v_add3_u32 v242, v2, v3, s40
    v_add_u32 v2, 192, v1
    v_mul_u32_u24 v3, 6554, v2
    v_lshrrev_b32 v3, 16, v3
    v_mul_u32_u24 v15, 10, v3
    v_sub_u32 v2, v2, v15
    v_lshrrev_b32 v15, 1, v3
    v_and_b32 v15, 4, v15
    v_xor_b32 v3, v3, v15
    v_lshlrev_b32 v2, 4, v2
    v_mul_u32_u24 v3, 1280, v3
    v_add3_u32 v243, v2, v3, s40
    v_add_u32 v2, 256, v1
    v_mul_u32_u24 v3, 6554, v2
    v_lshrrev_b32 v3, 16, v3
    v_mul_u32_u24 v15, 10, v3
    v_sub_u32 v2, v2, v15
    v_lshrrev_b32 v15, 1, v3
    v_and_b32 v15, 4, v15
    v_xor_b32 v3, v3, v15
    v_lshlrev_b32 v2, 4, v2
    v_mul_u32_u24 v3, 1280, v3
    v_add3_u32 v244, v2, v3, s40
    s_cmp_eq_u32 s39, 0
    s_cbranch_scc1 H_NOFREE
    s_waitcnt vmcnt(0)
    s_barrier
H_NOFREE:
    s_setprio 3
    s_lshl_b32 s3, 1, s63
    s_or_b32 exec_lo, s3, 1
    s_mov_b32 exec_hi, 0
    s_mov_b32 s47, 0
H_P2:
    buffer_load_dword v147, v145, s[28:31], 0 offen sc1
    s_sleep 3
    s_waitcnt vmcnt(12)
H_P2_C:
    v_readlane_b32 s3, v147, s63
    s_add_u32 s47, s47, 1
    s_cmp_gt_u32 s47, 0x40000
    s_cselect_b32 s3, -1, s3
    s_cmp_lt_u32 s3, s62
    s_cbranch_scc1 H_P2
    s_mov_b64 exec, -1
    buffer_load_dwordx2 v[32:33], v5, s[64:67], s48 offen offset:0 sc1
    buffer_load_dwordx2 v[34:35], v5, s[64:67], s48 offen offset:512 sc1
    buffer_load_dwordx2 v[40:41], v4, s[64:67], s48 offen offset:1024 sc1
    buffer_load_dwordx2 v[36:37], v5, s[64:67], s48 offen offset:1280 sc1
    buffer_load_dwordx2 v[38:39], v5, s[64:67], s48 offen offset:1792 sc1
    buffer_load_dwordx2 v[42:43], v4, s[64:67], s48 offen offset:2304 sc1
    s_lshl_b32 s3, 1, s63
    s_or_b32 exec_lo, s3, 1
    s_mov_b32 exec_hi, 0
    s_mov_b32 s47, 0
    s_branch H_P1_C
H_P1:
    buffer_load_dword v147, v145, s[28:31], 0 offen sc1
    s_sleep 3
    s_waitcnt vmcnt(12)
H_P1_C:
    v_readlane_b32 s3, v147, 0
    s_lshl_b32 s3, s3, 15
    s_and_b32 s3, s3, 0x7fffffff
    s_add_u32 s47, s47, 1
    s_cmp_gt_u32 s47, 0x40000
    s_cselect_b32 s3, -1, s3
    s_cmp_lt_u32 s3, s62
    s_cbranch_scc1 H_P1
    s_mov_b64 exec, -1
    buffer_load_dwordx2 v[20:21], v5, s[12:15], s49 offen sc1
    buffer_load_dwordx2 v[22:23], v5, s[12:15], s49 offen offset:512 sc1
    buffer_load_dwordx2 v[24:25], v6, s[12:15], s49 offen sc1
    s_add_u32 m0, s58, 0
    s_nop 0
    buffer_load_dwordx4 v16, s[12:15], s44 offen offset:0 sc1 lds
    buffer_load_dwordx4 v16, s[12:15], s44 offen offset:1024 sc1 lds
    buffer_load_dwordx4 v16, s[12:15], s44 offen offset:2048 sc1 lds
    buffer_load_dwordx4 v16, s[12:15], s44 offen offset:3072 sc1 lds
    s_add_u32 m0, m0, 4096
    s_nop 0
    buffer_load_dwordx4 v13, s[12:15], s44 offen sc1 lds
    s_mov_b64 exec, 0xffff
    buffer_load_dwordx4 v13, s[12:15], s44 offen offset:1024 sc1 lds
    s_mov_b64 exec, -1
    s_add_u32 s44, s44, 86016
    s_mov_b64 exec, 0x1ff
    buffer_load_dword v147, v145, s[28:31], 0 offen sc1
    s_mov_b64 exec, -1
    v_mov_b32 v2, 0
    v_mov_b32 v3, 159744
    ds_write2_b32 v3, v2, v2 offset1:1
    s_waitcnt vmcnt(7)
    v_cmp_eq_u32 vcc, 0, v18
    s_nop 1
    v_cndmask_b32 v40, 0, v40, vcc
    v_cndmask_b32 v41, 0, v41, vcc
    v_cndmask_b32 v42, 0, v42, vcc
    v_cndmask_b32 v43, 0, v43, vcc
    v_mfma_f32_32x32x16_bf16 v[64:79], v[20:23], v[32:35], 0
    v_mfma_f32_32x32x16_bf16 v[80:95], v[20:23], v[36:39], 0
    v_mfma_f32_32x32x8bf16_1k v[64:79], v[24:25], v[40:41], v[64:79]
    v_mfma_f32_32x32x8bf16_1k v[80:95], v[24:25], v[42:43], v[80:95]
    ds_write_b128 v7, v[32:35]
    ds_write_b128 v7, v[36:39] offset:1024
    s_nop 15
    s_nop 7
    v_max3_f32 v8, v64, v65, v66
    v_max3_f32 v8, v8, v67, v68
    v_max3_f32 v8, v8, v69, v70
    v_max3_f32 v8, v8, v71, v72
    v_max3_f32 v8, v8, v73, v74
    v_max3_f32 v8, v8, v75, v76
    v_max3_f32 v8, v8, v77, v78
    v_max_f32 v8, v8, v79
    v_max3_f32 v9, v80, v81, v82
    v_max3_f32 v9, v9, v83, v84
    v_max3_f32 v9, v9, v85, v86
    v_max3_f32 v9, v9, v87, v88
    v_max3_f32 v9, v9, v89, v90
    v_max3_f32 v9, v9, v91, v92
    v_max3_f32 v9, v9, v93, v94
    v_max_f32 v9, v9, v95
    v_mov_b32 v3, v8
    v_mov_b32 v5, v9
    s_nop 1
    v_permlane32_swap_b32 v8, v3
    v_permlane32_swap_b32 v9, v5
    s_nop 1
    v_max_f32 v8, v8, v3
    v_max_f32 v9, v9, v5
    v_and_b32 v3, 0xffff0000, v8
    v_sub_f32 v2, v8, v3
    v_and_b32 v19, 0xffff0000, v2
    v_sub_f32 v2, v2, v19
    v_lshrrev_b32 v3, 16, v3
    v_or_b32 v3, v3, v19
    v_xor_b32 v3, 0x80008000, v3
    v_lshrrev_b32 v2, 16, v2
    v_xor_b32 v2, 0x8000, v2
    v_and_b32 v5, 0xffff0000, v9
    v_sub_f32 v4, v9, v5
    v_and_b32 v6, 0xffff0000, v4
    v_sub_f32 v4, v4, v6
    v_lshrrev_b32 v5, 16, v5
    v_or_b32 v5, v5, v6
    v_xor_b32 v5, 0x80008000, v5
    v_lshrrev_b32 v4, 16, v4
    v_xor_b32 v4, 0x8000, v4
    v_cmp_eq_u32 vcc, 0, v18
    s_nop 1
    v_cndmask_b32 v40, v3, v40, vcc
    v_cndmask_b32 v41, v2, v41, vcc
    v_cndmask_b32 v42, v5, v42, vcc
    v_cndmask_b32 v43, v4, v43, vcc
    ds_write_b128 v7, v[40:43] offset:2048
    v_mov_b32 v4, 1
    v_lshlrev_b32 v5, 8, v1
    s_waitcnt vmcnt(1)
    s_waitcnt lgkmcnt(0)
    s_setprio 0
    s_barrier
    s_mov_b64 exec, 0x1ff
    s_mov_b32 s47, 0
H_P3:
    v_and_b32 v2, 0xffff, v147
    v_cmp_lt_u32 vcc, v2, v146
    s_nop 4
    s_and_b32 s3, vcc_lo, 18
    s_cmp_eq_u32 s3, 0
    s_cbranch_scc1 H_P3_OK
    s_sleep 4
H_P3_L:
    buffer_load_dword v147, v145, s[28:31], 0 offen sc1
    s_add_u32 s47, s47, 1
    s_cmp_lt_u32 s47, 0x20000
    s_waitcnt vmcnt(0)
    s_cbranch_scc1 H_P3
H_P3_OK:
    s_mov_b64 exec, -1
    s_add_u32 m0, s58, 21504
    s_nop 0
    buffer_load_dwordx4 v16, s[12:15], s44 offen offset:0 sc1 lds
    buffer_load_dwordx4 v16, s[12:15], s44 offen offset:1024 sc1 lds
    buffer_load_dwordx4 v16, s[12:15], s44 offen offset:2048 sc1 lds
    buffer_load_dwordx4 v16, s[12:15], s44 offen offset:3072 sc1 lds
    s_add_u32 m0, m0, 4096
    s_nop 0
    buffer_load_dwordx4 v13, s[12:15], s44 offen sc1 lds
    s_mov_b64 exec, 0xffff
    buffer_load_dwordx4 v13, s[12:15], s44 offen offset:1024 sc1 lds
    s_mov_b64 exec, -1
    s_sub_u32 s44, s44, 64512
    s_add_u32 m0, s58, 43008
    s_branch PADX_12
PAD_12:
    s_branch PAD_END
PADX_12:
    s_nop 0
    buffer_load_dwordx4 v16, s[12:15], s44 offen offset:0 sc1 lds
    buffer_load_dwordx4 v16, s[12:15], s44 offen offset:1024 sc1 lds
    buffer_load_dwordx4 v16, s[12:15], s44 offen offset:2048 sc1 lds
    buffer_load_dwordx4 v16, s[12:15], s44 offen offset:3072 sc1 lds
    s_add_u32 m0, m0, 4096
    s_nop 0
    buffer_load_dwordx4 v13, s[12:15], s44 offen sc1 lds
    s_mov_b64 exec, 0xffff
    buffer_load_dwordx4 v13, s[12:15], s44 offen offset:1024 sc1 lds
    s_mov_b64 exec, -1
    s_add_u32 s44, s44, 86016
    s_waitcnt vmcnt(6)
    s_barrier
    s_mov_b64 exec, s[34:35]
    buffer_atomic_add v4, v5, s[28:31], s85 offen
    s_mov_b64 exec, -1
    s_add_u32 m0, s41, 4096
    s_nop 0
    buffer_load_dwordx4 v152, s[16:19], s46 offen offset:0 lds
    buffer_load_dwordx4 v153, s[16:19], s46 offen offset:1024 lds
    buffer_load_dwordx4 v154, s[16:19], s46 offen offset:2048 lds
    buffer_load_dwordx4 v155, s[16:19], s46 offen offset:3072 lds
    s_add_u32 m0, s41, 8192
    s_nop 0
    buffer_load_dwordx4 v156, s[16:19], s46 offen lds
    s_add_u32 s46, s46, 40960
    s_add_u32 m0, s41, 13312
    s_nop 0
    buffer_load_dwordx4 v152, s[16:19], s46 offen offset:0 lds
    buffer_load_dwordx4 v153, s[16:19], s46 offen offset:1024 lds
    buffer_load_dwordx4 v154, s[16:19], s46 offen offset:2048 lds
    buffer_load_dwordx4 v155, s[16:19], s46 offen offset:3072 lds
    s_add_u32 m0, s41, 17408
    s_nop 0
    buffer_load_dwordx4 v156, s[16:19], s46 offen lds
    s_add_u32 s46, s46, 40960
    s_waitcnt vmcnt(10)
    s_barrier
    s_mov_b64 exec, 0x1ff
    s_mov_b32 s47, 0
H_P5:
    v_and_b32 v2, 0xffff, v147
    v_cmp_lt_u32 vcc, v2, v146
    s_nop 4
    s_and_b32 s3, vcc_lo, 255
    s_cmp_eq_u32 s3, 0
    s_cbranch_scc1 H_P5_OK
    s_sleep 4
H_P5_L:
    buffer_load_dword v147, v145, s[28:31], 0 offen sc1
    s_add_u32 s47, s47, 1
    s_cmp_lt_u32 s47, 0x20000
    s_waitcnt vmcnt(0)
    s_cbranch_scc1 H_P5
H_P5_OK:
    s_mov_b64 exec, -1
    s_add_u32 m0, s58, 0
    s_nop 0
    buffer_load_dwordx4 v16, s[12:15], s44 offen offset:0 sc1 lds
    buffer_load_dwordx4 v16, s[12:15], s44 offen offset:1024 sc1 lds
    buffer_load_dwordx4 v16, s[12:15], s44 offen offset:2048 sc1 lds
    buffer_load_dwordx4 v16, s[12:15], s44 offen offset:3072 sc1 lds
    s_add_u32 m0, m0, 4096
    s_nop 0
    buffer_load_dwordx4 v13, s[12:15], s44 offen sc1 lds
    s_mov_b64 exec, 0xffff
    buffer_load_dwordx4 v13, s[12:15], s44 offen offset:1024 sc1 lds
    s_mov_b64 exec, -1
    s_sub_u32 s44, s44, 64512
    s_mov_b64 exec, 0x1ff
    s_mov_b32 s47, 0
H_P4:
    v_and_b32 v2, 0xffff, v147
    v_cmp_lt_u32 vcc, v2, v146
    s_nop 4
    s_and_b32 s3, vcc_lo, 256
    s_cmp_eq_u32 s3, 0
    s_cbranch_scc1 H_P4_OK
    s_sleep 4
H_P4_L:
    buffer_load_dword v147, v145, s[28:31], 0 offen sc1
    s_add_u32 s47, s47, 1
    s_cmp_lt_u32 s47, 0x20000
    s_waitcnt vmcnt(0)
    s_cbranch_scc1 H_P4
H_P4_OK:
    s_mov_b64 exec, -1
    s_add_u32 m0, s41, 0
    s_nop 0
    buffer_load_dwordx4 v16, s[24:27], s45 offen offset:0 sc1 lds
    buffer_load_dwordx4 v16, s[24:27], s45 offen offset:1024 sc1 lds
    buffer_load_dwordx4 v16, s[24:27], s45 offen offset:2048 sc1 lds
    buffer_load_dwordx4 v16, s[24:27], s45 offen offset:3072 sc1 lds
    s_add_u32 s45, s45, 4096
    s_add_u32 m0, s41, 9216
    s_nop 0
    buffer_load_dwordx4 v16, s[24:27], s45 offen offset:0 sc1 lds
    buffer_load_dwordx4 v16, s[24:27], s45 offen offset:1024 sc1 lds
    buffer_load_dwordx4 v16, s[24:27], s45 offen offset:2048 sc1 lds
    buffer_load_dwordx4 v16, s[24:27], s45 offen offset:3072 sc1 lds
    s_add_u32 s45, s45, 4096
    s_waitcnt vmcnt(4)
    ds_read_b128 v[24:27], v141 offset:0
    ds_read_b128 v[28:31], v142 offset:0
    ds_read_b128 v[32:35], v143 offset:0
    ds_read_b128 v[36:39], v144 offset:0
    ds_read_b64_tr_b16 v[40:41], v157 offset:0
    ds_read_b64_tr_b16 v[42:43], v157 offset:640
    ds_read_b64_tr_b16 v[44:45], v157 offset:32
    ds_read_b64_tr_b16 v[46:47], v157 offset:672
    ds_read_b64_tr_b16 v[48:49], v157 offset:64
    ds_read_b64_tr_b16 v[50:51], v157 offset:704
    ds_read_b64_tr_b16 v[52:53], v157 offset:96
    ds_read_b64_tr_b16 v[54:55], v157 offset:736
    ds_read_b64_tr_b16 v[56:57], v157 offset:128
    ds_read_b64_tr_b16 v[58:59], v157 offset:768
    s_waitcnt lgkmcnt(0)
    v_mfma_f32_16x16x32_bf16 v[160:163], v[40:43], v[24:27], 0
    v_mfma_f32_16x16x32_bf16 v[164:167], v[40:43], v[28:31], 0
    s_add_u32 m0, s41, 0
    s_nop 0
    buffer_load_dwordx4 v16, s[24:27], s45 offen offset:0 sc1 lds
    v_mfma_f32_16x16x32_bf16 v[168:171], v[40:43], v[32:35], 0
    v_mfma_f32_16x16x32_bf16 v[172:175], v[40:43], v[36:39], 0
    buffer_load_dwordx4 v16, s[24:27], s45 offen offset:1024 sc1 lds
    v_mfma_f32_16x16x32_bf16 v[176:179], v[44:47], v[24:27], 0
    v_mfma_f32_16x16x32_bf16 v[180:183], v[44:47], v[28:31], 0
    buffer_load_dwordx4 v16, s[24:27], s45 offen offset:2048 sc1 lds
    v_mfma_f32_16x16x32_bf16 v[184:187], v[44:47], v[32:35], 0
    v_mfma_f32_16x16x32_bf16 v[188:191], v[44:47], v[36:39], 0
    buffer_load_dwordx4 v16, s[24:27], s45 offen offset:3072 sc1 lds
    s_add_u32 s45, s45, 4096
    v_mfma_f32_16x16x32_bf16 v[192:195], v[48:51], v[24:27], 0
    v_mfma_f32_16x16x32_bf16 v[196:199], v[48:51], v[28:31], 0
    s_add_u32 m0, s41, 4096
    s_nop 0
    buffer_load_dwordx4 v152, s[16:19], s46 offen offset:0 lds
    v_mfma_f32_16x16x32_bf16 v[200:203], v[48:51], v[32:35], 0
    v_mfma_f32_16x16x32_bf16 v[204:207], v[48:51], v[36:39], 0
    buffer_load_dwordx4 v153, s[16:19], s46 offen offset:1024 lds
    v_mfma_f32_16x16x32_bf16 v[208:211], v[52:55], v[24:27], 0
    v_mfma_f32_16x16x32_bf16 v[212:215], v[52:55], v[28:31], 0
    buffer_load_dwordx4 v154, s[16:19], s46 offen offset:2048 lds
    v_mfma_f32_16x16x32_bf16 v[216:219], v[52:55], v[32:35], 0
    v_mfma_f32_16x16x32_bf16 v[220:223], v[52:55], v[36:39], 0
    buffer_load_dwordx4 v155, s[16:19], s46 offen offset:3072 lds
    v_mfma_f32_16x16x32_bf16 v[224:227], v[56:59], v[24:27], 0
    v_mfma_f32_16x16x32_bf16 v[228:231], v[56:59], v[28:31], 0
    s_add_u32 m0, s41, 8192
    s_nop 0
    buffer_load_dwordx4 v156, s[16:19], s46 offen lds
    s_add_u32 s46, s46, 40960
    v_mfma_f32_16x16x32_bf16 v[232:235], v[56:59], v[32:35], 0
    v_mfma_f32_16x16x32_bf16 v[236:239], v[56:59], v[36:39], 0
    s_barrier
    s_add_u32 m0, s58, 21504
    s_nop 0
    buffer_load_dwordx4 v16, s[12:15], s44 offen offset:0 sc1 lds
    buffer_load_dwordx4 v16, s[12:15], s44 offen offset:1024 sc1 lds
    buffer_load_dwordx4 v16, s[12:15], s44 offen offset:2048 sc1 lds
    buffer_load_dwordx4 v16, s[12:15], s44 offen offset:3072 sc1 lds
    s_add_u32 m0, m0, 4096
    s_nop 0
    buffer_load_dwordx4 v13, s[12:15], s44 offen sc1 lds
    s_mov_b64 exec, 0xffff
    buffer_load_dwordx4 v13, s[12:15], s44 offen offset:1024 sc1 lds
    s_mov_b64 exec, -1
    s_add_u32 s44, s44, 86016
    s_waitcnt vmcnt(15)
    ds_read_b128 v[24:27], v141 offset:9216
    ds_read_b128 v[28:31], v142 offset:9216
    ds_read_b128 v[32:35], v143 offset:9216
    ds_read_b128 v[36:39], v144 offset:9216
    ds_read_b64_tr_b16 v[40:41], v157 offset:9216
    ds_read_b64_tr_b16 v[42:43], v157 offset:9856
    ds_read_b64_tr_b16 v[44:45], v157 offset:9248
    ds_read_b64_tr_b16 v[46:47], v157 offset:9888
    ds_read_b64_tr_b16 v[48:49], v157 offset:9280
    ds_read_b64_tr_b16 v[50:51], v157 offset:9920
    ds_read_b64_tr_b16 v[52:53], v157 offset:9312
    ds_read_b64_tr_b16 v[54:55], v157 offset:9952
    ds_read_b64_tr_b16 v[56:57], v157 offset:9344
    ds_read_b64_tr_b16 v[58:59], v157 offset:9984
    s_waitcnt lgkmcnt(0)
    v_mfma_f32_16x16x32_bf16 v[160:163], v[40:43], v[24:27], v[160:163]
    v_mfma_f32_16x16x32_bf16 v[164:167], v[40:43], v[28:31], v[164:167]
    s_add_u32 m0, s41, 9216
    s_nop 0
    buffer_load_dwordx4 v16, s[24:27], s45 offen offset:0 sc1 lds
    v_mfma_f32_16x16x32_bf16 v[168:171], v[40:43], v[32:35], v[168:171]
    v_mfma_f32_16x16x32_bf16 v[172:175], v[40:43], v[36:39], v[172:175]
    buffer_load_dwordx4 v16, s[24:27], s45 offen offset:1024 sc1 lds
    v_mfma_f32_16x16x32_bf16 v[176:179], v[44:47], v[24:27], v[176:179]
    v_mfma_f32_16x16x32_bf16 v[180:183], v[44:47], v[28:31], v[180:183]
    buffer_load_dwordx4 v16, s[24:27], s45 offen offset:2048 sc1 lds
    v_mfma_f32_16x16x32_bf16 v[184:187], v[44:47], v[32:35], v[184:187]
    v_mfma_f32_16x16x32_bf16 v[188:191], v[44:47], v[36:39], v[188:191]
    buffer_load_dwordx4 v16, s[24:27], s45 offen offset:3072 sc1 lds
    s_add_u32 s45, s45, 4096
    v_mfma_f32_16x16x32_bf16 v[192:195], v[48:51], v[24:27], v[192:195]
    v_mfma_f32_16x16x32_bf16 v[196:199], v[48:51], v[28:31], v[196:199]
    s_add_u32 m0, s41, 13312
    s_nop 0
    buffer_load_dwordx4 v152, s[16:19], s46 offen offset:0 lds
    v_mfma_f32_16x16x32_bf16 v[200:203], v[48:51], v[32:35], v[200:203]
    v_mfma_f32_16x16x32_bf16 v[204:207], v[48:51], v[36:39], v[204:207]
    buffer_load_dwordx4 v153, s[16:19], s46 offen offset:1024 lds
    v_mfma_f32_16x16x32_bf16 v[208:211], v[52:55], v[24:27], v[208:211]
    v_mfma_f32_16x16x32_bf16 v[212:215], v[52:55], v[28:31], v[212:215]
    buffer_load_dwordx4 v154, s[16:19], s46 offen offset:2048 lds
    v_mfma_f32_16x16x32_bf16 v[216:219], v[52:55], v[32:35], v[216:219]
    v_mfma_f32_16x16x32_bf16 v[220:223], v[52:55], v[36:39], v[220:223]
    buffer_load_dwordx4 v155, s[16:19], s46 offen offset:3072 lds
    v_mfma_f32_16x16x32_bf16 v[224:227], v[56:59], v[24:27], v[224:227]
    v_mfma_f32_16x16x32_bf16 v[228:231], v[56:59], v[28:31], v[228:231]
    s_add_u32 m0, s41, 17408
    s_nop 0
    buffer_load_dwordx4 v156, s[16:19], s46 offen lds
    s_add_u32 s46, s46, 40960
    v_mfma_f32_16x16x32_bf16 v[232:235], v[56:59], v[32:35], v[232:235]
    v_mfma_f32_16x16x32_bf16 v[236:239], v[56:59], v[36:39], v[236:239]
    s_waitcnt vmcnt(15)
    ds_read_b128 v[24:27], v141 offset:0
    ds_read_b128 v[28:31], v142 offset:0
    ds_read_b128 v[32:35], v143 offset:0
    ds_read_b128 v[36:39], v144 offset:0
    ds_read_b64_tr_b16 v[40:41], v157 offset:0
    ds_read_b64_tr_b16 v[42:43], v157 offset:640
    ds_read_b64_tr_b16 v[44:45], v157 offset:32
    ds_read_b64_tr_b16 v[46:47], v157 offset:672
    ds_read_b64_tr_b16 v[48:49], v157 offset:64
    ds_read_b64_tr_b16 v[50:51], v157 offset:704
    ds_read_b64_tr_b16 v[52:53], v157 offset:96
    ds_read_b64_tr_b16 v[54:55], v157 offset:736
    ds_read_b64_tr_b16 v[56:57], v157 offset:128
    ds_read_b64_tr_b16 v[58:59], v157 offset:768
    s_waitcnt lgkmcnt(0)
    v_mfma_f32_16x16x32_bf16 v[160:163], v[40:43], v[24:27], v[160:163]
    v_mfma_f32_16x16x32_bf16 v[164:167], v[40:43], v[28:31], v[164:167]
    s_add_u32 m0, s41, 0
    s_nop 0
    buffer_load_dwordx4 v16, s[24:27], s45 offen offset:0 sc1 lds
    v_mfma_f32_16x16x32_bf16 v[168:171], v[40:43], v[32:35], v[168:171]
    v_mfma_f32_16x16x32_bf16 v[172:175], v[40:43], v[36:39], v[172:175]
    buffer_load_dwordx4 v16, s[24:27], s45 offen offset:1024 sc1 lds
    v_mfma_f32_16x16x32_bf16 v[176:179], v[44:47], v[24:27], v[176:179]
    v_mfma_f32_16x16x32_bf16 v[180:183], v[44:47], v[28:31], v[180:183]
    buffer_load_dwordx4 v16, s[24:27], s45 offen offset:2048 sc1 lds
    v_mfma_f32_16x16x32_bf16 v[184:187], v[44:47], v[32:35], v[184:187]
    v_mfma_f32_16x16x32_bf16 v[188:191], v[44:47], v[36:39], v[188:191]
    buffer_load_dwordx4 v16, s[24:27], s45 offen offset:3072 sc1 lds
    s_add_u32 s45, s45, 4096
    v_mfma_f32_16x16x32_bf16 v[192:195], v[48:51], v[24:27], v[192:195]
    v_mfma_f32_16x16x32_bf16 v[196:199], v[48:51], v[28:31], v[196:199]
    s_add_u32 m0, s41, 4096
    s_nop 0
    buffer_load_dwordx4 v152, s[16:19], s46 offen offset:0 lds
    v_mfma_f32_16x16x32_bf16 v[200:203], v[48:51], v[32:35], v[200:203]
    v_mfma_f32_16x16x32_bf16 v[204:207], v[48:51], v[36:39], v[204:207]
    buffer_load_dwordx4 v153, s[16:19], s46 offen offset:1024 lds
    v_mfma_f32_16x16x32_bf16 v[208:211], v[52:55], v[24:27], v[208:211]
    v_mfma_f32_16x16x32_bf16 v[212:215], v[52:55], v[28:31], v[212:215]
    buffer_load_dwordx4 v154, s[16:19], s46 offen offset:2048 lds
    v_mfma_f32_16x16x32_bf16 v[216:219], v[52:55], v[32:35], v[216:219]
    v_mfma_f32_16x16x32_bf16 v[220:223], v[52:55], v[36:39], v[220:223]
    buffer_load_dwordx4 v155, s[16:19], s46 offen offset:3072 lds
    v_mfma_f32_16x16x32_bf16 v[224:227], v[56:59], v[24:27], v[224:227]
    v_mfma_f32_16x16x32_bf16 v[228:231], v[56:59], v[28:31], v[228:231]
    s_add_u32 m0, s41, 8192
    s_nop 0
    buffer_load_dwordx4 v156, s[16:19], s46 offen lds
    s_add_u32 s46, s46, 40960
    v_mfma_f32_16x16x32_bf16 v[232:235], v[56:59], v[32:35], v[232:235]
    v_mfma_f32_16x16x32_bf16 v[236:239], v[56:59], v[36:39], v[236:239]
    s_waitcnt vmcnt(9)
    ds_read_b128 v[24:27], v141 offset:9216
    ds_read_b128 v[28:31], v142 offset:9216
    ds_read_b128 v[32:35], v143 offset:9216
    ds_read_b128 v[36:39], v144 offset:9216
    ds_read_b64_tr_b16 v[40:41], v157 offset:9216
    ds_read_b64_tr_b16 v[42:43], v157 offset:9856
    ds_read_b64_tr_b16 v[44:45], v157 offset:9248
    ds_read_b64_tr_b16 v[46:47], v157 offset:9888
    ds_read_b64_tr_b16 v[48:49], v157 offset:9280
    ds_read_b64_tr_b16 v[50:51], v157 offset:9920
    ds_read_b64_tr_b16 v[52:53], v157 offset:9312
    ds_read_b64_tr_b16 v[54:55], v157 offset:9952
    ds_read_b64_tr_b16 v[56:57], v157 offset:9344
    ds_read_b64_tr_b16 v[58:59], v157 offset:9984
    s_waitcnt lgkmcnt(0)
    v_mfma_f32_16x16x32_bf16 v[160:163], v[40:43], v[24:27], v[160:163]
    v_mfma_f32_16x16x32_bf16 v[164:167], v[40:43], v[28:31], v[164:167]
    s_add_u32 m0, s41, 9216
    s_nop 0
    buffer_load_dwordx4 v16, s[24:27], s45 offen offset:0 sc1 lds
    v_mfma_f32_16x16x32_bf16 v[168:171], v[40:43], v[32:35], v[168:171]
    v_mfma_f32_16x16x32_bf16 v[172:175], v[40:43], v[36:39], v[172:175]
    buffer_load_dwordx4 v16, s[24:27], s45 offen offset:1024 sc1 lds
    v_mfma_f32_16x16x32_bf16 v[176:179], v[44:47], v[24:27], v[176:179]
    v_mfma_f32_16x16x32_bf16 v[180:183], v[44:47], v[28:31], v[180:183]
    buffer_load_dwordx4 v16, s[24:27], s45 offen offset:2048 sc1 lds
    v_mfma_f32_16x16x32_bf16 v[184:187], v[44:47], v[32:35], v[184:187]
    v_mfma_f32_16x16x32_bf16 v[188:191], v[44:47], v[36:39], v[188:191]
    buffer_load_dwordx4 v16, s[24:27], s45 offen offset:3072 sc1 lds
    s_add_u32 s45, s45, 4096
    v_mfma_f32_16x16x32_bf16 v[192:195], v[48:51], v[24:27], v[192:195]
    v_mfma_f32_16x16x32_bf16 v[196:199], v[48:51], v[28:31], v[196:199]
    s_add_u32 m0, s41, 13312
    s_nop 0
    buffer_load_dwordx4 v152, s[16:19], s46 offen offset:0 lds
    v_mfma_f32_16x16x32_bf16 v[200:203], v[48:51], v[32:35], v[200:203]
    v_mfma_f32_16x16x32_bf16 v[204:207], v[48:51], v[36:39], v[204:207]
    buffer_load_dwordx4 v153, s[16:19], s46 offen offset:1024 lds
    v_mfma_f32_16x16x32_bf16 v[208:211], v[52:55], v[24:27], v[208:211]
    v_mfma_f32_16x16x32_bf16 v[212:215], v[52:55], v[28:31], v[212:215]
    buffer_load_dwordx4 v154, s[16:19], s46 offen offset:2048 lds
    v_mfma_f32_16x16x32_bf16 v[216:219], v[52:55], v[32:35], v[216:219]
    v_mfma_f32_16x16x32_bf16 v[220:223], v[52:55], v[36:39], v[220:223]
    buffer_load_dwordx4 v155, s[16:19], s46 offen offset:3072 lds
    v_mfma_f32_16x16x32_bf16 v[224:227], v[56:59], v[24:27], v[224:227]
    v_mfma_f32_16x16x32_bf16 v[228:231], v[56:59], v[28:31], v[228:231]
    s_add_u32 m0, s41, 17408
    s_nop 0
    buffer_load_dwordx4 v156, s[16:19], s46 offen lds
    s_add_u32 s46, s46, 40960
    v_mfma_f32_16x16x32_bf16 v[232:235], v[56:59], v[32:35], v[232:235]
    v_mfma_f32_16x16x32_bf16 v[236:239], v[56:59], v[36:39], v[236:239]
    s_barrier
    s_add_u32 m0, s58, 43008
    s_nop 0
    buffer_load_dwordx4 v16, s[12:15], s44 offen offset:0 sc1 lds
    buffer_load_dwordx4 v16, s[12:15], s44 offen offset:1024 sc1 lds
    buffer_load_dwordx4 v16, s[12:15], s44 offen offset:2048 sc1 lds
    buffer_load_dwordx4 v16, s[12:15], s44 offen offset:3072 sc1 lds
    s_add_u32 m0, m0, 4096
    s_nop 0
    buffer_load_dwordx4 v13, s[12:15], s44 offen sc1 lds
    s_mov_b64 exec, 0xffff
    buffer_load_dwordx4 v13, s[12:15], s44 offen offset:1024 sc1 lds
    s_mov_b64 exec, -1
    s_sub_u32 s44, s44, 64512
    s_waitcnt vmcnt(15)
    ds_read_b128 v[24:27], v141 offset:0
    ds_read_b128 v[28:31], v142 offset:0
    ds_read_b128 v[32:35], v143 offset:0
    ds_read_b128 v[36:39], v144 offset:0
    ds_read_b64_tr_b16 v[40:41], v157 offset:0
    ds_read_b64_tr_b16 v[42:43], v157 offset:640
    ds_read_b64_tr_b16 v[44:45], v157 offset:32
    ds_read_b64_tr_b16 v[46:47], v157 offset:672
    ds_read_b64_tr_b16 v[48:49], v157 offset:64
    ds_read_b64_tr_b16 v[50:51], v157 offset:704
    ds_read_b64_tr_b16 v[52:53], v157 offset:96
    ds_read_b64_tr_b16 v[54:55], v157 offset:736
    ds_read_b64_tr_b16 v[56:57], v157 offset:128
    ds_read_b64_tr_b16 v[58:59], v157 offset:768
    s_waitcnt lgkmcnt(0)
    v_mfma_f32_16x16x32_bf16 v[160:163], v[40:43], v[24:27], v[160:163]
    v_mfma_f32_16x16x32_bf16 v[164:167], v[40:43], v[28:31], v[164:167]
    s_add_u32 m0, s41, 0
    s_nop 0
    buffer_load_dwordx4 v16, s[24:27], s45 offen offset:0 sc1 lds
    v_mfma_f32_16x16x32_bf16 v[168:171], v[40:43], v[32:35], v[168:171]
    v_mfma_f32_16x16x32_bf16 v[172:175], v[40:43], v[36:39], v[172:175]
    buffer_load_dwordx4 v16, s[24:27], s45 offen offset:1024 sc1 lds
    v_mfma_f32_16x16x32_bf16 v[176:179], v[44:47], v[24:27], v[176:179]
    v_mfma_f32_16x16x32_bf16 v[180:183], v[44:47], v[28:31], v[180:183]
    buffer_load_dwordx4 v16, s[24:27], s45 offen offset:2048 sc1 lds
    v_mfma_f32_16x16x32_bf16 v[184:187], v[44:47], v[32:35], v[184:187]
    v_mfma_f32_16x16x32_bf16 v[188:191], v[44:47], v[36:39], v[188:191]
    buffer_load_dwordx4 v16, s[24:27], s45 offen offset:3072 sc1 lds
    s_add_u32 s45, s45, 4096
    v_mfma_f32_16x16x32_bf16 v[192:195], v[48:51], v[24:27], v[192:195]
    v_mfma_f32_16x16x32_bf16 v[196:199], v[48:51], v[28:31], v[196:199]
    s_add_u32 m0, s41, 4096
    s_nop 0
    buffer_load_dwordx4 v152, s[16:19], s46 offen offset:0 lds
    v_mfma_f32_16x16x32_bf16 v[200:203], v[48:51], v[32:35], v[200:203]
    v_mfma_f32_16x16x32_bf16 v[204:207], v[48:51], v[36:39], v[204:207]
    buffer_load_dwordx4 v153, s[16:19], s46 offen offset:1024 lds
    v_mfma_f32_16x16x32_bf16 v[208:211], v[52:55], v[24:27], v[208:211]
    v_mfma_f32_16x16x32_bf16 v[212:215], v[52:55], v[28:31], v[212:215]
    buffer_load_dwordx4 v154, s[16:19], s46 offen offset:2048 lds
    v_mfma_f32_16x16x32_bf16 v[216:219], v[52:55], v[32:35], v[216:219]
    v_mfma_f32_16x16x32_bf16 v[220:223], v[52:55], v[36:39], v[220:223]
    buffer_load_dwordx4 v155, s[16:19], s46 offen offset:3072 lds
    v_mfma_f32_16x16x32_bf16 v[224:227], v[56:59], v[24:27], v[224:227]
    v_mfma_f32_16x16x32_bf16 v[228:231], v[56:59], v[28:31], v[228:231]
    s_add_u32 m0, s41, 8192
    s_nop 0
    buffer_load_dwordx4 v156, s[16:19], s46 offen lds
    s_add_u32 s46, s46, 40960
    v_mfma_f32_16x16x32_bf16 v[232:235], v[56:59], v[32:35], v[232:235]
    v_mfma_f32_16x16x32_bf16 v[236:239], v[56:59], v[36:39], v[236:239]
    s_waitcnt vmcnt(15)
    ds_read_b128 v[24:27], v141 offset:9216
    ds_read_b128 v[28:31], v142 offset:9216
    ds_read_b128 v[32:35], v143 offset:9216
    ds_read_b128 v[36:39], v144 offset:9216
    ds_read_b64_tr_b16 v[40:41], v157 offset:9216
    ds_read_b64_tr_b16 v[42:43], v157 offset:9856
    ds_read_b64_tr_b16 v[44:45], v157 offset:9248
    ds_read_b64_tr_b16 v[46:47], v157 offset:9888
    ds_read_b64_tr_b16 v[48:49], v157 offset:9280
    ds_read_b64_tr_b16 v[50:51], v157 offset:9920
    ds_read_b64_tr_b16 v[52:53], v157 offset:9312
    ds_read_b64_tr_b16 v[54:55], v157 offset:9952
    ds_read_b64_tr_b16 v[56:57], v157 offset:9344
    ds_read_b64_tr_b16 v[58:59], v157 offset:9984
    s_waitcnt lgkmcnt(0)
    v_mfma_f32_16x16x32_bf16 v[160:163], v[40:43], v[24:27], v[160:163]
    v_mfma_f32_16x16x32_bf16 v[164:167], v[40:43], v[28:31], v[164:167]
    s_add_u32 m0, s41, 9216
    s_nop 0
    buffer_load_dwordx4 v16, s[24:27], s45 offen offset:0 sc1 lds
    v_mfma_f32_16x16x32_bf16 v[168:171], v[40:43], v[32:35], v[168:171]
    v_mfma_f32_16x16x32_bf16 v[172:175], v[40:43], v[36:39], v[172:175]
    buffer_load_dwordx4 v16, s[24:27], s45 offen offset:1024 sc1 lds
    v_mfma_f32_16x16x32_bf16 v[176:179], v[44:47], v[24:27], v[176:179]
    v_mfma_f32_16x16x32_bf16 v[180:183], v[44:47], v[28:31], v[180:183]
    buffer_load_dwordx4 v16, s[24:27], s45 offen offset:2048 sc1 lds
    v_mfma_f32_16x16x32_bf16 v[184:187], v[44:47], v[32:35], v[184:187]
    v_mfma_f32_16x16x32_bf16 v[188:191], v[44:47], v[36:39], v[188:191]
    buffer_load_dwordx4 v16, s[24:27], s45 offen offset:3072 sc1 lds
    s_add_u32 s45, s45, 4096
    v_mfma_f32_16x16x32_bf16 v[192:195], v[48:51], v[24:27], v[192:195]
    v_mfma_f32_16x16x32_bf16 v[196:199], v[48:51], v[28:31], v[196:199]
    s_add_u32 m0, s41, 13312
    s_nop 0
    buffer_load_dwordx4 v152, s[16:19], s46 offen offset:0 lds
    v_mfma_f32_16x16x32_bf16 v[200:203], v[48:51], v[32:35], v[200:203]
    v_mfma_f32_16x16x32_bf16 v[204:207], v[48:51], v[36:39], v[204:207]
    buffer_load_dwordx4 v153, s[16:19], s46 offen offset:1024 lds
    v_mfma_f32_16x16x32_bf16 v[208:211], v[52:55], v[24:27], v[208:211]
    v_mfma_f32_16x16x32_bf16 v[212:215], v[52:55], v[28:31], v[212:215]
    buffer_load_dwordx4 v154, s[16:19], s46 offen offset:2048 lds
    v_mfma_f32_16x16x32_bf16 v[216:219], v[52:55], v[32:35], v[216:219]
    v_mfma_f32_16x16x32_bf16 v[220:223], v[52:55], v[36:39], v[220:223]
    buffer_load_dwordx4 v155, s[16:19], s46 offen offset:3072 lds
    v_mfma_f32_16x16x32_bf16 v[224:227], v[56:59], v[24:27], v[224:227]
    v_mfma_f32_16x16x32_bf16 v[228:231], v[56:59], v[28:31], v[228:231]
    s_add_u32 m0, s41, 17408
    s_nop 0
    buffer_load_dwordx4 v156, s[16:19], s46 offen lds
    s_add_u32 s46, s46, 40960
    v_mfma_f32_16x16x32_bf16 v[232:235], v[56:59], v[32:35], v[232:235]
    v_mfma_f32_16x16x32_bf16 v[236:239], v[56:59], v[36:39], v[236:239]
    s_waitcnt vmcnt(9)
    ds_read_b128 v[24:27], v141 offset:0
    ds_read_b128 v[28:31], v142 offset:0
    ds_read_b128 v[32:35], v143 offset:0
    ds_read_b128 v[36:39], v144 offset:0
    ds_read_b64_tr_b16 v[40:41], v157 offset:0
    ds_read_b64_tr_b16 v[42:43], v157 offset:640
    ds_read_b64_tr_b16 v[44:45], v157 offset:32
    ds_read_b64_tr_b16 v[46:47], v157 offset:672
    ds_read_b64_tr_b16 v[48:49], v157 offset:64
    ds_read_b64_tr_b16 v[50:51], v157 offset:704
    ds_read_b64_tr_b16 v[52:53], v157 offset:96
    ds_read_b64_tr_b16 v[54:55], v157 offset:736
    ds_read_b64_tr_b16 v[56:57], v157 offset:128
    ds_read_b64_tr_b16 v[58:59], v157 offset:768
    s_waitcnt lgkmcnt(0)
    v_mfma_f32_16x16x32_bf16 v[160:163], v[40:43], v[24:27], v[160:163]
    v_mfma_f32_16x16x32_bf16 v[164:167], v[40:43], v[28:31], v[164:167]
    s_add_u32 m0, s41, 0
    s_nop 0
    buffer_load_dwordx4 v16, s[24:27], s45 offen offset:0 sc1 lds
    v_mfma_f32_16x16x32_bf16 v[168:171], v[40:43], v[32:35], v[168:171]
    v_mfma_f32_16x16x32_bf16 v[172:175], v[40:43], v[36:39], v[172:175]
    buffer_load_dwordx4 v16, s[24:27], s45 offen offset:1024 sc1 lds
    v_mfma_f32_16x16x32_bf16 v[176:179], v[44:47], v[24:27], v[176:179]
    v_mfma_f32_16x16x32_bf16 v[180:183], v[44:47], v[28:31], v[180:183]
    buffer_load_dwordx4 v16, s[24:27], s45 offen offset:2048 sc1 lds
    v_mfma_f32_16x16x32_bf16 v[184:187], v[44:47], v[32:35], v[184:187]
    v_mfma_f32_16x16x32_bf16 v[188:191], v[44:47], v[36:39], v[188:191]
    buffer_load_dwordx4 v16, s[24:27], s45 offen offset:3072 sc1 lds
    s_add_u32 s45, s45, 4096
    v_mfma_f32_16x16x32_bf16 v[192:195], v[48:51], v[24:27], v[192:195]
    v_mfma_f32_16x16x32_bf16 v[196:199], v[48:51], v[28:31], v[196:199]
    s_add_u32 m0, s41, 4096
    s_nop 0
    buffer_load_dwordx4 v152, s[16:19], s46 offen offset:0 lds
    v_mfma_f32_16x16x32_bf16 v[200:203], v[48:51], v[32:35], v[200:203]
    v_mfma_f32_16x16x32_bf16 v[204:207], v[48:51], v[36:39], v[204:207]
    buffer_load_dwordx4 v153, s[16:19], s46 offen offset:1024 lds
    v_mfma_f32_16x16x32_bf16 v[208:211], v[52:55], v[24:27], v[208:211]
    v_mfma_f32_16x16x32_bf16 v[212:215], v[52:55], v[28:31], v[212:215]
    buffer_load_dwordx4 v154, s[16:19], s46 offen offset:2048 lds
    v_mfma_f32_16x16x32_bf16 v[216:219], v[52:55], v[32:35], v[216:219]
    v_mfma_f32_16x16x32_bf16 v[220:223], v[52:55], v[36:39], v[220:223]
    buffer_load_dwordx4 v155, s[16:19], s46 offen offset:3072 lds
    v_mfma_f32_16x16x32_bf16 v[224:227], v[56:59], v[24:27], v[224:227]
    v_mfma_f32_16x16x32_bf16 v[228:231], v[56:59], v[28:31], v[228:231]
    s_add_u32 m0, s41, 8192
    s_nop 0
    buffer_load_dwordx4 v156, s[16:19], s46 offen lds
    s_add_u32 s46, s46, 40960
    v_mfma_f32_16x16x32_bf16 v[232:235], v[56:59], v[32:35], v[232:235]
    v_mfma_f32_16x16x32_bf16 v[236:239], v[56:59], v[36:39], v[236:239]
    s_barrier
    s_add_u32 m0, s58, 0
    s_nop 0
    buffer_load_dwordx4 v16, s[12:15], s44 offen offset:0 sc1 lds
    buffer_load_dwordx4 v16, s[12:15], s44 offen offset:1024 sc1 lds
    buffer_load_dwordx4 v16, s[12:15], s44 offen offset:2048 sc1 lds
    buffer_load_dwordx4 v16, s[12:15], s44 offen offset:3072 sc1 lds
    s_add_u32 m0, m0, 4096
    s_nop 0
    buffer_load_dwordx4 v13, s[12:15], s44 offen sc1 lds
    s_mov_b64 exec, 0xffff
    buffer_load_dwordx4 v13, s[12:15], s44 offen offset:1024 sc1 lds
    s_mov_b64 exec, -1
    s_add_u32 s44, s44, 86016
    s_waitcnt vmcnt(15)
    ds_read_b128 v[24:27], v141 offset:9216
    ds_read_b128 v[28:31], v142 offset:9216
    ds_read_b128 v[32:35], v143 offset:9216
    ds_read_b128 v[36:39], v144 offset:9216
    ds_read_b64_tr_b16 v[40:41], v157 offset:9216
    ds_read_b64_tr_b16 v[42:43], v157 offset:9856
    ds_read_b64_tr_b16 v[44:45], v157 offset:9248
    ds_read_b64_tr_b16 v[46:47], v157 offset:9888
    ds_read_b64_tr_b16 v[48:49], v157 offset:9280
    ds_read_b64_tr_b16 v[50:51], v157 offset:9920
    ds_read_b64_tr_b16 v[52:53], v157 offset:9312
    ds_read_b64_tr_b16 v[54:55], v157 offset:9952
    ds_read_b64_tr_b16 v[56:57], v157 offset:9344
    ds_read_b64_tr_b16 v[58:59], v157 offset:9984
    s_waitcnt lgkmcnt(0)
    v_mfma_f32_16x16x32_bf16 v[160:163], v[40:43], v[24:27], v[160:163]
    v_mfma_f32_16x16x32_bf16 v[164:167], v[40:43], v[28:31], v[164:167]
    s_add_u32 m0, s41, 9216
    s_nop 0
    buffer_load_dwordx4 v16, s[24:27], s45 offen offset:0 sc1 lds
    v_mfma_f32_16x16x32_bf16 v[168:171], v[40:43], v[32:35], v[168:171]
    v_mfma_f32_16x16x32_bf16 v[172:175], v[40:43], v[36:39], v[172:175]
    buffer_load_dwordx4 v16, s[24:27], s45 offen offset:1024 sc1 lds
    v_mfma_f32_16x16x32_bf16 v[176:179], v[44:47], v[24:27], v[176:179]
    v_mfma_f32_16x16x32_bf16 v[180:183], v[44:47], v[28:31], v[180:183]
    buffer_load_dwordx4 v16, s[24:27], s45 offen offset:2048 sc1 lds
    v_mfma_f32_16x16x32_bf16 v[184:187], v[44:47], v[32:35], v[184:187]
    v_mfma_f32_16x16x32_bf16 v[188:191], v[44:47], v[36:39], v[188:191]
    buffer_load_dwordx4 v16, s[24:27], s45 offen offset:3072 sc1 lds
    s_add_u32 s45, s45, 4096
    v_mfma_f32_16x16x32_bf16 v[192:195], v[48:51], v[24:27], v[192:195]
    v_mfma_f32_16x16x32_bf16 v[196:199], v[48:51], v[28:31], v[196:199]
    s_add_u32 m0, s41, 13312
    s_nop 0
    buffer_load_dwordx4 v152, s[16:19], s46 offen offset:0 lds
    v_mfma_f32_16x16x32_bf16 v[200:203], v[48:51], v[32:35], v[200:203]
    v_mfma_f32_16x16x32_bf16 v[204:207], v[48:51], v[36:39], v[204:207]
    buffer_load_dwordx4 v153, s[16:19], s46 offen offset:1024 lds
    v_mfma_f32_16x16x32_bf16 v[208:211], v[52:55], v[24:27], v[208:211]
    v_mfma_f32_16x16x32_bf16 v[212:215], v[52:55], v[28:31], v[212:215]
    buffer_load_dwordx4 v154, s[16:19], s46 offen offset:2048 lds
    v_mfma_f32_16x16x32_bf16 v[216:219], v[52:55], v[32:35], v[216:219]
    v_mfma_f32_16x16x32_bf16 v[220:223], v[52:55], v[36:39], v[220:223]
    buffer_load_dwordx4 v155, s[16:19], s46 offen offset:3072 lds
    v_mfma_f32_16x16x32_bf16 v[224:227], v[56:59], v[24:27], v[224:227]
    v_mfma_f32_16x16x32_bf16 v[228:231], v[56:59], v[28:31], v[228:231]
    s_add_u32 m0, s41, 17408
    s_nop 0
    buffer_load_dwordx4 v156, s[16:19], s46 offen lds
    s_add_u32 s46, s46, 40960
    s_branch PADX_13
PAD_13:
    s_branch PAD_END
PADX_13:
    v_mfma_f32_16x16x32_bf16 v[232:235], v[56:59], v[32:35], v[232:235]
    v_mfma_f32_16x16x32_bf16 v[236:239], v[56:59], v[36:39], v[236:239]
    s_waitcnt vmcnt(15)
    ds_read_b128 v[24:27], v141 offset:0
    ds_read_b128 v[28:31], v142 offset:0
    ds_read_b128 v[32:35], v143 offset:0
    ds_read_b128 v[36:39], v144 offset:0
    ds_read_b64_tr_b16 v[40:41], v157 offset:0
    ds_read_b64_tr_b16 v[42:43], v157 offset:640
    ds_read_b64_tr_b16 v[44:45], v157 offset:32
    ds_read_b64_tr_b16 v[46:47], v157 offset:672
    ds_read_b64_tr_b16 v[48:49], v157 offset:64
    ds_read_b64_tr_b16 v[50:51], v157 offset:704
    ds_read_b64_tr_b16 v[52:53], v157 offset:96
    ds_read_b64_tr_b16 v[54:55], v157 offset:736
    ds_read_b64_tr_b16 v[56:57], v157 offset:128
    ds_read_b64_tr_b16 v[58:59], v157 offset:768
    s_waitcnt lgkmcnt(0)
    v_mfma_f32_16x16x32_bf16 v[160:163], v[40:43], v[24:27], v[160:163]
    v_mfma_f32_16x16x32_bf16 v[164:167], v[40:43], v[28:31], v[164:167]
    s_add_u32 m0, s41, 0
    s_nop 0
    buffer_load_dwordx4 v16, s[24:27], s45 offen offset:0 sc1 lds
    v_mfma_f32_16x16x32_bf16 v[168:171], v[40:43], v[32:35], v[168:171]
    v_mfma_f32_16x16x32_bf16 v[172:175], v[40:43], v[36:39], v[172:175]
    buffer_load_dwordx4 v16, s[24:27], s45 offen offset:1024 sc1 lds
    v_mfma_f32_16x16x32_bf16 v[176:179], v[44:47], v[24:27], v[176:179]
    v_mfma_f32_16x16x32_bf16 v[180:183], v[44:47], v[28:31], v[180:183]
    buffer_load_dwordx4 v16, s[24:27], s45 offen offset:2048 sc1 lds
    v_mfma_f32_16x16x32_bf16 v[184:187], v[44:47], v[32:35], v[184:187]
    v_mfma_f32_16x16x32_bf16 v[188:191], v[44:47], v[36:39], v[188:191]
    buffer_load_dwordx4 v16, s[24:27], s45 offen offset:3072 sc1 lds
    s_add_u32 s45, s45, 4096
    v_mfma_f32_16x16x32_bf16 v[192:195], v[48:51], v[24:27], v[192:195]
    v_mfma_f32_16x16x32_bf16 v[196:199], v[48:51], v[28:31], v[196:199]
    s_add_u32 m0, s41, 4096
    s_nop 0
    buffer_load_dwordx4 v152, s[16:19], s46 offen offset:0 lds
    v_mfma_f32_16x16x32_bf16 v[200:203], v[48:51], v[32:35], v[200:203]
    v_mfma_f32_16x16x32_bf16 v[204:207], v[48:51], v[36:39], v[204:207]
    buffer_load_dwordx4 v153, s[16:19], s46 offen offset:1024 lds
    v_mfma_f32_16x16x32_bf16 v[208:211], v[52:55], v[24:27], v[208:211]
    v_mfma_f32_16x16x32_bf16 v[212:215], v[52:55], v[28:31], v[212:215]
    buffer_load_dwordx4 v154, s[16:19], s46 offen offset:2048 lds
    v_mfma_f32_16x16x32_bf16 v[216:219], v[52:55], v[32:35], v[216:219]
    v_mfma_f32_16x16x32_bf16 v[220:223], v[52:55], v[36:39], v[220:223]
    buffer_load_dwordx4 v155, s[16:19], s46 offen offset:3072 lds
    v_mfma_f32_16x16x32_bf16 v[224:227], v[56:59], v[24:27], v[224:227]
    v_mfma_f32_16x16x32_bf16 v[228:231], v[56:59], v[28:31], v[228:231]
    s_add_u32 m0, s41, 8192
    s_nop 0
    buffer_load_dwordx4 v156, s[16:19], s46 offen lds
    s_add_u32 s46, s46, 40960
    v_mfma_f32_16x16x32_bf16 v[232:235], v[56:59], v[32:35], v[232:235]
    v_mfma_f32_16x16x32_bf16 v[236:239], v[56:59], v[36:39], v[236:239]
    s_waitcnt vmcnt(9)
    ds_read_b128 v[24:27], v141 offset:9216
    ds_read_b128 v[28:31], v142 offset:9216
    ds_read_b128 v[32:35], v143 offset:9216
    ds_read_b128 v[36:39], v144 offset:9216
    ds_read_b64_tr_b16 v[40:41], v157 offset:9216
    ds_read_b64_tr_b16 v[42:43], v157 offset:9856
    ds_read_b64_tr_b16 v[44:45], v157 offset:9248
    ds_read_b64_tr_b16 v[46:47], v157 offset:9888
    ds_read_b64_tr_b16 v[48:49], v157 offset:9280
    ds_read_b64_tr_b16 v[50:51], v157 offset:9920
    ds_read_b64_tr_b16 v[52:53], v157 offset:9312
    ds_read_b64_tr_b16 v[54:55], v157 offset:9952
    ds_read_b64_tr_b16 v[56:57], v157 offset:9344
    ds_read_b64_tr_b16 v[58:59], v157 offset:9984
    s_waitcnt lgkmcnt(0)
    v_mfma_f32_16x16x32_bf16 v[160:163], v[40:43], v[24:27], v[160:163]
    v_mfma_f32_16x16x32_bf16 v[164:167], v[40:43], v[28:31], v[164:167]
    s_add_u32 m0, s41, 9216
    s_nop 0
    buffer_load_dwordx4 v16, s[24:27], s45 offen offset:0 sc1 lds
    v_mfma_f32_16x16x32_bf16 v[168:171], v[40:43], v[32:35], v[168:171]
    v_mfma_f32_16x16x32_bf16 v[172:175], v[40:43], v[36:39], v[172:175]
    buffer_load_dwordx4 v16, s[24:27], s45 offen offset:1024 sc1 lds
    v_mfma_f32_16x16x32_bf16 v[176:179], v[44:47], v[24:27], v[176:179]
    v_mfma_f32_16x16x32_bf16 v[180:183], v[44:47], v[28:31], v[180:183]
    buffer_load_dwordx4 v16, s[24:27], s45 offen offset:2048 sc1 lds
    v_mfma_f32_16x16x32_bf16 v[184:187], v[44:47], v[32:35], v[184:187]
    v_mfma_f32_16x16x32_bf16 v[188:191], v[44:47], v[36:39], v[188:191]
    buffer_load_dwordx4 v16, s[24:27], s45 offen offset:3072 sc1 lds
    s_add_u32 s45, s45, 4096
    v_mfma_f32_16x16x32_bf16 v[192:195], v[48:51], v[24:27], v[192:195]
    v_mfma_f32_16x16x32_bf16 v[196:199], v[48:51], v[28:31], v[196:199]
    s_add_u32 m0, s41, 13312
    s_nop 0
    buffer_load_dwordx4 v152, s[16:19], s46 offen offset:0 lds
    v_mfma_f32_16x16x32_bf16 v[200:203], v[48:51], v[32:35], v[200:203]
    v_mfma_f32_16x16x32_bf16 v[204:207], v[48:51], v[36:39], v[204:207]
    buffer_load_dwordx4 v153, s[16:19], s46 offen offset:1024 lds
    v_mfma_f32_16x16x32_bf16 v[208:211], v[52:55], v[24:27], v[208:211]
    v_mfma_f32_16x16x32_bf16 v[212:215], v[52:55], v[28:31], v[212:215]
    buffer_load_dwordx4 v154, s[16:19], s46 offen offset:2048 lds
    v_mfma_f32_16x16x32_bf16 v[216:219], v[52:55], v[32:35], v[216:219]
    v_mfma_f32_16x16x32_bf16 v[220:223], v[52:55], v[36:39], v[220:223]
    buffer_load_dwordx4 v155, s[16:19], s46 offen offset:3072 lds
    v_mfma_f32_16x16x32_bf16 v[224:227], v[56:59], v[24:27], v[224:227]
    v_mfma_f32_16x16x32_bf16 v[228:231], v[56:59], v[28:31], v[228:231]
    s_add_u32 m0, s41, 17408
    s_nop 0
    buffer_load_dwordx4 v156, s[16:19], s46 offen lds
    s_add_u32 s46, s46, 40960
    v_mfma_f32_16x16x32_bf16 v[232:235], v[56:59], v[32:35], v[232:235]
    v_mfma_f32_16x16x32_bf16 v[236:239], v[56:59], v[36:39], v[236:239]
    s_barrier
    s_add_u32 m0, s58, 21504
    s_nop 0
    buffer_load_dwordx4 v16, s[12:15], s44 offen offset:0 sc1 lds
    buffer_load_dwordx4 v16, s[12:15], s44 offen offset:1024 sc1 lds
    buffer_load_dwordx4 v16, s[12:15], s44 offen offset:2048 sc1 lds
    buffer_load_dwordx4 v16, s[12:15], s44 offen offset:3072 sc1 lds
    s_add_u32 m0, m0, 4096
    s_nop 0
    buffer_load_dwordx4 v13, s[12:15], s44 offen sc1 lds
    s_mov_b64 exec, 0xffff
    buffer_load_dwordx4 v13, s[12:15], s44 offen offset:1024 sc1 lds
    s_mov_b64 exec, -1
    s_sub_u32 s44, s44, 64512
    s_waitcnt vmcnt(15)
    ds_read_b128 v[24:27], v141 offset:0
    ds_read_b128 v[28:31], v142 offset:0
    ds_read_b128 v[32:35], v143 offset:0
    ds_read_b128 v[36:39], v144 offset:0
    ds_read_b64_tr_b16 v[40:41], v157 offset:0
    ds_read_b64_tr_b16 v[42:43], v157 offset:640
    ds_read_b64_tr_b16 v[44:45], v157 offset:32
    ds_read_b64_tr_b16 v[46:47], v157 offset:672
    ds_read_b64_tr_b16 v[48:49], v157 offset:64
    ds_read_b64_tr_b16 v[50:51], v157 offset:704
    ds_read_b64_tr_b16 v[52:53], v157 offset:96
    ds_read_b64_tr_b16 v[54:55], v157 offset:736
    ds_read_b64_tr_b16 v[56:57], v157 offset:128
    ds_read_b64_tr_b16 v[58:59], v157 offset:768
    s_waitcnt lgkmcnt(0)
    v_mfma_f32_16x16x32_bf16 v[160:163], v[40:43], v[24:27], v[160:163]
    v_mfma_f32_16x16x32_bf16 v[164:167], v[40:43], v[28:31], v[164:167]
    s_add_u32 m0, s41, 0
    s_nop 0
    buffer_load_dwordx4 v16, s[24:27], s45 offen offset:0 sc1 lds
    v_mfma_f32_16x16x32_bf16 v[168:171], v[40:43], v[32:35], v[168:171]
    v_mfma_f32_16x16x32_bf16 v[172:175], v[40:43], v[36:39], v[172:175]
    buffer_load_dwordx4 v16, s[24:27], s45 offen offset:1024 sc1 lds
    v_mfma_f32_16x16x32_bf16 v[176:179], v[44:47], v[24:27], v[176:179]
    v_mfma_f32_16x16x32_bf16 v[180:183], v[44:47], v[28:31], v[180:183]
    buffer_load_dwordx4 v16, s[24:27], s45 offen offset:2048 sc1 lds
    v_mfma_f32_16x16x32_bf16 v[184:187], v[44:47], v[32:35], v[184:187]
    v_mfma_f32_16x16x32_bf16 v[188:191], v[44:47], v[36:39], v[188:191]
    buffer_load_dwordx4 v16, s[24:27], s45 offen offset:3072 sc1 lds
    s_add_u32 s45, s45, 4096
    v_mfma_f32_16x16x32_bf16 v[192:195], v[48:51], v[24:27], v[192:195]
    v_mfma_f32_16x16x32_bf16 v[196:199], v[48:51], v[28:31], v[196:199]
    s_add_u32 m0, s41, 4096
    s_nop 0
    buffer_load_dwordx4 v152, s[16:19], s46 offen offset:0 lds
    v_mfma_f32_16x16x32_bf16 v[200:203], v[48:51], v[32:35], v[200:203]
    v_mfma_f32_16x16x32_bf16 v[204:207], v[48:51], v[36:39], v[204:207]
    buffer_load_dwordx4 v153, s[16:19], s46 offen offset:1024 lds
    v_mfma_f32_16x16x32_bf16 v[208:211], v[52:55], v[24:27], v[208:211]
    v_mfma_f32_16x16x32_bf16 v[212:215], v[52:55], v[28:31], v[212:215]
    buffer_load_dwordx4 v154, s[16:19], s46 offen offset:2048 lds
    v_mfma_f32_16x16x32_bf16 v[216:219], v[52:55], v[32:35], v[216:219]
    v_mfma_f32_16x16x32_bf16 v[220:223], v[52:55], v[36:39], v[220:223]
    buffer_load_dwordx4 v155, s[16:19], s46 offen offset:3072 lds
    v_mfma_f32_16x16x32_bf16 v[224:227], v[56:59], v[24:27], v[224:227]
    v_mfma_f32_16x16x32_bf16 v[228:231], v[56:59], v[28:31], v[228:231]
    s_add_u32 m0, s41, 8192
    s_nop 0
    buffer_load_dwordx4 v156, s[16:19], s46 offen lds
    s_add_u32 s46, s46, 40960
    v_mfma_f32_16x16x32_bf16 v[232:235], v[56:59], v[32:35], v[232:235]
    v_mfma_f32_16x16x32_bf16 v[236:239], v[56:59], v[36:39], v[236:239]
    s_waitcnt vmcnt(15)
    ds_read_b128 v[24:27], v141 offset:9216
    ds_read_b128 v[28:31], v142 offset:9216
    ds_read_b128 v[32:35], v143 offset:9216
    ds_read_b128 v[36:39], v144 offset:9216
    ds_read_b64_tr_b16 v[40:41], v157 offset:9216
    ds_read_b64_tr_b16 v[42:43], v157 offset:9856
    ds_read_b64_tr_b16 v[44:45], v157 offset:9248
    ds_read_b64_tr_b16 v[46:47], v157 offset:9888
    ds_read_b64_tr_b16 v[48:49], v157 offset:9280
    ds_read_b64_tr_b16 v[50:51], v157 offset:9920
    ds_read_b64_tr_b16 v[52:53], v157 offset:9312
    ds_read_b64_tr_b16 v[54:55], v157 offset:9952
    ds_read_b64_tr_b16 v[56:57], v157 offset:9344
    ds_read_b64_tr_b16 v[58:59], v157 offset:9984
    s_waitcnt lgkmcnt(0)
    v_mfma_f32_16x16x32_bf16 v[160:163], v[40:43], v[24:27], v[160:163]
    v_mfma_f32_16x16x32_bf16 v[164:167], v[40:43], v[28:31], v[164:167]
    s_add_u32 m0, s41, 9216
    s_nop 0
    buffer_load_dwordx4 v16, s[24:27], s45 offen offset:0 sc1 lds
    v_mfma_f32_16x16x32_bf16 v[168:171], v[40:43], v[32:35], v[168:171]
    v_mfma_f32_16x16x32_bf16 v[172:175], v[40:43], v[36:39], v[172:175]
    buffer_load_dwordx4 v16, s[24:27], s45 offen offset:1024 sc1 lds
    v_mfma_f32_16x16x32_bf16 v[176:179], v[44:47], v[24:27], v[176:179]
    v_mfma_f32_16x16x32_bf16 v[180:183], v[44:47], v[28:31], v[180:183]
    buffer_load_dwordx4 v16, s[24:27], s45 offen offset:2048 sc1 lds
    v_mfma_f32_16x16x32_bf16 v[184:187], v[44:47], v[32:35], v[184:187]
    v_mfma_f32_16x16x32_bf16 v[188:191], v[44:47], v[36:39], v[188:191]
    buffer_load_dwordx4 v16, s[24:27], s45 offen offset:3072 sc1 lds
    s_add_u32 s45, s45, 4096
    v_mfma_f32_16x16x32_bf16 v[192:195], v[48:51], v[24:27], v[192:195]
    v_mfma_f32_16x16x32_bf16 v[196:199], v[48:51], v[28:31], v[196:199]
    s_add_u32 m0, s41, 13312
    s_nop 0
    buffer_load_dwordx4 v152, s[16:19], s46 offen offset:0 lds
    v_mfma_f32_16x16x32_bf16 v[200:203], v[48:51], v[32:35], v[200:203]
    v_mfma_f32_16x16x32_bf16 v[204:207], v[48:51], v[36:39], v[204:207]
    buffer_load_dwordx4 v153, s[16:19], s46 offen offset:1024 lds
    v_mfma_f32_16x16x32_bf16 v[208:211], v[52:55], v[24:27], v[208:211]
    v_mfma_f32_16x16x32_bf16 v[212:215], v[52:55], v[28:31], v[212:215]
    buffer_load_dwordx4 v154, s[16:19], s46 offen offset:2048 lds
    v_mfma_f32_16x16x32_bf16 v[216:219], v[52:55], v[32:35], v[216:219]
    v_mfma_f32_16x16x32_bf16 v[220:223], v[52:55], v[36:39], v[220:223]
    buffer_load_dwordx4 v155, s[16:19], s46 offen offset:3072 lds
    v_mfma_f32_16x16x32_bf16 v[224:227], v[56:59], v[24:27], v[224:227]
    v_mfma_f32_16x16x32_bf16 v[228:231], v[56:59], v[28:31], v[228:231]
    s_add_u32 m0, s41, 17408
    s_nop 0
    buffer_load_dwordx4 v156, s[16:19], s46 offen lds
    s_add_u32 s46, s46, 40960
    v_mfma_f32_16x16x32_bf16 v[232:235], v[56:59], v[32:35], v[232:235]
    v_mfma_f32_16x16x32_bf16 v[236:239], v[56:59], v[36:39], v[236:239]
    s_waitcnt vmcnt(9)
    ds_read_b128 v[24:27], v141 offset:0
    ds_read_b128 v[28:31], v142 offset:0
    ds_read_b128 v[32:35], v143 offset:0
    ds_read_b128 v[36:39], v144 offset:0
    ds_read_b64_tr_b16 v[40:41], v157 offset:0
    ds_read_b64_tr_b16 v[42:43], v157 offset:640
    ds_read_b64_tr_b16 v[44:45], v157 offset:32
    ds_read_b64_tr_b16 v[46:47], v157 offset:672
    ds_read_b64_tr_b16 v[48:49], v157 offset:64
    ds_read_b64_tr_b16 v[50:51], v157 offset:704
    ds_read_b64_tr_b16 v[52:53], v157 offset:96
    ds_read_b64_tr_b16 v[54:55], v157 offset:736
    ds_read_b64_tr_b16 v[56:57], v157 offset:128
    ds_read_b64_tr_b16 v[58:59], v157 offset:768
    s_waitcnt lgkmcnt(0)
    v_mfma_f32_16x16x32_bf16 v[160:163], v[40:43], v[24:27], v[160:163]
    v_mfma_f32_16x16x32_bf16 v[164:167], v[40:43], v[28:31], v[164:167]
    v_mfma_f32_16x16x32_bf16 v[168:171], v[40:43], v[32:35], v[168:171]
    v_mfma_f32_16x16x32_bf16 v[172:175], v[40:43], v[36:39], v[172:175]
    v_mfma_f32_16x16x32_bf16 v[176:179], v[44:47], v[24:27], v[176:179]
    v_mfma_f32_16x16x32_bf16 v[180:183], v[44:47], v[28:31], v[180:183]
    v_mfma_f32_16x16x32_bf16 v[184:187], v[44:47], v[32:35], v[184:187]
    v_mfma_f32_16x16x32_bf16 v[188:191], v[44:47], v[36:39], v[188:191]
    v_mfma_f32_16x16x32_bf16 v[192:195], v[48:51], v[24:27], v[192:195]
    v_mfma_f32_16x16x32_bf16 v[196:199], v[48:51], v[28:31], v[196:199]
    v_mfma_f32_16x16x32_bf16 v[200:203], v[48:51], v[32:35], v[200:203]
    v_mfma_f32_16x16x32_bf16 v[204:207], v[48:51], v[36:39], v[204:207]
    v_mfma_f32_16x16x32_bf16 v[208:211], v[52:55], v[24:27], v[208:211]
    v_mfma_f32_16x16x32_bf16 v[212:215], v[52:55], v[28:31], v[212:215]
    v_mfma_f32_16x16x32_bf16 v[216:219], v[52:55], v[32:35], v[216:219]
    v_mfma_f32_16x16x32_bf16 v[220:223], v[52:55], v[36:39], v[220:223]
    v_mfma_f32_16x16x32_bf16 v[224:227], v[56:59], v[24:27], v[224:227]
    v_mfma_f32_16x16x32_bf16 v[228:231], v[56:59], v[28:31], v[228:231]
    v_mfma_f32_16x16x32_bf16 v[232:235], v[56:59], v[32:35], v[232:235]
    v_mfma_f32_16x16x32_bf16 v[236:239], v[56:59], v[36:39], v[236:239]
    s_barrier
    s_waitcnt vmcnt(0)
    s_cmp_ge_u32 s38, 2
    s_cbranch_scc1 K2_FSKIP
    ds_read_b128 v[24:27], v141 offset:9216
    ds_read_b128 v[28:31], v142 offset:9216
    ds_read_b128 v[32:35], v143 offset:9216
    ds_read_b128 v[36:39], v144 offset:9216
    ds_read_b64_tr_b16 v[40:41], v157 offset:9216
    ds_read_b64_tr_b16 v[42:43], v157 offset:9856
    ds_read_b64_tr_b16 v[44:45], v157 offset:9248
    ds_read_b64_tr_b16 v[46:47], v157 offset:9888
    ds_read_b64_tr_b16 v[48:49], v157 offset:9280
    ds_read_b64_tr_b16 v[50:51], v157 offset:9920
    ds_read_b64_tr_b16 v[52:53], v157 offset:9312
    ds_read_b64_tr_b16 v[54:55], v157 offset:9952
    ds_read_b64_tr_b16 v[56:57], v157 offset:9344
    ds_read_b64_tr_b16 v[58:59], v157 offset:9984
    s_waitcnt lgkmcnt(0)
    v_mfma_f32_16x16x32_bf16 v[160:163], v[40:43], v[24:27], v[160:163]
    v_mfma_f32_16x16x32_bf16 v[164:167], v[40:43], v[28:31], v[164:167]
    v_mfma_f32_16x16x32_bf16 v[168:171], v[40:43], v[32:35], v[168:171]
    v_mfma_f32_16x16x32_bf16 v[172:175], v[40:43], v[36:39], v[172:175]
    v_mfma_f32_16x16x32_bf16 v[176:179], v[44:47], v[24:27], v[176:179]
    v_mfma_f32_16x16x32_bf16 v[180:183], v[44:47], v[28:31], v[180:183]
    v_mfma_f32_16x16x32_bf16 v[184:187], v[44:47], v[32:35], v[184:187]
    v_mfma_f32_16x16x32_bf16 v[188:191], v[44:47], v[36:39], v[188:191]
    v_mfma_f32_16x16x32_bf16 v[192:195], v[48:51], v[24:27], v[192:195]
    v_mfma_f32_16x16x32_bf16 v[196:199], v[48:51], v[28:31], v[196:199]
    v_mfma_f32_16x16x32_bf16 v[200:203], v[48:51], v[32:35], v[200:203]
    v_mfma_f32_16x16x32_bf16 v[204:207], v[48:51], v[36:39], v[204:207]
    v_mfma_f32_16x16x32_bf16 v[208:211], v[52:55], v[24:27], v[208:211]
    v_mfma_f32_16x16x32_bf16 v[212:215], v[52:55], v[28:31], v[212:215]
    v_mfma_f32_16x16x32_bf16 v[216:219], v[52:55], v[32:35], v[216:219]
    v_mfma_f32_16x16x32_bf16 v[220:223], v[52:55], v[36:39], v[220:223]
    v_mfma_f32_16x16x32_bf16 v[224:227], v[56:59], v[24:27], v[224:227]
    v_mfma_f32_16x16x32_bf16 v[228:231], v[56:59], v[28:31], v[228:231]
    v_mfma_f32_16x16x32_bf16 v[232:235], v[56:59], v[32:35], v[232:235]
    v_mfma_f32_16x16x32_bf16 v[236:239], v[56:59], v[36:39], v[236:239]
K2_FSKIP:
    s_lshl_b32 s56, s38, 2
    s_add_u32 s56, s56, 0
    s_add_u32 s57, s41, 0
    s_mul_i32 s56, s56, 40960
    s_add_u32 m0, s57, 0
    s_nop 0
    buffer_load_dwordx4 v240, s[52:55], s56 offen lds
    s_add_u32 m0, s57, 1024
    s_nop 0
    buffer_load_dwordx4 v241, s[52:55], s56 offen lds
    s_add_u32 m0, s57, 2048
    s_nop 0
    buffer_load_dwordx4 v242, s[52:55], s56 offen lds
    s_add_u32 m0, s57, 3072
    s_nop 0
    buffer_load_dwordx4 v243, s[52:55], s56 offen lds
    s_add_u32 m0, s57, 4096
    s_nop 0
    buffer_load_dwordx4 v244, s[52:55], s56 offen lds
    s_lshl_b32 s56, s38, 2
    s_add_u32 s56, s56, 1
    s_add_u32 s57, s41, 5120
    s_mul_i32 s56, s56, 40960
    s_add_u32 m0, s57, 0
    s_nop 0
    buffer_load_dwordx4 v240, s[52:55], s56 offen lds
    s_add_u32 m0, s57, 1024
    s_nop 0
    buffer_load_dwordx4 v241, s[52:55], s56 offen lds
    s_add_u32 m0, s57, 2048
    s_nop 0
    buffer_load_dwordx4 v242, s[52:55], s56 offen lds
    s_add_u32 m0, s57, 3072
    s_nop 0
    buffer_load_dwordx4 v243, s[52:55], s56 offen lds
    s_add_u32 m0, s57, 4096
    s_nop 0
    buffer_load_dwordx4 v244, s[52:55], s56 offen lds
    s_lshl_b32 s56, s38, 2
    s_add_u32 s56, s56, 2
    s_add_u32 s57, s41, 10240
    s_mul_i32 s56, s56, 40960
    s_add_u32 m0, s57, 0
    s_nop 0
    buffer_load_dwordx4 v240, s[52:55], s56 offen lds
    s_add_u32 m0, s57, 1024
    s_nop 0
    buffer_load_dwordx4 v241, s[52:55], s56 offen lds
    s_add_u32 m0, s57, 2048
    s_nop 0
    buffer_load_dwordx4 v242, s[52:55], s56 offen lds
    s_add_u32 m0, s57, 3072
    s_nop 0
    buffer_load_dwordx4 v243, s[52:55], s56 offen lds
    s_add_u32 m0, s57, 4096
    s_nop 0
    buffer_load_dwordx4 v244, s[52:55], s56 offen lds
    s_lshl_b32 s56, s38, 2
    s_add_u32 s56, s56, 3
    s_add_u32 s57, s41, 15360
    s_mul_i32 s56, s56, 40960
    s_add_u32 m0, s57, 0
    s_nop 0
    buffer_load_dwordx4 v240, s[52:55], s56 offen lds
    s_add_u32 m0, s57, 1024
    s_nop 0
    buffer_load_dwordx4 v241, s[52:55], s56 offen lds
    s_add_u32 m0, s57, 2048
    s_nop 0
    buffer_load_dwordx4 v242, s[52:55], s56 offen lds
    s_add_u32 m0, s57, 3072
    s_nop 0
    buffer_load_dwordx4 v243, s[52:55], s56 offen lds
    s_add_u32 m0, s57, 4096
    s_nop 0
    buffer_load_dwordx4 v244, s[52:55], s56 offen lds
    s_add_u32 s56, s38, 16
    s_mul_i32 s57, s38, 5120
    s_add_u32 s57, s57, 44032
    s_mul_i32 s56, s56, 40960
    s_add_u32 m0, s57, 0
    s_nop 0
    buffer_load_dwordx4 v240, s[52:55], s56 offen lds
    s_add_u32 m0, s57, 1024
    s_nop 0
    buffer_load_dwordx4 v241, s[52:55], s56 offen lds
    s_add_u32 m0, s57, 2048
    s_nop 0
    buffer_load_dwordx4 v242, s[52:55], s56 offen lds
    s_add_u32 m0, s57, 3072
    s_nop 0
    buffer_load_dwordx4 v243, s[52:55], s56 offen lds
    s_add_u32 m0, s57, 4096
    s_nop 0
    buffer_load_dwordx4 v244, s[52:55], s56 offen lds
    s_barrier
    s_add_u32 s20, s8, 20971520
    s_addc_u32 s21, s9, 0
    s_and_b32 s21, s21, 0xffff
    s_mov_b32 s22, 2621440
    s_mov_b32 s23, 0x00020000
    s_mul_i32 s60, s38, 10240
    v_add_u32 v148, s60, v16
    s_xor_b32 s60, s38, 2
    s_mul_i32 s60, s60, 10240
    v_add_u32 v149, s60, v16
    s_xor_b32 s60, s38, 3
    s_mul_i32 s60, s60, 10240
    v_add_u32 v150, s60, v16
    s_mul_i32 s60, s38, 2560
    s_add_u32 s60, s60, 146432
    v_lshlrev_b32 v2, 3, v1
    v_add_u32 v151, s60, v2
    s_add_u32 s38, s38, 4
    s_mov_b32 s39, 0
    s_load_dwordx2 s[4:5], s[0:1], 56
    s_add_u32 s32, s8, 25165824
    s_addc_u32 s33, s9, 0
    s_and_b32 s33, s33, 0xffff
    s_mov_b32 s34, 8192
    s_mov_b32 s35, 0x00020000
    buffer_load_dword v18, v255, s[32:35], 0 offen sc1
    s_add_u32 s24, s8, 41943040
    s_addc_u32 s25, s9, 0
    s_and_b32 s25, s25, 0xffff
    s_mov_b32 s26, 65536
    s_mov_b32 s27, 0x00020000
    s_lshr_b32 s60, s2, 6
    s_lshl_b32 s60, s60, 2
    s_bfe_u32 s61, s2, 0x20001
    s_add_u32 s60, s60, s61
    s_bfe_u32 s61, s2, 0x10005
    s_lshl_b32 s61, s61, 4
    s_add_u32 s62, s60, s61
    s_and_b32 s60, s2, 1
    s_lshl_b32 s60, s60, 2
    s_bfe_u32 s61, s2, 0x20003
    s_add_u32 s63, s60, s61
    s_lshl_b32 s66, s62, 2
    s_add_u32 s66, s66, s38
    s_mul_i32 s66, s66, 20480
    s_sub_u32 s66, s66, 79872
    s_lshl_b32 s67, s62, 3
    s_add_u32 s67, s67, s63
    s_lshl_b32 s67, s67, 8
    s_waitcnt lgkmcnt(0)
    s_mov_b32 s16, s4
    s_and_b32 s17, s5, 0xffff
    s_mov_b32 s18, 2621440
    s_mov_b32 s19, 0x00020000
    s_setprio 0
K2_FB8:
    s_waitcnt vmcnt(0)
    s_barrier
    ds_write_b128 v148, v[168:171] offset:0
    ds_write_b128 v148, v[172:175] offset:1024
    ds_write_b128 v148, v[184:187] offset:2048
    ds_write_b128 v148, v[188:191] offset:3072
    ds_write_b128 v148, v[200:203] offset:4096
    ds_write_b128 v148, v[204:207] offset:5120
    ds_write_b128 v148, v[216:219] offset:6144
    ds_write_b128 v148, v[220:223] offset:7168
    ds_write_b128 v148, v[232:235] offset:8192
    ds_write_b128 v148, v[236:239] offset:9216
    v_sub_f32 v17, 1.0, v18
    v_cvt_pk_bf16_f32 v17, v17, v17
    v_lshlrev_b32 v17, 16, v17
    v_mov_b32 v4, 159744
    v_mov_b32 v20, 0
    s_waitcnt lgkmcnt(0)
    ds_read_b64_tr_b16 v[84:85], v245 offset:20480
    ds_read_b64_tr_b16 v[86:87], v246 offset:20480
    ds_read_b64_tr_b16 v[88:89], v245 offset:20512
    ds_read_b64_tr_b16 v[90:91], v246 offset:20512
    ds_read_b64_tr_b16 v[92:93], v245 offset:20544
    ds_read_b64_tr_b16 v[94:95], v246 offset:20544
    ds_read_b64_tr_b16 v[96:97], v245 offset:20576
    ds_read_b64_tr_b16 v[98:99], v246 offset:20576
    ds_read_b64_tr_b16 v[100:101], v245 offset:20608
    ds_read_b64_tr_b16 v[102:103], v246 offset:20608
    s_barrier
    ds_read_b32 v2, v4
    ds_read_b128 v[24:27], v149 offset:0
    ds_read_b128 v[28:31], v149 offset:1024
    ds_read_b128 v[32:35], v149 offset:2048
    ds_read_b128 v[36:39], v149 offset:3072
    ds_read_b128 v[40:43], v149 offset:4096
    ds_read_b128 v[44:47], v149 offset:5120
    ds_read_b128 v[48:51], v149 offset:6144
    ds_read_b128 v[52:55], v149 offset:7168
    ds_read_b128 v[56:59], v149 offset:8192
    ds_read_b128 v[60:63], v149 offset:9216
    s_waitcnt lgkmcnt(10)
    v_readfirstlane_b32 s47, v2
    s_andn2_b32 s47, s47, s39
    s_cmp_lg_u32 s47, 0
    s_cbranch_scc1 K2_SERV
    s_waitcnt lgkmcnt(9)
    v_pk_add_f32 v[160:161], v[160:161], v[24:25]
    v_pk_add_f32 v[162:163], v[162:163], v[26:27]
    s_waitcnt lgkmcnt(8)
    v_pk_add_f32 v[164:165], v[164:165], v[28:29]
    v_pk_add_f32 v[166:167], v[166:167], v[30:31]
    s_waitcnt lgkmcnt(7)
    v_pk_add_f32 v[176:177], v[176:177], v[32:33]
    v_pk_add_f32 v[178:179], v[178:179], v[34:35]
    s_waitcnt lgkmcnt(6)
    v_pk_add_f32 v[180:181], v[180:181], v[36:37]
    v_pk_add_f32 v[182:183], v[182:183], v[38:39]
    s_waitcnt lgkmcnt(5)
    v_pk_add_f32 v[192:193], v[192:193], v[40:41]
    v_pk_add_f32 v[194:195], v[194:195], v[42:43]
    s_waitcnt lgkmcnt(4)
    v_pk_add_f32 v[196:197], v[196:197], v[44:45]
    v_pk_add_f32 v[198:199], v[198:199], v[46:47]
    s_waitcnt lgkmcnt(3)
    v_pk_add_f32 v[208:209], v[208:209], v[48:49]
    v_pk_add_f32 v[210:211], v[210:211], v[50:51]
    s_waitcnt lgkmcnt(2)
    v_pk_add_f32 v[212:213], v[212:213], v[52:53]
    v_pk_add_f32 v[214:215], v[214:215], v[54:55]
    s_waitcnt lgkmcnt(1)
    v_pk_add_f32 v[224:225], v[224:225], v[56:57]
    v_pk_add_f32 v[226:227], v[226:227], v[58:59]
    s_waitcnt lgkmcnt(0)
    v_pk_add_f32 v[228:229], v[228:229], v[60:61]
    v_pk_add_f32 v[230:231], v[230:231], v[62:63]
    ds_write_b128 v149, v[164:167] offset:0
    ds_write_b128 v149, v[180:183] offset:1024
    ds_write_b128 v149, v[196:199] offset:2048
    ds_write_b128 v149, v[212:215] offset:3072
    ds_write_b128 v149, v[228:231] offset:4096
    s_waitcnt lgkmcnt(0)
    s_barrier
    ds_read_b128 v[24:27], v150 offset:0
    ds_read_b128 v[28:31], v150 offset:1024
    ds_read_b128 v[32:35], v150 offset:2048
    ds_read_b128 v[36:39], v150 offset:3072
    ds_read_b128 v[40:43], v150 offset:4096
    s_waitcnt lgkmcnt(4)
    v_pk_add_f32 v[160:161], v[160:161], v[24:25]
    v_pk_add_f32 v[162:163], v[162:163], v[26:27]
    v_cvt_pk_bf16_f32 v2, v160, v161
    v_cvt_pk_bf16_f32 v3, v162, v163
    v_lshlrev_b32 v160, 16, v2
    v_and_b32 v161, 0xffff0000, v2
    v_lshlrev_b32 v162, 16, v3
    v_and_b32 v163, 0xffff0000, v3
    v_mul_f32 v160, v17, v160
    v_mul_f32 v161, v17, v161
    v_mul_f32 v162, v17, v162
    v_mul_f32 v163, v17, v163
    v_cvt_pk_bf16_f32 v6, v160, v161
    v_cvt_pk_bf16_f32 v7, v162, v163
    s_waitcnt lgkmcnt(3)
    v_pk_add_f32 v[176:177], v[176:177], v[28:29]
    v_pk_add_f32 v[178:179], v[178:179], v[30:31]
    v_cvt_pk_bf16_f32 v2, v176, v177
    v_cvt_pk_bf16_f32 v3, v178, v179
    v_lshlrev_b32 v176, 16, v2
    v_and_b32 v177, 0xffff0000, v2
    v_lshlrev_b32 v178, 16, v3
    v_and_b32 v179, 0xffff0000, v3
    v_mul_f32 v176, v17, v176
    v_mul_f32 v177, v17, v177
    v_mul_f32 v178, v17, v178
    v_mul_f32 v179, v17, v179
    v_cvt_pk_bf16_f32 v8, v176, v177
    v_cvt_pk_bf16_f32 v9, v178, v179
    s_waitcnt lgkmcnt(2)
    v_pk_add_f32 v[192:193], v[192:193], v[32:33]
    v_pk_add_f32 v[194:195], v[194:195], v[34:35]
    v_cvt_pk_bf16_f32 v2, v192, v193
    v_cvt_pk_bf16_f32 v3, v194, v195
    v_lshlrev_b32 v192, 16, v2
    v_and_b32 v193, 0xffff0000, v2
    v_lshlrev_b32 v194, 16, v3
    v_and_b32 v195, 0xffff0000, v3
    v_mul_f32 v192, v17, v192
    v_mul_f32 v193, v17, v193
    v_mul_f32 v194, v17, v194
    v_mul_f32 v195, v17, v195
    s_branch PADX_14
PAD_14:
    s_branch PAD_END
PADX_14:
    v_cvt_pk_bf16_f32 v10, v192, v193
    v_cvt_pk_bf16_f32 v11, v194, v195
    s_waitcnt lgkmcnt(1)
    v_pk_add_f32 v[208:209], v[208:209], v[36:37]
    v_pk_add_f32 v[210:211], v[210:211], v[38:39]
    v_cvt_pk_bf16_f32 v2, v208, v209
    v_cvt_pk_bf16_f32 v3, v210, v211
    v_lshlrev_b32 v208, 16, v2
    v_and_b32 v209, 0xffff0000, v2
    v_lshlrev_b32 v210, 16, v3
    v_and_b32 v211, 0xffff0000, v3
    v_mul_f32 v208, v17, v208
    v_mul_f32 v209, v17, v209
    v_mul_f32 v210, v17, v210
    v_mul_f32 v211, v17, v211
    v_cvt_pk_bf16_f32 v12, v208, v209
    v_cvt_pk_bf16_f32 v13, v210, v211
    s_waitcnt lgkmcnt(0)
    v_pk_add_f32 v[224:225], v[224:225], v[40:41]
    v_pk_add_f32 v[226:227], v[226:227], v[42:43]
    v_cvt_pk_bf16_f32 v2, v224, v225
    v_cvt_pk_bf16_f32 v3, v226, v227
    v_lshlrev_b32 v224, 16, v2
    v_and_b32 v225, 0xffff0000, v2
    v_lshlrev_b32 v226, 16, v3
    v_and_b32 v227, 0xffff0000, v3
    v_mul_f32 v224, v17, v224
    v_mul_f32 v225, v17, v225
    v_mul_f32 v226, v17, v226
    v_mul_f32 v227, v17, v227
    v_cvt_pk_bf16_f32 v14, v224, v225
    v_cvt_pk_bf16_f32 v15, v226, v227
    s_setprio 0
    s_branch T_X1
K2_SERV:
    s_waitcnt lgkmcnt(0)
    s_barrier
K2_SPASS:
    s_mov_b32 s44, s59
    s_add_u32 m0, s58, 0
    s_nop 0
    buffer_load_dwordx4 v16, s[12:15], s44 offen offset:0 sc1 lds
    buffer_load_dwordx4 v16, s[12:15], s44 offen offset:1024 sc1 lds
    buffer_load_dwordx4 v16, s[12:15], s44 offen offset:2048 sc1 lds
    buffer_load_dwordx4 v16, s[12:15], s44 offen offset:3072 sc1 lds
    s_add_u32 m0, m0, 4096
    s_nop 0
    buffer_load_dwordx4 v13, s[12:15], s44 offen sc1 lds
    s_mov_b64 exec, 0xffff
    buffer_load_dwordx4 v13, s[12:15], s44 offen offset:1024 sc1 lds
    s_mov_b64 exec, -1
    s_add_u32 s44, s44, 21504
    s_add_u32 m0, s58, 21504
    s_nop 0
    buffer_load_dwordx4 v16, s[12:15], s44 offen offset:0 sc1 lds
    buffer_load_dwordx4 v16, s[12:15], s44 offen offset:1024 sc1 lds
    buffer_load_dwordx4 v16, s[12:15], s44 offen offset:2048 sc1 lds
    buffer_load_dwordx4 v16, s[12:15], s44 offen offset:3072 sc1 lds
    s_add_u32 m0, m0, 4096
    s_nop 0
    buffer_load_dwordx4 v13, s[12:15], s44 offen sc1 lds
    s_mov_b64 exec, 0xffff
    buffer_load_dwordx4 v13, s[12:15], s44 offen offset:1024 sc1 lds
    s_mov_b64 exec, -1
    s_add_u32 s44, s44, 21504
    s_mov_b32 s40, 0
    s_mov_b32 s43, 43008
K2_SSTAGE:
    s_waitcnt vmcnt(0)
    s_barrier
    s_cmp_ge_u32 s40, 6
    s_cbranch_scc1 K2_SNO
    s_add_u32 m0, s58, s43
    s_nop 0
    buffer_load_dwordx4 v16, s[12:15], s44 offen offset:0 sc1 lds
    buffer_load_dwordx4 v16, s[12:15], s44 offen offset:1024 sc1 lds
    buffer_load_dwordx4 v16, s[12:15], s44 offen offset:2048 sc1 lds
    buffer_load_dwordx4 v16, s[12:15], s44 offen offset:3072 sc1 lds
    s_add_u32 m0, m0, 4096
    s_nop 0
    buffer_load_dwordx4 v13, s[12:15], s44 offen sc1 lds
    s_mov_b64 exec, 0xffff
    buffer_load_dwordx4 v13, s[12:15], s44 offen offset:1024 sc1 lds
    s_mov_b64 exec, -1
    s_add_u32 s44, s44, 21504
    s_add_u32 s43, s43, 21504
    s_cmp_eq_u32 s43, 64512
    s_cselect_b32 s43, 0, s43
K2_SNO:
    s_add_u32 s40, s40, 1
    s_cmp_lt_u32 s40, 8
    s_cbranch_scc1 K2_SSTAGE
    s_cmp_lg_u32 s39, 0
    s_cbranch_scc1 K2_SDONE
    s_barrier
    s_mov_b32 s39, 1
    s_branch K2_SPASS
K2_SDONE:
    s_sub_u32 s38, s38, 4
    s_add_u32 s56, s38, 16
    s_mul_i32 s57, s38, 5120
    s_add_u32 s57, s57, 44032
    s_mul_i32 s56, s56, 40960
    s_add_u32 m0, s57, 0
    s_nop 0
    buffer_load_dwordx4 v240, s[52:55], s56 offen lds
    s_add_u32 m0, s57, 1024
    s_nop 0
    buffer_load_dwordx4 v241, s[52:55], s56 offen lds
    s_add_u32 m0, s57, 2048
    s_nop 0
    buffer_load_dwordx4 v242, s[52:55], s56 offen lds
    s_add_u32 m0, s57, 3072
    s_nop 0
    buffer_load_dwordx4 v243, s[52:55], s56 offen lds
    s_add_u32 m0, s57, 4096
    s_nop 0
    buffer_load_dwordx4 v244, s[52:55], s56 offen lds
    s_add_u32 s38, s38, 4
    s_branch K2_FB8
.section .rodata,"a"
.p2align 6
.amdhsa_kernel gated_mix__mha_block__dense_activation_relu__prompt_kernel
  .amdhsa_next_free_vgpr 256
  .amdhsa_next_free_sgpr 96
  .amdhsa_accum_offset 256
  .amdhsa_group_segment_fixed_size 0
  .amdhsa_kernarg_size 80
  .amdhsa_user_sgpr_count 2
  .amdhsa_user_sgpr_kernarg_segment_ptr 1
  .amdhsa_system_sgpr_workgroup_id_x 1
.end_amdhsa_kernel
```
